```python
import torch

def _softmax(x, axis=-1):
    return torch.softmax(x, dim=axis)
def _gelu(x):
    return torch.nn.functional.gelu(x, approximate="tanh")
def _silu(x):
    return torch.nn.functional.silu(x)
def _sigmoid(x):
    return torch.sigmoid(x)
def _layernorm(x, axis=-1, eps=1e-5):
    m = x.mean(dim=axis, keepdim=True)
    v = x.var(dim=axis, keepdim=True, unbiased=False)
    return (x - m) / torch.sqrt(v + eps)
def _scatter_add(tgt, idx, src, axis=0):
    return tgt.clone().index_add_(axis, idx, src)
def _segment_sum(src, seg, n):
    out = torch.zeros((n,) + src.shape[1:], dtype=src.dtype)
    return out.index_add_(0, seg, src)
def _pad(x, pw):
    flat = tuple(v for pair in reversed(pw) for v in pair)
    return torch.nn.functional.pad(x, flat)

kernel_name = 'parallel_sum__linear_attn_block__mixer_token_mlp__prompt'

def setup_inputs():

    _w = (lambda a: (lambda t: t.to(torch.bfloat16) if t.is_floating_point() else t)(torch.as_tensor(a)))
    def _A_setup():
        B, S, D = 1, 2048, 512
        return {
            "x": _w((lambda *s: torch.randn(*s, dtype=torch.bfloat16) * 0.05)(B, S, D)),
            "wqkv": _w((lambda *s: torch.randn(*s, dtype=torch.bfloat16) * 0.05)(D, 3 * D)),
            "wo": _w((lambda *s: torch.randn(*s, dtype=torch.bfloat16) * 0.05)(D, D)),
        }
    _A_in = _A_setup()

    def _B_setup():
        B, S, D, F = 1, 2048, 512, 1376
        return {
            "x": _w((lambda *s: torch.randn(*s, dtype=torch.bfloat16) * 0.05)(B, S, D)),
            "w1": _w((lambda *s: torch.randn(*s, dtype=torch.bfloat16) * 0.4)(S, F) * (S ** -0.5)),
            "b1": _w((lambda *s: torch.randn(*s, dtype=torch.bfloat16) * 3.2)(F) * 0.02),
            "w2": _w((lambda *s: torch.randn(*s, dtype=torch.bfloat16) * 0.2)(F, S) * (F ** -0.5)),
            "b2": _w((lambda *s: torch.randn(*s, dtype=torch.bfloat16) * 0.8)(S) * 0.02),
        }
    _B_in = _B_setup()

    return {
        "A_x": _A_in["x"],
        "A_wqkv": _A_in["wqkv"],
        "A_wo": _A_in["wo"],
        "B_x": _B_in["x"],
        "B_w1": _B_in["w1"],
        "B_b1": _B_in["b1"],
        "B_w2": _B_in["w2"],
        "B_b2": _B_in["b2"],
    }

def reference(A_x, A_wqkv, A_wo, B_x, B_w1, B_b1, B_w2, B_b2):
    def _A_ref(x, wqkv, wo):
        B, S, D = x.shape
        H = 32; Dh = D // H
        qkv = (lambda x, *d: x.permute(*d))((x @ wqkv).reshape(B, S, 3, H, Dh), 2, 0, 3, 1, 4)
        q, k, v = qkv[0], qkv[1], qkv[2]
        phi = lambda t: torch.where(t > 0, t + 1, torch.exp(t)) + 1e-6
        pq, pk = phi(q), phi(k)
        kv = torch.einsum("bhsd,bhse->bhde", pk, v)
        z = torch.einsum("bhsd->bhd", pk)
        num = torch.einsum("bhqd,bhde->bhqe", pq, kv)
        den = torch.einsum("bhqd,bhd->bhq", pq, z)[..., None] + 1e-6
        o = num / den
        return (lambda x, *d: x.permute(*d))(o, 0, 2, 1, 3).reshape(B, S, D) @ wo

    def _B_ref(x, w1, b1, w2, b2):
        B, S, D = x.shape
        h = _layernorm(x, axis=-1)
        u = torch.einsum("bsd,sf->bdf", h, w1) + b1
        u = _gelu(u)
        y = torch.einsum("bdf,fs->bds", u, w2) + b2
        return (lambda x, *d: x.permute(*d))(y, 0, 2, 1)

    x = A_x
    xn = _layernorm(x, axis=-1)
    return x + _A_ref(xn, A_wqkv, A_wo) + _B_ref(xn, B_w1, B_b1, B_w2, B_b2)
```

```asm
; @launch grid=(256,1,1) block=(256,1,1) lds=163840
.amdgcn_target "amdgcn-amd-amdhsa--gfx950"
.text
.set CODE_SHARE, 11
.globl parallel_sum__linear_attn_block__mixer_token_mlp__prompt_kernel
.p2align 8
.type parallel_sum__linear_attn_block__mixer_token_mlp__prompt_kernel,@function
parallel_sum__linear_attn_block__mixer_token_mlp__prompt_kernel:
s_cmp_ge_u32 s2, 256
s_cbranch_scc1 L_exit
s_load_dwordx16 s[76:91], s[0:1], 0
s_load_dwordx2 s[64:65], s[0:1], 80
s_load_dwordx2 s[56:57], s[0:1], 64
v_lshrrev_b32 v1, 6, v0
v_and_b32 v2, 63, v0
v_readfirstlane_b32 s26, v1
s_getpc_b64 s[68:69]
L_pc:
s_lshr_b32 s5, s2, 3
s_mul_i32 s70, s5, CODE_SHARE
v_add_u32 v3, s70, v0
v_lshlrev_b32 v3, 7, v3
v_cmp_gt_u32 vcc, CODE_SHARE, v0
s_mov_b32 s71, L_end-L_pc-4
v_cmp_gt_u32 s[72:73], s71, v3
s_and_b64 vcc, vcc, s[72:73]
v_mov_b32 v5, s69
v_add_co_u32 v4, s[72:73], s68, v3
s_and_b32 s4, s2, 7
s_and_b32 s71, s5, 15
v_addc_co_u32 v5, s[72:73], 0, v5, s[72:73]
s_and_saveexec_b64 s[72:73], vcc
s_cbranch_execz L_nopf
global_load_dword v1, v[4:5], off
L_nopf:
s_mov_b64 exec, s[72:73]
s_lshl4_add_u32 s12, s4, s71
s_cmp_lt_u32 s5, 16
s_cbranch_scc0 L_g2
s_lshr_b32 s68, s4, 1
s_and_b32 s69, s5, 3
s_lshl2_add_u32 s6, s68, s69
s_and_b32 s68, s4, 1
s_lshr_b32 s69, s5, 2
s_lshl2_add_u32 s7, s68, s69
s_lshl3_add_u32 s12, s6, s7
s_lshl2_add_u32 s71, s12, s26
s_lshl_b32 s71, s71, 12
v_lshlrev_b32 v8, 4, v2
s_mov_b32 s30, 2097152
s_mov_b32 s31, 0x20000
s_waitcnt lgkmcnt(0)
s_mov_b64 s[28:29], s[76:77]
buffer_load_dwordx4 v[10:13], v8, s[28:31], s71 offen offset:0
buffer_load_dwordx4 v[14:17], v8, s[28:31], s71 offen offset:1024
buffer_load_dwordx4 v[18:21], v8, s[28:31], s71 offen offset:2048
buffer_load_dwordx4 v[22:25], v8, s[28:31], s71 offen offset:3072
s_add_u32 s10, s6, s7
s_lshl_b32 s10, s10, 1
s_lshr_b32 s68, s4, 1
s_xor_b32 s68, s68, s4
s_and_b32 s68, s68, 1
s_add_u32 s10, s10, s68
s_and_b32 s10, s10, 7
s_lshl_b32 s13, s10, 7
s_mul_i32 s3, s10, 196608
s_add_u32 s14, s3, 1024
v_lshrrev_b32 v3, 3, v2
v_and_b32 v4, 7, v2
v_lshrrev_b32 v5, 4, v2
s_lshl_b32 s68, s6, 7
s_lshl_b32 s69, s26, 5
s_add_u32 s68, s68, s69
s_lshl_b32 s68, s68, 10
v_lshl_add_u32 v6, v3, 10, s68
v_add_u32 v7, 0, v5
v_xor_b32 v7, v4, v7
v_and_b32 v7, 7, v7
v_lshl_add_u32 v220, v7, 4, v6
v_add_u32 v7, 4, v5
v_xor_b32 v7, v4, v7
v_and_b32 v7, 7, v7
v_lshl_add_u32 v221, v7, 4, v6
v_add_u32 v221, 7168, v221
v_add_u32 v7, 0, v5
v_xor_b32 v7, v4, v7
v_and_b32 v7, 7, v7
v_lshl_add_u32 v222, v7, 4, v6
v_add_u32 v222, 14336, v222
v_add_u32 v7, 4, v5
v_xor_b32 v7, v4, v7
v_and_b32 v7, 7, v7
v_lshl_add_u32 v223, v7, 4, v6
v_add_u32 v223, 21504, v223
v_and_b32 v7, 1, v5
v_lshlrev_b32 v7, 2, v7
v_xor_b32 v7, v4, v7
s_mul_i32 s68, s26, 49152
s_lshl_b32 s69, s7, 7
s_add_u32 s68, s68, s69
v_mul_u32_u24 v6, 3072, v3
v_add_u32 v6, s68, v6
v_lshl_add_u32 v224, v7, 4, v6
v_add_u32 v225, 23552, v224
s_lshl_b32 s15, s26, 12
s_lshl_b32 s16, s26, 11
s_mov_b64 s[32:33], s[78:79]
s_mov_b32 s34, 1572864
s_mov_b32 s35, 0x20000
s_add_u32 m0, s15, 0
s_nop 0
buffer_load_dwordx4 v220, s[28:31], s13 offen offset:0 lds
buffer_load_dwordx4 v221, s[28:31], s13 offen offset:1024 lds
buffer_load_dwordx4 v222, s[28:31], s13 offen offset:2048 lds
buffer_load_dwordx4 v223, s[28:31], s13 offen offset:3072 lds
s_add_u32 s13, s13, 128
s_and_b32 s13, s13, 1023
s_add_u32 m0, s16, 16384
s_add_u32 s17, s14, 0
buffer_load_dwordx4 v224, s[32:35], s17 offen offset:0 lds
buffer_load_dwordx4 v225, s[32:35], s17 offen offset:1024 lds
s_add_u32 m0, s16, 24576
s_add_u32 s17, s14, 1024
buffer_load_dwordx4 v224, s[32:35], s17 offen offset:0 lds
buffer_load_dwordx4 v225, s[32:35], s17 offen offset:1024 lds
s_add_u32 s14, s14, 196608
s_cmp_eq_u32 s10, 7
s_cselect_b32 s14, 1024, s14
s_mov_b64 s[40:41], s[84:85]
s_mov_b64 s[36:37], s[80:81]
s_mov_b64 s[44:45], s[86:87]
s_mov_b64 s[48:49], s[88:89]
s_mov_b64 s[52:53], s[90:91]
s_mov_b32 s22, 6905728
s_mov_b32 s23, 11534336
s_load_dword s27, s[64:65], s22
s_load_dword s82, s[64:65], s23
s_mov_b32 s42, 5636096
s_mov_b32 s43, 0x20000
s_mov_b32 s66, 11534464
s_mov_b32 s67, 0x20000
s_mov_b32 s38, 524288
s_mov_b32 s39, 0x20000
s_mov_b32 s46, 2752
s_mov_b32 s47, 0x20000
s_mov_b32 s50, 5636096
s_mov_b32 s51, 0x20000
s_mov_b32 s54, 4096
s_mov_b32 s55, 0x20000
s_mov_b32 s58, 2097152
s_mov_b32 s59, 0x20000
s_lshl_b32 s11, s4, 11
s_lshr_b32 s18, s26, 1
s_and_b32 s19, s26, 1
s_and_b32 s68, s5, 7
s_lshr_b32 s8, s4, 1
s_lshl3_add_u32 s8, s8, s68
s_lshr_b32 s9, s5, 3
s_and_b32 s68, s5, 1
s_lshl1_add_u32 s9, s68, s9
s_and_b32 s9, s9, 3
s_and_b32 s68, s4, 1
s_lshl2_add_u32 s9, s68, s9
s_waitcnt vmcnt(11)
v_lshlrev_b32 v64, 16, v10
v_and_b32 v65, 0xffff0000, v10
v_lshlrev_b32 v66, 16, v11
v_and_b32 v67, 0xffff0000, v11
v_lshlrev_b32 v68, 16, v12
v_and_b32 v69, 0xffff0000, v12
v_lshlrev_b32 v70, 16, v13
v_and_b32 v71, 0xffff0000, v13
v_readlane_b32 s72, v64, 0
s_waitcnt vmcnt(10)
v_lshlrev_b32 v72, 16, v14
v_and_b32 v73, 0xffff0000, v14
v_lshlrev_b32 v74, 16, v15
v_and_b32 v75, 0xffff0000, v15
v_lshlrev_b32 v76, 16, v16
v_and_b32 v77, 0xffff0000, v16
v_lshlrev_b32 v78, 16, v17
v_and_b32 v79, 0xffff0000, v17
v_readlane_b32 s73, v72, 0
s_waitcnt vmcnt(9)
v_lshlrev_b32 v80, 16, v18
v_and_b32 v81, 0xffff0000, v18
v_lshlrev_b32 v82, 16, v19
v_and_b32 v83, 0xffff0000, v19
v_lshlrev_b32 v84, 16, v20
v_and_b32 v85, 0xffff0000, v20
v_lshlrev_b32 v86, 16, v21
v_and_b32 v87, 0xffff0000, v21
v_readlane_b32 s74, v80, 0
s_waitcnt vmcnt(8)
v_lshlrev_b32 v88, 16, v22
v_and_b32 v89, 0xffff0000, v22
v_lshlrev_b32 v90, 16, v23
v_and_b32 v91, 0xffff0000, v23
v_lshlrev_b32 v92, 16, v24
v_and_b32 v93, 0xffff0000, v24
v_lshlrev_b32 v94, 16, v25
v_and_b32 v95, 0xffff0000, v25
v_readlane_b32 s75, v88, 0
v_lshrrev_b32 v8, 4, v2
v_pk_add_f32 v[64:65], v[64:65], s[72:73] op_sel:[0,0] op_sel_hi:[1,0] neg_lo:[0,1] neg_hi:[0,1]
v_pk_add_f32 v[66:67], v[66:67], s[72:73] op_sel:[0,0] op_sel_hi:[1,0] neg_lo:[0,1] neg_hi:[0,1]
v_pk_add_f32 v[68:69], v[68:69], s[72:73] op_sel:[0,0] op_sel_hi:[1,0] neg_lo:[0,1] neg_hi:[0,1]
v_pk_add_f32 v[70:71], v[70:71], s[72:73] op_sel:[0,0] op_sel_hi:[1,0] neg_lo:[0,1] neg_hi:[0,1]
v_pk_add_f32 v[72:73], v[72:73], s[72:73] op_sel:[0,1] op_sel_hi:[1,1] neg_lo:[0,1] neg_hi:[0,1]
v_pk_add_f32 v[74:75], v[74:75], s[72:73] op_sel:[0,1] op_sel_hi:[1,1] neg_lo:[0,1] neg_hi:[0,1]
v_pk_add_f32 v[76:77], v[76:77], s[72:73] op_sel:[0,1] op_sel_hi:[1,1] neg_lo:[0,1] neg_hi:[0,1]
v_pk_add_f32 v[78:79], v[78:79], s[72:73] op_sel:[0,1] op_sel_hi:[1,1] neg_lo:[0,1] neg_hi:[0,1]
v_pk_add_f32 v[80:81], v[80:81], s[74:75] op_sel:[0,0] op_sel_hi:[1,0] neg_lo:[0,1] neg_hi:[0,1]
v_pk_add_f32 v[82:83], v[82:83], s[74:75] op_sel:[0,0] op_sel_hi:[1,0] neg_lo:[0,1] neg_hi:[0,1]
v_pk_add_f32 v[84:85], v[84:85], s[74:75] op_sel:[0,0] op_sel_hi:[1,0] neg_lo:[0,1] neg_hi:[0,1]
v_pk_add_f32 v[86:87], v[86:87], s[74:75] op_sel:[0,0] op_sel_hi:[1,0] neg_lo:[0,1] neg_hi:[0,1]
v_pk_add_f32 v[88:89], v[88:89], s[74:75] op_sel:[0,1] op_sel_hi:[1,1] neg_lo:[0,1] neg_hi:[0,1]
v_pk_add_f32 v[90:91], v[90:91], s[74:75] op_sel:[0,1] op_sel_hi:[1,1] neg_lo:[0,1] neg_hi:[0,1]
v_pk_add_f32 v[92:93], v[92:93], s[74:75] op_sel:[0,1] op_sel_hi:[1,1] neg_lo:[0,1] neg_hi:[0,1]
v_pk_add_f32 v[94:95], v[94:95], s[74:75] op_sel:[0,1] op_sel_hi:[1,1] neg_lo:[0,1] neg_hi:[0,1]
v_pk_add_f32 v[10:11], v[64:65], v[66:67]
v_pk_mul_f32 v[12:13], v[64:65], v[64:65]
v_pk_add_f32 v[14:15], v[72:73], v[74:75]
v_pk_mul_f32 v[16:17], v[72:73], v[72:73]
v_pk_add_f32 v[18:19], v[80:81], v[82:83]
v_pk_mul_f32 v[20:21], v[80:81], v[80:81]
v_pk_add_f32 v[22:23], v[88:89], v[90:91]
v_pk_mul_f32 v[24:25], v[88:89], v[88:89]
v_pk_add_f32 v[10:11], v[10:11], v[68:69]
v_pk_add_f32 v[14:15], v[14:15], v[76:77]
v_pk_add_f32 v[18:19], v[18:19], v[84:85]
v_pk_add_f32 v[22:23], v[22:23], v[92:93]
v_pk_add_f32 v[10:11], v[10:11], v[70:71]
v_pk_add_f32 v[14:15], v[14:15], v[78:79]
v_pk_add_f32 v[18:19], v[18:19], v[86:87]
v_pk_add_f32 v[22:23], v[22:23], v[94:95]
v_pk_fma_f32 v[12:13], v[66:67], v[66:67], v[12:13]
v_pk_fma_f32 v[16:17], v[74:75], v[74:75], v[16:17]
v_pk_fma_f32 v[20:21], v[82:83], v[82:83], v[20:21]
v_pk_fma_f32 v[24:25], v[90:91], v[90:91], v[24:25]
v_pk_fma_f32 v[12:13], v[68:69], v[68:69], v[12:13]
v_pk_fma_f32 v[16:17], v[76:77], v[76:77], v[16:17]
v_pk_fma_f32 v[20:21], v[84:85], v[84:85], v[20:21]
v_pk_fma_f32 v[24:25], v[92:93], v[92:93], v[24:25]
v_pk_fma_f32 v[12:13], v[70:71], v[70:71], v[12:13]
v_pk_fma_f32 v[16:17], v[78:79], v[78:79], v[16:17]
v_pk_fma_f32 v[20:21], v[86:87], v[86:87], v[20:21]
v_pk_fma_f32 v[24:25], v[94:95], v[94:95], v[24:25]
v_add_f32 v26, v10, v11
v_add_f32 v27, v14, v15
v_add_f32 v28, v18, v19
v_add_f32 v29, v22, v23
v_add_f32 v30, v12, v13
v_add_f32 v31, v16, v17
v_add_f32 v32, v20, v21
v_add_f32 v33, v24, v25
v_mov_b32 v9, s72
v_mov_b32 v4, s73
v_cmp_eq_u32 vcc, 1, v8
v_mov_b32 v5, s74
v_mov_b32 v6, s75
v_cndmask_b32 v9, v9, v4, vcc
v_cmp_eq_u32 vcc, 2, v8
v_permlane32_swap_b32 v26, v28
v_permlane32_swap_b32 v27, v29
v_permlane32_swap_b32 v30, v32
v_permlane32_swap_b32 v31, v33
v_cndmask_b32 v9, v9, v5, vcc
v_cmp_eq_u32 vcc, 3, v8
v_add_f32 v26, v26, v28
v_add_f32 v27, v27, v29
v_add_f32 v30, v30, v32
v_add_f32 v31, v31, v33
v_cndmask_b32 v9, v9, v6, vcc
v_permlane16_swap_b32 v26, v27
v_permlane16_swap_b32 v30, v31
v_add_f32 v26, v26, v27
v_add_f32 v30, v30, v31
s_mov_b32 s70, 0x3727c5ac
s_nop 0
v_add_f32_dpp v26, v26, v26 row_ror:8 row_mask:0xf bank_mask:0xf
v_add_f32_dpp v30, v30, v30 row_ror:8 row_mask:0xf bank_mask:0xf
s_nop 0
v_add_f32_dpp v26, v26, v26 row_ror:4 row_mask:0xf bank_mask:0xf
v_add_f32_dpp v30, v30, v30 row_ror:4 row_mask:0xf bank_mask:0xf
s_nop 0
v_add_f32_dpp v26, v26, v26 row_ror:2 row_mask:0xf bank_mask:0xf
v_add_f32_dpp v30, v30, v30 row_ror:2 row_mask:0xf bank_mask:0xf
s_nop 0
v_add_f32_dpp v26, v26, v26 row_ror:1 row_mask:0xf bank_mask:0xf
v_add_f32_dpp v30, v30, v30 row_ror:1 row_mask:0xf bank_mask:0xf
v_mul_f32 v12, 0x3b000000, v26
v_mul_f32 v16, 0x3b000000, v30
v_fma_f32 v16, -v12, v12, v16
v_max_f32 v16, 0, v16
v_add_f32 v13, s70, v16
v_rsq_f32 v13, v13
v_add_f32 v9, v9, v12
v_mul_f32 v14, v16, v13
v_fma_f32 v14, v14, v13, s70
v_rsq_f32 v14, v14
v_mul_f32 v9, v9, v13
v_mul_f32 v14, v14, v13
v_mul_f32 v15, v12, v14
v_sub_f32 v15, 0, v15
v_and_b32 v6, 1, v2
v_cmp_eq_u32 vcc, 0, v6
v_readlane_b32 s72, v14, 0
v_readlane_b32 s73, v15, 0
v_readlane_b32 s74, v14, 16
v_readlane_b32 s75, v15, 16
v_readlane_b32 s76, v14, 32
v_readlane_b32 s77, v15, 32
v_readlane_b32 s78, v14, 48
v_readlane_b32 s79, v15, 48
v_cndmask_b32 v9, v9, v13, vcc
s_mul_i32 s68, s26, 4352
s_add_u32 s68, s68, 106496
v_lshl_add_u32 v7, v2, 4, s68
v_pk_fma_f32 v[64:65], v[64:65], s[72:73], s[72:73] op_sel:[0,0,1] op_sel_hi:[1,0,1]
v_pk_fma_f32 v[66:67], v[66:67], s[72:73], s[72:73] op_sel:[0,0,1] op_sel_hi:[1,0,1]
v_pk_fma_f32 v[68:69], v[68:69], s[72:73], s[72:73] op_sel:[0,0,1] op_sel_hi:[1,0,1]
v_pk_fma_f32 v[70:71], v[70:71], s[72:73], s[72:73] op_sel:[0,0,1] op_sel_hi:[1,0,1]
v_cvt_pk_bf16_f32 v36, v64, v65
v_cvt_pk_bf16_f32 v37, v66, v67
v_cvt_pk_bf16_f32 v38, v68, v69
v_cvt_pk_bf16_f32 v39, v70, v71
ds_write_b128 v7, v[36:39] offset:0
v_pk_fma_f32 v[72:73], v[72:73], s[74:75], s[74:75] op_sel:[0,0,1] op_sel_hi:[1,0,1]
v_pk_fma_f32 v[74:75], v[74:75], s[74:75], s[74:75] op_sel:[0,0,1] op_sel_hi:[1,0,1]
v_pk_fma_f32 v[76:77], v[76:77], s[74:75], s[74:75] op_sel:[0,0,1] op_sel_hi:[1,0,1]
v_pk_fma_f32 v[78:79], v[78:79], s[74:75], s[74:75] op_sel:[0,0,1] op_sel_hi:[1,0,1]
v_cvt_pk_bf16_f32 v40, v72, v73
v_cvt_pk_bf16_f32 v41, v74, v75
v_cvt_pk_bf16_f32 v42, v76, v77
v_cvt_pk_bf16_f32 v43, v78, v79
ds_write_b128 v7, v[40:43] offset:1088
v_pk_fma_f32 v[80:81], v[80:81], s[76:77], s[76:77] op_sel:[0,0,1] op_sel_hi:[1,0,1]
v_pk_fma_f32 v[82:83], v[82:83], s[76:77], s[76:77] op_sel:[0,0,1] op_sel_hi:[1,0,1]
v_pk_fma_f32 v[84:85], v[84:85], s[76:77], s[76:77] op_sel:[0,0,1] op_sel_hi:[1,0,1]
v_pk_fma_f32 v[86:87], v[86:87], s[76:77], s[76:77] op_sel:[0,0,1] op_sel_hi:[1,0,1]
v_cvt_pk_bf16_f32 v44, v80, v81
v_cvt_pk_bf16_f32 v45, v82, v83
v_cvt_pk_bf16_f32 v46, v84, v85
v_cvt_pk_bf16_f32 v47, v86, v87
ds_write_b128 v7, v[44:47] offset:2176
v_pk_fma_f32 v[88:89], v[88:89], s[78:79], s[78:79] op_sel:[0,0,1] op_sel_hi:[1,0,1]
v_pk_fma_f32 v[90:91], v[90:91], s[78:79], s[78:79] op_sel:[0,0,1] op_sel_hi:[1,0,1]
v_pk_fma_f32 v[92:93], v[92:93], s[78:79], s[78:79] op_sel:[0,0,1] op_sel_hi:[1,0,1]
v_pk_fma_f32 v[94:95], v[94:95], s[78:79], s[78:79] op_sel:[0,0,1] op_sel_hi:[1,0,1]
v_cvt_pk_bf16_f32 v48, v88, v89
v_cvt_pk_bf16_f32 v49, v90, v91
v_cvt_pk_bf16_f32 v50, v92, v93
v_cvt_pk_bf16_f32 v51, v94, v95
ds_write_b128 v7, v[48:51] offset:3264
s_lshr_b32 s68, s26, 1
s_lshl_b32 s68, s68, 6
s_and_b32 s69, s26, 1
s_lshl_b32 s69, s69, 4
s_add_u32 s68, s68, s69
s_lshl_b32 s69, s12, 7
s_add_u32 s68, s68, s69
s_add_u32 s68, s68, 6881280
v_lshlrev_b32 v4, 2, v8
v_lshl_add_u32 v4, v6, 5, v4
s_mov_b32 exec_lo, 0x00030003
s_mov_b32 exec_hi, 0x00030003
buffer_store_dword v9, v4, s[64:67], s68 offen sc1
s_mov_b64 exec, -1
v_bfe_u32 v4, v2, 2, 2
v_mul_u32_u24 v4, 1088, v4
v_lshl_add_u32 v4, v8, 5, v4
v_and_b32 v5, 3, v2
v_lshl_add_u32 v4, v5, 3, v4
s_lshl_b32 s68, s26, 8
s_add_u32 s68, s68, 106496
v_add_u32 v4, s68, v4
v_lshlrev_b32 v5, 4, v2
v_lshl_add_u32 v5, s26, 11, v5
s_lshl_b32 s68, s12, 14
s_add_u32 s69, s68, 8192
s_waitcnt lgkmcnt(0)
s_barrier
ds_read_b64_tr_b16 v[10:11], v4 offset:0
ds_read_b64_tr_b16 v[12:13], v4 offset:4352
ds_read_b64_tr_b16 v[14:15], v4 offset:128
ds_read_b64_tr_b16 v[16:17], v4 offset:4480
ds_read_b64_tr_b16 v[18:19], v4 offset:8704
ds_read_b64_tr_b16 v[20:21], v4 offset:13056
ds_read_b64_tr_b16 v[22:23], v4 offset:8832
ds_read_b64_tr_b16 v[24:25], v4 offset:13184
s_waitcnt lgkmcnt(6)
buffer_store_dwordx4 v[10:13], v5, s[64:67], s68 offen offset:0 sc1
s_waitcnt lgkmcnt(4)
buffer_store_dwordx4 v[14:17], v5, s[64:67], s68 offen offset:1024 sc1
s_waitcnt lgkmcnt(2)
buffer_store_dwordx4 v[18:21], v5, s[64:67], s69 offen offset:0 sc1
s_waitcnt lgkmcnt(0)
buffer_store_dwordx4 v[22:25], v5, s[64:67], s69 offen offset:1024 sc1
v_and_b32 v3, 31, v2
v_lshrrev_b32 v4, 5, v2
v_bfe_u32 v5, v2, 1, 3
v_xor_b32 v5, v5, v4
s_lshl_b32 s68, s18, 13
v_lshl_add_u32 v3, v3, 7, s68
s_lshl_b32 s68, s18, 1
v_xor_b32 v5, s68, v5
v_xor_b32 v6, 0, v5
v_lshl_add_u32 v226, v6, 4, v3
v_add_u32 v230, 73728, v226
v_xor_b32 v6, 2, v5
v_lshl_add_u32 v227, v6, 4, v3
v_add_u32 v231, 73728, v227
v_xor_b32 v6, 4, v5
v_lshl_add_u32 v228, v6, 4, v3
v_add_u32 v232, 73728, v228
v_xor_b32 v6, 6, v5
v_lshl_add_u32 v229, v6, 4, v3
v_add_u32 v233, 73728, v229
v_bfe_u32 v3, v2, 2, 2
v_lshl_add_u32 v3, v4, 3, v3
v_lshlrev_b32 v3, 7, v3
v_bfe_u32 v5, v2, 4, 1
v_bfe_u32 v6, v2, 1, 1
v_lshl_add_u32 v5, v5, 1, v6
v_bfe_u32 v6, v2, 3, 1
v_xor_b32 v6, s19, v6
v_lshl_add_u32 v5, v6, 2, v5
v_lshl_add_u32 v3, v5, 4, v3
v_and_b32 v5, 1, v2
v_lshl_add_u32 v3, v5, 3, v3
s_lshl_b32 s68, s18, 11
v_add_u32 v234, s68, v3
s_sub_u32 s68, 2048, s68
v_add_u32 v235, s68, v3
v_add_u32 v236, 73728, v234
v_add_u32 v237, 73728, v235
s_waitcnt lgkmcnt(0)
s_mul_i32 s27, s27, 0x9E3779B1
s_mul_i32 s82, s82, 0x85EBCA6C
s_add_u32 s27, s27, s82
s_add_u32 s27, s27, 0x7F4A7C15
s_lshr_b32 s62, s26, 1
s_mul_i32 s62, s62, 73728
s_and_b32 s69, s26, 1
s_mul_i32 s69, s69, 12288
s_add_u32 s62, s62, s69
v_lshrrev_b32 v3, 3, v2
v_and_b32 v4, 7, v2
v_lshrrev_b32 v5, 4, v2
v_lshlrev_b32 v6, 1, v5
v_xor_b32 v6, v4, v6
v_lshlrev_b32 v6, 4, v6
s_lshl_b32 s68, s8, 7
v_lshl_add_u32 v240, v3, 12, v6
v_add_u32 v240, s68, v240
v_add_u32 v241, 31744, v240
s_lshl_b32 s69, s9, 7
v_lshl_add_u32 v242, v3, 10, v6
v_add_u32 v242, s69, v242
v_add_u32 v243, 7168, v242
s_lshl2_add_u32 s68, s8, s26
s_lshl_b32 s68, s68, 14
s_add_u32 s68, s68, s69
v_lshl_add_u32 v3, v3, 10, s68
v_lshl_add_u32 v247, v4, 4, v3
s_mul_i32 s68, s26, 11
s_add_u32 s69, s68, 11
s_min_u32 s69, s69, 43
s_lshl_b32 s0, s68, 17
s_lshl_b32 s1, s69, 17
s_and_b32 s70, s9, 1
s_lshl_b32 s70, s70, 2
s_and_b32 s71, s9, 2
s_add_u32 s70, s70, s71
s_add_u32 s70, s70, s8
s_and_b32 s71, s4, 1
s_lshl1_add_u32 s70, s71, s70
s_and_b32 s70, s70, 7
s_mul_i32 s70, s70, 10
s_lshr_b32 s70, s70, 3
s_add_u32 s68, s68, s70
s_lshl_b32 s60, s68, 17
s_lshl_b32 s63, s68, 10
s_add_u32 s70, s9, s8
s_lshl_b32 s70, s70, 1
s_and_b32 s83, s70, 6
v_bfe_u32 v3, v2, 2, 2
v_lshl_add_u32 v3, v5, 2, v3
v_bfe_u32 v4, v3, 1, 2
v_lshlrev_b32 v3, 7, v3
v_and_b32 v6, 3, v2
v_lshl_add_u32 v3, v6, 3, v3
v_add_u32 v3, s62, v3
v_xor_b32 v6, 0, v4
v_lshl_add_u32 v248, v6, 5, v3
v_xor_b32 v6, 1, v4
v_lshl_add_u32 v249, v6, 5, v3
v_xor_b32 v6, 2, v4
v_lshl_add_u32 v250, v6, 5, v3
v_xor_b32 v6, 3, v4
v_lshl_add_u32 v251, v6, 5, v3
v_lshlrev_b32 v246, 4, v2
s_lshl_b32 s68, s6, 7
s_add_u32 s68, s68, 6905856
v_and_b32 v26, 7, v2
v_lshl_add_u32 v26, v26, 4, s68
s_lshl_b32 s69, s7, 5
s_add_u32 s69, s69, 6971392
v_mov_b32 v6, s69
s_lshl_b32 s69, s7, 10
s_lshl_b32 s70, s19, 7
s_add_u32 s69, s69, s70
s_add_u32 s86, s69, 6897664
s_lshl1_add_u32 s68, s6, s18
s_lshl_b32 s68, s68, 9
s_add_u32 s79, s68, 6881280
v_and_b32 v3, 31, v2
v_lshlrev_b32 v59, 4, v3
v_lshlrev_b32 v29, 2, v3
v_lshrrev_b32 v30, 5, v2
v_lshlrev_b32 v30, 4, v30
s_lshl_b32 s70, s26, 10
s_add_u32 s70, s70, 147456
v_mov_b32 v53, v30
v_add_u32 v28, s70, v59
v_add_u32 v30, s70, v30
v_lshrrev_b32 v31, 3, v3
v_lshlrev_b32 v31, 6, v31
v_and_b32 v3, 7, v3
v_lshl_add_u32 v31, v3, 2, v31
v_add_u32 v31, s70, v31
s_mov_b32 s80, 1069066811
s_mov_b32 s81, 0xb5c1a2a0
s_mov_b32 s82, 0x358637bd
v_and_b32 v4, 16, v2
v_cmp_eq_u32 s[84:85], 0, v4
s_lshl1_add_u32 s68, s7, s19
s_lshl_b32 s20, s68, 12
s_add_u32 s20, s20, 6815744
s_lshl1_add_u32 s68, s6, s18
s_lshl_b32 s72, s68, 7
s_add_u32 s72, s72, s20
s_lshl_b32 s70, s26, 10
s_add_u32 s70, s70, 151552
v_lshl_add_u32 v8, v2, 4, s70
v_xor_b32 v9, 2048, v8
s_lshl_b32 s21, s7, 16
s_lshl_b32 s69, s19, 11
s_add_u32 s21, s21, s69
s_lshl_b32 s69, s18, 10
s_add_u32 s21, s21, s69
s_add_u32 s21, s21, 6291456
s_lshl_b32 s73, s6, 12
s_add_u32 s73, s73, s21
s_lshl4_add_u32 s68, s68, s7
s_lshl1_add_u32 s68, s68, s19
s_lshl_b32 s74, s68, 11
s_add_u32 s74, s74, 2097152
s_add_u32 s75, s74, 32768
s_lshl4_add_u32 s76, s7, s6
s_lshl1_add_u32 s77, s6, s18
s_lshl3_add_u32 s77, s77, s7
s_lshl1_add_u32 s77, s77, s19
s_lshl_b32 s77, s77, 4
s_add_u32 s77, s77, 6955008
s_lshl_b32 s78, s7, 4
s_waitcnt vmcnt(0)
s_barrier
s_cmp_lg_u32 s26, 0
s_cbranch_scc1 L_pub_1
s_lshl_b32 s68, s12, 4
s_add_u32 s68, s68, 6905856
v_lshlrev_b32 v3, 11, v2
v_mov_b32 v4, s27
s_mov_b64 exec, 255
buffer_store_dword v4, v3, s[64:67], s68 offen sc1
s_mov_b64 exec, -1
L_pub_1:
s_add_u32 m0, s15, 73728
s_nop 0
buffer_load_dwordx4 v220, s[28:31], s13 offen offset:0 lds
buffer_load_dwordx4 v221, s[28:31], s13 offen offset:1024 lds
buffer_load_dwordx4 v222, s[28:31], s13 offen offset:2048 lds
buffer_load_dwordx4 v223, s[28:31], s13 offen offset:3072 lds
s_add_u32 s13, s13, 128
s_and_b32 s13, s13, 1023
s_add_u32 m0, s16, 90112
s_add_u32 s17, s14, 0
buffer_load_dwordx4 v224, s[32:35], s17 offen offset:0 lds
buffer_load_dwordx4 v225, s[32:35], s17 offen offset:1024 lds
s_add_u32 m0, s16, 98304
s_add_u32 s17, s14, 1024
buffer_load_dwordx4 v224, s[32:35], s17 offen offset:0 lds
buffer_load_dwordx4 v225, s[32:35], s17 offen offset:1024 lds
s_add_u32 s14, s14, 196608
s_cmp_eq_u32 s10, 6
s_cselect_b32 s14, 1024, s14
ds_read_b128 a[0:3], v226 offset:0
ds_read_b64_tr_b16 v[64:65], v234 offset:16384
ds_read_b64_tr_b16 v[66:67], v234 offset:16896
ds_read_b128 a[4:7], v226 offset:4096
ds_read_b64_tr_b16 v[68:69], v234 offset:24576
ds_read_b64_tr_b16 v[70:71], v234 offset:25088
s_waitcnt lgkmcnt(3)
v_mfma_f32_32x32x16_bf16 v[96:111], a[0:3], v[64:67], 0
ds_read_b128 a[8:11], v227 offset:0
ds_read_b64_tr_b16 v[72:73], v235 offset:16384
s_add_u32 m0, s15, 32768
s_nop 0
buffer_load_dwordx4 v220, s[28:31], s13 offen offset:0 lds
s_waitcnt lgkmcnt(4)
v_mfma_f32_32x32x16_bf16 v[112:127], a[4:7], v[64:67], 0
ds_read_b64_tr_b16 v[74:75], v235 offset:16896
ds_read_b128 a[12:15], v227 offset:4096
buffer_load_dwordx4 v221, s[28:31], s13 offen offset:1024 lds
s_waitcnt lgkmcnt(4)
v_mfma_f32_32x32x16_bf16 v[128:143], a[0:3], v[68:71], 0
ds_read_b64_tr_b16 v[76:77], v235 offset:24576
ds_read_b64_tr_b16 v[78:79], v235 offset:25088
buffer_load_dwordx4 v222, s[28:31], s13 offen offset:2048 lds
v_mfma_f32_32x32x16_bf16 v[144:159], a[4:7], v[68:71], 0
buffer_load_dwordx4 v223, s[28:31], s13 offen offset:3072 lds
s_add_u32 s13, s13, 128
s_and_b32 s13, s13, 1023
s_waitcnt lgkmcnt(3)
v_mfma_f32_32x32x16_bf16 v[96:111], a[8:11], v[72:75], v[96:111]
ds_read_b128 a[16:19], v228 offset:0
ds_read_b64_tr_b16 v[64:65], v234 offset:20480
s_add_u32 m0, s16, 49152
s_add_u32 s17, s14, 0
buffer_load_dwordx4 v224, s[32:35], s17 offen offset:0 lds
s_waitcnt lgkmcnt(4)
v_mfma_f32_32x32x16_bf16 v[112:127], a[12:15], v[72:75], v[112:127]
ds_read_b64_tr_b16 v[66:67], v234 offset:20992
ds_read_b128 a[20:23], v228 offset:4096
buffer_load_dwordx4 v225, s[32:35], s17 offen offset:1024 lds
s_waitcnt lgkmcnt(4)
v_mfma_f32_32x32x16_bf16 v[128:143], a[8:11], v[76:79], v[128:143]
ds_read_b64_tr_b16 v[68:69], v234 offset:28672
ds_read_b64_tr_b16 v[70:71], v234 offset:29184
s_add_u32 m0, s16, 57344
s_add_u32 s17, s14, 1024
buffer_load_dwordx4 v224, s[32:35], s17 offen offset:0 lds
v_mfma_f32_32x32x16_bf16 v[144:159], a[12:15], v[76:79], v[144:159]
buffer_load_dwordx4 v225, s[32:35], s17 offen offset:1024 lds
s_add_u32 s14, s14, 196608
s_cmp_eq_u32 s10, 5
s_cselect_b32 s14, 1024, s14
s_waitcnt lgkmcnt(3)
v_mfma_f32_32x32x16_bf16 v[96:111], a[16:19], v[64:67], v[96:111]
ds_read_b128 a[24:27], v229 offset:0
ds_read_b64_tr_b16 v[72:73], v235 offset:20480
s_waitcnt lgkmcnt(4)
v_mfma_f32_32x32x16_bf16 v[112:127], a[20:23], v[64:67], v[112:127]
ds_read_b64_tr_b16 v[74:75], v235 offset:20992
ds_read_b128 a[28:31], v229 offset:4096
s_add_u32 m0, s15, 106496
s_nop 0
buffer_load_dwordx4 v220, s[28:31], s13 offen offset:0 lds
s_waitcnt lgkmcnt(4)
v_mfma_f32_32x32x16_bf16 v[128:143], a[16:19], v[68:71], v[128:143]
ds_read_b64_tr_b16 v[76:77], v235 offset:28672
ds_read_b64_tr_b16 v[78:79], v235 offset:29184
v_mfma_f32_32x32x16_bf16 v[144:159], a[20:23], v[68:71], v[144:159]
buffer_load_dwordx4 v221, s[28:31], s13 offen offset:1024 lds
s_waitcnt vmcnt(10) lgkmcnt(0)
s_barrier
v_mfma_f32_32x32x16_bf16 v[96:111], a[24:27], v[72:75], v[96:111]
ds_read_b128 a[32:35], v230 offset:0
ds_read_b64_tr_b16 v[64:65], v236 offset:16384
buffer_load_dwordx4 v222, s[28:31], s13 offen offset:2048 lds
v_mfma_f32_32x32x16_bf16 v[112:127], a[28:31], v[72:75], v[112:127]
ds_read_b64_tr_b16 v[66:67], v236 offset:16896
ds_read_b128 a[36:39], v230 offset:4096
buffer_load_dwordx4 v223, s[28:31], s13 offen offset:3072 lds
s_add_u32 s13, s13, 128
s_and_b32 s13, s13, 1023
v_mfma_f32_32x32x16_bf16 v[128:143], a[24:27], v[76:79], v[128:143]
ds_read_b64_tr_b16 v[68:69], v236 offset:24576
ds_read_b64_tr_b16 v[70:71], v236 offset:25088
s_add_u32 m0, s16, 122880
s_add_u32 s17, s14, 0
buffer_load_dwordx4 v224, s[32:35], s17 offen offset:0 lds
v_mfma_f32_32x32x16_bf16 v[144:159], a[28:31], v[76:79], v[144:159]
buffer_load_dwordx4 v225, s[32:35], s17 offen offset:1024 lds
s_waitcnt lgkmcnt(3)
v_mfma_f32_32x32x16_bf16 v[96:111], a[32:35], v[64:67], v[96:111]
ds_read_b128 a[40:43], v231 offset:0
ds_read_b64_tr_b16 v[72:73], v237 offset:16384
s_add_u32 m0, s16, 131072
s_add_u32 s17, s14, 1024
buffer_load_dwordx4 v224, s[32:35], s17 offen offset:0 lds
s_waitcnt lgkmcnt(4)
v_mfma_f32_32x32x16_bf16 v[112:127], a[36:39], v[64:67], v[112:127]
ds_read_b64_tr_b16 v[74:75], v237 offset:16896
ds_read_b128 a[44:47], v231 offset:4096
buffer_load_dwordx4 v225, s[32:35], s17 offen offset:1024 lds
s_add_u32 s14, s14, 196608
s_cmp_eq_u32 s10, 4
s_cselect_b32 s14, 1024, s14
s_waitcnt lgkmcnt(4)
v_mfma_f32_32x32x16_bf16 v[128:143], a[32:35], v[68:71], v[128:143]
ds_read_b64_tr_b16 v[76:77], v237 offset:24576
ds_read_b64_tr_b16 v[78:79], v237 offset:25088
s_add_u32 m0, s15, 0
s_nop 0
buffer_load_dwordx4 v220, s[28:31], s13 offen offset:0 lds
v_mfma_f32_32x32x16_bf16 v[144:159], a[36:39], v[68:71], v[144:159]
buffer_load_dwordx4 v221, s[28:31], s13 offen offset:1024 lds
s_waitcnt lgkmcnt(3)
v_mfma_f32_32x32x16_bf16 v[96:111], a[40:43], v[72:75], v[96:111]
ds_read_b128 a[48:51], v232 offset:0
ds_read_b64_tr_b16 v[64:65], v236 offset:20480
s_waitcnt lgkmcnt(4)
v_mfma_f32_32x32x16_bf16 v[112:127], a[44:47], v[72:75], v[112:127]
ds_read_b64_tr_b16 v[66:67], v236 offset:20992
ds_read_b128 a[52:55], v232 offset:4096
buffer_load_dwordx4 v222, s[28:31], s13 offen offset:2048 lds
s_waitcnt lgkmcnt(4)
v_mfma_f32_32x32x16_bf16 v[128:143], a[40:43], v[76:79], v[128:143]
ds_read_b64_tr_b16 v[68:69], v236 offset:28672
ds_read_b64_tr_b16 v[70:71], v236 offset:29184
v_mfma_f32_32x32x16_bf16 v[144:159], a[44:47], v[76:79], v[144:159]
buffer_load_dwordx4 v223, s[28:31], s13 offen offset:3072 lds
s_add_u32 s13, s13, 128
s_and_b32 s13, s13, 1023
s_waitcnt lgkmcnt(3)
v_mfma_f32_32x32x16_bf16 v[96:111], a[48:51], v[64:67], v[96:111]
ds_read_b128 a[56:59], v233 offset:0
ds_read_b64_tr_b16 v[72:73], v237 offset:20480
s_waitcnt lgkmcnt(4)
v_mfma_f32_32x32x16_bf16 v[112:127], a[52:55], v[64:67], v[112:127]
ds_read_b64_tr_b16 v[74:75], v237 offset:20992
ds_read_b128 a[60:63], v233 offset:4096
s_add_u32 m0, s16, 16384
s_add_u32 s17, s14, 0
buffer_load_dwordx4 v224, s[32:35], s17 offen offset:0 lds
s_waitcnt lgkmcnt(4)
v_mfma_f32_32x32x16_bf16 v[128:143], a[48:51], v[68:71], v[128:143]
ds_read_b64_tr_b16 v[76:77], v237 offset:28672
ds_read_b64_tr_b16 v[78:79], v237 offset:29184
v_mfma_f32_32x32x16_bf16 v[144:159], a[52:55], v[68:71], v[144:159]
buffer_load_dwordx4 v225, s[32:35], s17 offen offset:1024 lds
s_waitcnt vmcnt(14) lgkmcnt(0)
s_barrier
v_mfma_f32_32x32x16_bf16 v[96:111], a[56:59], v[72:75], v[96:111]
ds_read_b128 a[64:67], v226 offset:32768
ds_read_b64_tr_b16 v[64:65], v234 offset:49152
s_add_u32 m0, s16, 24576
s_add_u32 s17, s14, 1024
buffer_load_dwordx4 v224, s[32:35], s17 offen offset:0 lds
v_mfma_f32_32x32x16_bf16 v[112:127], a[60:63], v[72:75], v[112:127]
ds_read_b64_tr_b16 v[66:67], v234 offset:49664
ds_read_b128 a[68:71], v226 offset:36864
buffer_load_dwordx4 v225, s[32:35], s17 offen offset:1024 lds
s_add_u32 s14, s14, 196608
s_cmp_eq_u32 s10, 3
s_cselect_b32 s14, 1024, s14
v_mfma_f32_32x32x16_bf16 v[128:143], a[56:59], v[76:79], v[128:143]
ds_read_b64_tr_b16 v[68:69], v234 offset:57344
ds_read_b64_tr_b16 v[70:71], v234 offset:57856
s_add_u32 m0, s15, 73728
s_nop 0
buffer_load_dwordx4 v220, s[28:31], s13 offen offset:0 lds
v_mfma_f32_32x32x16_bf16 v[144:159], a[60:63], v[76:79], v[144:159]
buffer_load_dwordx4 v221, s[28:31], s13 offen offset:1024 lds
s_waitcnt lgkmcnt(3)
v_mfma_f32_32x32x16_bf16 v[96:111], a[64:67], v[64:67], v[96:111]
ds_read_b128 a[72:75], v227 offset:32768
ds_read_b64_tr_b16 v[72:73], v235 offset:49152
s_waitcnt lgkmcnt(4)
v_mfma_f32_32x32x16_bf16 v[112:127], a[68:71], v[64:67], v[112:127]
ds_read_b64_tr_b16 v[74:75], v235 offset:49664
ds_read_b128 a[76:79], v227 offset:36864
buffer_load_dwordx4 v222, s[28:31], s13 offen offset:2048 lds
s_waitcnt lgkmcnt(4)
v_mfma_f32_32x32x16_bf16 v[128:143], a[64:67], v[68:71], v[128:143]
ds_read_b64_tr_b16 v[76:77], v235 offset:57344
ds_read_b64_tr_b16 v[78:79], v235 offset:57856
v_mfma_f32_32x32x16_bf16 v[144:159], a[68:71], v[68:71], v[144:159]
buffer_load_dwordx4 v223, s[28:31], s13 offen offset:3072 lds
s_add_u32 s13, s13, 128
s_and_b32 s13, s13, 1023
s_waitcnt lgkmcnt(3)
v_mfma_f32_32x32x16_bf16 v[96:111], a[72:75], v[72:75], v[96:111]
ds_read_b128 a[80:83], v228 offset:32768
ds_read_b64_tr_b16 v[64:65], v234 offset:53248
s_waitcnt lgkmcnt(4)
v_mfma_f32_32x32x16_bf16 v[112:127], a[76:79], v[72:75], v[112:127]
ds_read_b64_tr_b16 v[66:67], v234 offset:53760
ds_read_b128 a[84:87], v228 offset:36864
s_add_u32 m0, s16, 90112
s_add_u32 s17, s14, 0
buffer_load_dwordx4 v224, s[32:35], s17 offen offset:0 lds
s_waitcnt lgkmcnt(4)
v_mfma_f32_32x32x16_bf16 v[128:143], a[72:75], v[76:79], v[128:143]
ds_read_b64_tr_b16 v[68:69], v234 offset:61440
ds_read_b64_tr_b16 v[70:71], v234 offset:61952
v_mfma_f32_32x32x16_bf16 v[144:159], a[76:79], v[76:79], v[144:159]
buffer_load_dwordx4 v225, s[32:35], s17 offen offset:1024 lds
s_waitcnt lgkmcnt(3)
v_mfma_f32_32x32x16_bf16 v[96:111], a[80:83], v[64:67], v[96:111]
ds_read_b128 a[88:91], v229 offset:32768
ds_read_b64_tr_b16 v[72:73], v235 offset:53248
s_waitcnt lgkmcnt(4)
v_mfma_f32_32x32x16_bf16 v[112:127], a[84:87], v[64:67], v[112:127]
ds_read_b64_tr_b16 v[74:75], v235 offset:53760
ds_read_b128 a[92:95], v229 offset:36864
s_add_u32 m0, s16, 98304
s_add_u32 s17, s14, 1024
buffer_load_dwordx4 v224, s[32:35], s17 offen offset:0 lds
s_waitcnt lgkmcnt(4)
v_mfma_f32_32x32x16_bf16 v[128:143], a[80:83], v[68:71], v[128:143]
ds_read_b64_tr_b16 v[76:77], v235 offset:61440
ds_read_b64_tr_b16 v[78:79], v235 offset:61952
v_mfma_f32_32x32x16_bf16 v[144:159], a[84:87], v[68:71], v[144:159]
buffer_load_dwordx4 v225, s[32:35], s17 offen offset:1024 lds
s_add_u32 s14, s14, 196608
s_cmp_eq_u32 s10, 2
s_cselect_b32 s14, 1024, s14
s_waitcnt vmcnt(16) lgkmcnt(0)
s_barrier
v_mfma_f32_32x32x16_bf16 v[96:111], a[88:91], v[72:75], v[96:111]
ds_read_b128 a[96:99], v230 offset:32768
ds_read_b64_tr_b16 v[64:65], v236 offset:49152
v_mfma_f32_32x32x16_bf16 v[112:127], a[92:95], v[72:75], v[112:127]
ds_read_b64_tr_b16 v[66:67], v236 offset:49664
ds_read_b128 a[100:103], v230 offset:36864
s_add_u32 m0, s15, 32768
s_nop 0
buffer_load_dwordx4 v220, s[28:31], s13 offen offset:0 lds
v_mfma_f32_32x32x16_bf16 v[128:143], a[88:91], v[76:79], v[128:143]
ds_read_b64_tr_b16 v[68:69], v236 offset:57344
ds_read_b64_tr_b16 v[70:71], v236 offset:57856
v_mfma_f32_32x32x16_bf16 v[144:159], a[92:95], v[76:79], v[144:159]
buffer_load_dwordx4 v221, s[28:31], s13 offen offset:1024 lds
buffer_load_dword v27, v26, s[64:67], s11 offen sc1
s_waitcnt lgkmcnt(3)
v_mfma_f32_32x32x16_bf16 v[96:111], a[96:99], v[64:67], v[96:111]
ds_read_b128 a[104:107], v231 offset:32768
ds_read_b64_tr_b16 v[72:73], v237 offset:49152
s_waitcnt lgkmcnt(4)
v_mfma_f32_32x32x16_bf16 v[112:127], a[100:103], v[64:67], v[112:127]
ds_read_b64_tr_b16 v[74:75], v237 offset:49664
ds_read_b128 a[108:111], v231 offset:36864
buffer_load_dwordx4 v222, s[28:31], s13 offen offset:2048 lds
s_waitcnt lgkmcnt(4)
v_mfma_f32_32x32x16_bf16 v[128:143], a[96:99], v[68:71], v[128:143]
ds_read_b64_tr_b16 v[76:77], v237 offset:57344
ds_read_b64_tr_b16 v[78:79], v237 offset:57856
v_mfma_f32_32x32x16_bf16 v[144:159], a[100:103], v[68:71], v[144:159]
buffer_load_dwordx4 v223, s[28:31], s13 offen offset:3072 lds
s_add_u32 s13, s13, 128
s_and_b32 s13, s13, 1023
s_waitcnt lgkmcnt(3)
v_mfma_f32_32x32x16_bf16 v[96:111], a[104:107], v[72:75], v[96:111]
ds_read_b128 a[112:115], v232 offset:32768
ds_read_b64_tr_b16 v[64:65], v236 offset:53248
s_waitcnt lgkmcnt(4)
v_mfma_f32_32x32x16_bf16 v[112:127], a[108:111], v[72:75], v[112:127]
ds_read_b64_tr_b16 v[66:67], v236 offset:53760
ds_read_b128 a[116:119], v232 offset:36864
s_add_u32 m0, s16, 49152
s_add_u32 s17, s14, 0
buffer_load_dwordx4 v224, s[32:35], s17 offen offset:0 lds
s_waitcnt lgkmcnt(4)
v_mfma_f32_32x32x16_bf16 v[128:143], a[104:107], v[76:79], v[128:143]
ds_read_b64_tr_b16 v[68:69], v236 offset:61440
ds_read_b64_tr_b16 v[70:71], v236 offset:61952
v_mfma_f32_32x32x16_bf16 v[144:159], a[108:111], v[76:79], v[144:159]
buffer_load_dwordx4 v225, s[32:35], s17 offen offset:1024 lds
s_waitcnt lgkmcnt(3)
v_mfma_f32_32x32x16_bf16 v[96:111], a[112:115], v[64:67], v[96:111]
ds_read_b128 a[120:123], v233 offset:32768
ds_read_b64_tr_b16 v[72:73], v237 offset:53248
s_waitcnt lgkmcnt(4)
v_mfma_f32_32x32x16_bf16 v[112:127], a[116:119], v[64:67], v[112:127]
ds_read_b64_tr_b16 v[74:75], v237 offset:53760
ds_read_b128 a[124:127], v233 offset:36864
s_add_u32 m0, s16, 57344
s_add_u32 s17, s14, 1024
buffer_load_dwordx4 v224, s[32:35], s17 offen offset:0 lds
s_waitcnt lgkmcnt(4)
v_mfma_f32_32x32x16_bf16 v[128:143], a[112:115], v[68:71], v[128:143]
ds_read_b64_tr_b16 v[76:77], v237 offset:61440
ds_read_b64_tr_b16 v[78:79], v237 offset:61952
v_mfma_f32_32x32x16_bf16 v[144:159], a[116:119], v[68:71], v[144:159]
buffer_load_dwordx4 v225, s[32:35], s17 offen offset:1024 lds
s_add_u32 s14, s14, 196608
s_cmp_eq_u32 s10, 1
s_cselect_b32 s14, 1024, s14
s_waitcnt vmcnt(17) lgkmcnt(0)
s_barrier
v_mfma_f32_32x32x16_bf16 v[96:111], a[120:123], v[72:75], v[96:111]
ds_read_b128 a[128:131], v226 offset:0
ds_read_b64_tr_b16 v[64:65], v234 offset:16384
v_mfma_f32_32x32x16_bf16 v[112:127], a[124:127], v[72:75], v[112:127]
ds_read_b64_tr_b16 v[66:67], v234 offset:16896
ds_read_b128 a[132:135], v226 offset:4096
s_add_u32 m0, s15, 106496
s_nop 0
buffer_load_dwordx4 v220, s[28:31], s13 offen offset:0 lds
v_mfma_f32_32x32x16_bf16 v[128:143], a[120:123], v[76:79], v[128:143]
ds_read_b64_tr_b16 v[68:69], v234 offset:24576
ds_read_b64_tr_b16 v[70:71], v234 offset:25088
v_mfma_f32_32x32x16_bf16 v[144:159], a[124:127], v[76:79], v[144:159]
buffer_load_dwordx4 v221, s[28:31], s13 offen offset:1024 lds
s_mov_b32 s25, 0
s_waitcnt vmcnt(8)
L_poll_2:
v_cmp_ne_u32 vcc, s27, v27
s_cbranch_vccz L_polld_3
s_add_u32 s25, s25, 1
s_cmp_lt_u32 s25, 262144
s_cbranch_scc0 L_polld_3
s_sleep 1
buffer_load_dword v27, v26, s[64:67], s11 offen sc1
s_waitcnt vmcnt(0)
s_branch L_poll_2
L_polld_3:
buffer_load_dwordx4 v[32:35], v59, s[64:67], s79 offen sc1
s_waitcnt lgkmcnt(3)
v_mfma_f32_32x32x16_bf16 v[96:111], a[128:131], v[64:67], v[96:111]
ds_read_b128 a[136:139], v227 offset:0
ds_read_b64_tr_b16 v[72:73], v235 offset:16384
s_waitcnt lgkmcnt(4)
v_mfma_f32_32x32x16_bf16 v[112:127], a[132:135], v[64:67], v[112:127]
ds_read_b64_tr_b16 v[74:75], v235 offset:16896
ds_read_b128 a[140:143], v227 offset:4096
buffer_load_dwordx4 v222, s[28:31], s13 offen offset:2048 lds
s_waitcnt lgkmcnt(4)
v_mfma_f32_32x32x16_bf16 v[128:143], a[128:131], v[68:71], v[128:143]
ds_read_b64_tr_b16 v[76:77], v235 offset:24576
ds_read_b64_tr_b16 v[78:79], v235 offset:25088
v_mfma_f32_32x32x16_bf16 v[144:159], a[132:135], v[68:71], v[144:159]
buffer_load_dwordx4 v223, s[28:31], s13 offen offset:3072 lds
s_add_u32 s13, s13, 128
s_waitcnt lgkmcnt(3)
v_mfma_f32_32x32x16_bf16 v[96:111], a[136:139], v[72:75], v[96:111]
ds_read_b128 a[144:147], v228 offset:0
ds_read_b64_tr_b16 v[64:65], v234 offset:20480
s_waitcnt lgkmcnt(4)
v_mfma_f32_32x32x16_bf16 v[112:127], a[140:143], v[72:75], v[112:127]
ds_read_b64_tr_b16 v[66:67], v234 offset:20992
ds_read_b128 a[148:151], v228 offset:4096
s_add_u32 m0, s16, 122880
s_add_u32 s17, s14, 0
buffer_load_dwordx4 v224, s[32:35], s17 offen offset:0 lds
s_waitcnt lgkmcnt(4)
v_mfma_f32_32x32x16_bf16 v[128:143], a[136:139], v[76:79], v[128:143]
ds_read_b64_tr_b16 v[68:69], v234 offset:28672
ds_read_b64_tr_b16 v[70:71], v234 offset:29184
v_mfma_f32_32x32x16_bf16 v[144:159], a[140:143], v[76:79], v[144:159]
buffer_load_dwordx4 v225, s[32:35], s17 offen offset:1024 lds
s_waitcnt lgkmcnt(3)
v_mfma_f32_32x32x16_bf16 v[96:111], a[144:147], v[64:67], v[96:111]
ds_read_b128 a[152:155], v229 offset:0
ds_read_b64_tr_b16 v[72:73], v235 offset:20480
s_waitcnt lgkmcnt(4)
v_mfma_f32_32x32x16_bf16 v[112:127], a[148:151], v[64:67], v[112:127]
ds_read_b64_tr_b16 v[74:75], v235 offset:20992
ds_read_b128 a[156:159], v229 offset:4096
s_add_u32 m0, s16, 131072
s_add_u32 s17, s14, 1024
buffer_load_dwordx4 v224, s[32:35], s17 offen offset:0 lds
s_waitcnt lgkmcnt(4)
v_mfma_f32_32x32x16_bf16 v[128:143], a[144:147], v[68:71], v[128:143]
ds_read_b64_tr_b16 v[76:77], v235 offset:28672
ds_read_b64_tr_b16 v[78:79], v235 offset:29184
v_mfma_f32_32x32x16_bf16 v[144:159], a[148:151], v[68:71], v[144:159]
buffer_load_dwordx4 v225, s[32:35], s17 offen offset:1024 lds
s_add_u32 s14, s14, 196608
s_waitcnt lgkmcnt(0)
s_barrier
v_mfma_f32_32x32x16_bf16 v[96:111], a[152:155], v[72:75], v[96:111]
ds_read_b128 a[160:163], v230 offset:0
ds_read_b64_tr_b16 v[64:65], v236 offset:16384
v_mfma_f32_32x32x16_bf16 v[112:127], a[156:159], v[72:75], v[112:127]
ds_read_b64_tr_b16 v[66:67], v236 offset:16896
ds_read_b128 a[164:167], v230 offset:4096
s_add_u32 m0, s16, 0
s_add_u32 s3, s10, 0
s_and_b32 s3, s3, 7
s_mul_i32 s3, s3, 196608
buffer_load_dwordx4 v224, s[32:35], s3 offen offset:0 lds
v_mfma_f32_32x32x16_bf16 v[128:143], a[152:155], v[76:79], v[128:143]
ds_read_b64_tr_b16 v[68:69], v236 offset:24576
ds_read_b64_tr_b16 v[70:71], v236 offset:25088
v_mfma_f32_32x32x16_bf16 v[144:159], a[156:159], v[76:79], v[144:159]
buffer_load_dwordx4 v225, s[32:35], s3 offen offset:1024 lds
s_waitcnt lgkmcnt(3)
v_mfma_f32_32x32x16_bf16 v[96:111], a[160:163], v[64:67], v[96:111]
ds_read_b128 a[168:171], v231 offset:0
ds_read_b64_tr_b16 v[72:73], v237 offset:16384
s_waitcnt lgkmcnt(4)
v_mfma_f32_32x32x16_bf16 v[112:127], a[164:167], v[64:67], v[112:127]
ds_read_b64_tr_b16 v[74:75], v237 offset:16896
ds_read_b128 a[172:175], v231 offset:4096
s_add_u32 m0, s16, 8192
s_add_u32 s3, s10, 2
s_and_b32 s3, s3, 7
s_mul_i32 s3, s3, 196608
buffer_load_dwordx4 v224, s[32:35], s3 offen offset:0 lds
s_waitcnt lgkmcnt(4)
v_mfma_f32_32x32x16_bf16 v[128:143], a[160:163], v[68:71], v[128:143]
ds_read_b64_tr_b16 v[76:77], v237 offset:24576
ds_read_b64_tr_b16 v[78:79], v237 offset:25088
v_mfma_f32_32x32x16_bf16 v[144:159], a[164:167], v[68:71], v[144:159]
buffer_load_dwordx4 v225, s[32:35], s3 offen offset:1024 lds
buffer_load_dword v7, v6, s[64:67], s11 offen sc1
s_waitcnt lgkmcnt(3)
v_mfma_f32_32x32x16_bf16 v[96:111], a[168:171], v[72:75], v[96:111]
ds_read_b128 a[176:179], v232 offset:0
ds_read_b64_tr_b16 v[64:65], v236 offset:20480
s_waitcnt lgkmcnt(4)
v_mfma_f32_32x32x16_bf16 v[112:127], a[172:175], v[72:75], v[112:127]
ds_read_b64_tr_b16 v[66:67], v236 offset:20992
ds_read_b128 a[180:183], v232 offset:4096
s_add_u32 m0, s16, 16384
s_add_u32 s3, s10, 4
s_and_b32 s3, s3, 7
s_mul_i32 s3, s3, 196608
buffer_load_dwordx4 v224, s[32:35], s3 offen offset:0 lds
s_waitcnt lgkmcnt(4)
v_mfma_f32_32x32x16_bf16 v[128:143], a[168:171], v[76:79], v[128:143]
ds_read_b64_tr_b16 v[68:69], v236 offset:28672
ds_read_b64_tr_b16 v[70:71], v236 offset:29184
v_mfma_f32_32x32x16_bf16 v[144:159], a[172:175], v[76:79], v[144:159]
buffer_load_dwordx4 v225, s[32:35], s3 offen offset:1024 lds
s_waitcnt vmcnt(13)
ds_write_b128 v28, v[32:35]
s_waitcnt lgkmcnt(4)
v_mfma_f32_32x32x16_bf16 v[96:111], a[176:179], v[64:67], v[96:111]
ds_read_b128 a[184:187], v233 offset:0
ds_read_b64_tr_b16 v[72:73], v237 offset:20480
s_waitcnt lgkmcnt(5)
v_mfma_f32_32x32x16_bf16 v[112:127], a[180:183], v[64:67], v[112:127]
ds_read_b64_tr_b16 v[74:75], v237 offset:20992
ds_read_b128 a[188:191], v233 offset:4096
s_waitcnt lgkmcnt(5)
v_mfma_f32_32x32x16_bf16 v[128:143], a[176:179], v[68:71], v[128:143]
ds_read_b64_tr_b16 v[76:77], v237 offset:28672
ds_read_b64_tr_b16 v[78:79], v237 offset:29184
v_mfma_f32_32x32x16_bf16 v[144:159], a[180:183], v[68:71], v[144:159]
s_waitcnt lgkmcnt(0)
s_barrier
v_mfma_f32_32x32x16_bf16 v[96:111], a[184:187], v[72:75], v[96:111]
ds_read_b128 a[192:195], v226 offset:32768
ds_read_b64_tr_b16 v[64:65], v234 offset:49152
v_mfma_f32_32x32x16_bf16 v[112:127], a[188:191], v[72:75], v[112:127]
ds_read_b64_tr_b16 v[66:67], v234 offset:49664
ds_read_b128 a[196:199], v226 offset:36864
s_add_u32 m0, s16, 73728
s_add_u32 s3, s10, 1
s_and_b32 s3, s3, 7
s_mul_i32 s3, s3, 196608
buffer_load_dwordx4 v224, s[32:35], s3 offen offset:0 lds
v_mfma_f32_32x32x16_bf16 v[128:143], a[184:187], v[76:79], v[128:143]
ds_read_b64_tr_b16 v[68:69], v234 offset:57344
ds_read_b64_tr_b16 v[70:71], v234 offset:57856
v_mfma_f32_32x32x16_bf16 v[144:159], a[188:191], v[76:79], v[144:159]
buffer_load_dwordx4 v225, s[32:35], s3 offen offset:1024 lds
s_waitcnt lgkmcnt(3)
v_mfma_f32_32x32x16_bf16 v[96:111], a[192:195], v[64:67], v[96:111]
ds_read_b128 a[200:203], v227 offset:32768
ds_read_b64_tr_b16 v[72:73], v235 offset:49152
s_waitcnt lgkmcnt(4)
v_mfma_f32_32x32x16_bf16 v[112:127], a[196:199], v[64:67], v[112:127]
ds_read_b64_tr_b16 v[74:75], v235 offset:49664
ds_read_b128 a[204:207], v227 offset:36864
s_add_u32 m0, s16, 81920
s_add_u32 s3, s10, 3
s_and_b32 s3, s3, 7
s_mul_i32 s3, s3, 196608
buffer_load_dwordx4 v224, s[32:35], s3 offen offset:0 lds
s_waitcnt lgkmcnt(4)
v_mfma_f32_32x32x16_bf16 v[128:143], a[192:195], v[68:71], v[128:143]
ds_read_b64_tr_b16 v[76:77], v235 offset:57344
ds_read_b64_tr_b16 v[78:79], v235 offset:57856
v_mfma_f32_32x32x16_bf16 v[144:159], a[196:199], v[68:71], v[144:159]
buffer_load_dwordx4 v225, s[32:35], s3 offen offset:1024 lds
ds_read_b128 v[160:163], v30 offset:0
ds_read_b128 v[164:167], v30 offset:32
ds_read_b128 v[168:171], v30 offset:64
s_mov_b32 s25, 0
s_waitcnt vmcnt(6)
L_poll_4:
v_cmp_ne_u32 vcc, s27, v7
s_cbranch_vccz L_polld_5
s_add_u32 s25, s25, 1
s_cmp_lt_u32 s25, 262144
s_cbranch_scc0 L_polld_5
s_sleep 1
buffer_load_dword v7, v6, s[64:67], s11 offen sc1
s_waitcnt vmcnt(0)
s_branch L_poll_4
L_polld_5:
v_add_u32 v6, 16, v6
buffer_load_dword v52, v29, s[64:67], s86 offen offset:256 sc1
buffer_load_dword v54, v29, s[64:67], s86 offen offset:512 sc1
s_waitcnt lgkmcnt(6)
v_mfma_f32_32x32x16_bf16 v[96:111], a[200:203], v[72:75], v[96:111]
ds_read_b128 a[208:211], v228 offset:32768
ds_read_b64_tr_b16 v[64:65], v234 offset:53248
s_waitcnt lgkmcnt(7)
v_mfma_f32_32x32x16_bf16 v[112:127], a[204:207], v[72:75], v[112:127]
ds_read_b64_tr_b16 v[66:67], v234 offset:53760
ds_read_b128 a[212:215], v228 offset:36864
s_add_u32 m0, s16, 90112
s_add_u32 s3, s10, 5
s_and_b32 s3, s3, 7
s_mul_i32 s3, s3, 196608
buffer_load_dwordx4 v224, s[32:35], s3 offen offset:0 lds
s_waitcnt lgkmcnt(7)
v_mfma_f32_32x32x16_bf16 v[128:143], a[200:203], v[76:79], v[128:143]
ds_read_b64_tr_b16 v[68:69], v234 offset:61440
ds_read_b64_tr_b16 v[70:71], v234 offset:61952
v_mfma_f32_32x32x16_bf16 v[144:159], a[204:207], v[76:79], v[144:159]
buffer_load_dwordx4 v225, s[32:35], s3 offen offset:1024 lds
ds_read_b128 v[172:175], v30 offset:96
ds_read_b128 v[176:179], v30 offset:128
ds_read_b128 v[180:183], v30 offset:160
s_waitcnt lgkmcnt(6)
v_mfma_f32_32x32x16_bf16 v[96:111], a[208:211], v[64:67], v[96:111]
ds_read_b128 a[216:219], v229 offset:32768
ds_read_b64_tr_b16 v[72:73], v235 offset:53248
s_waitcnt lgkmcnt(7)
v_mfma_f32_32x32x16_bf16 v[112:127], a[212:215], v[64:67], v[112:127]
ds_read_b64_tr_b16 v[74:75], v235 offset:53760
ds_read_b128 a[220:223], v229 offset:36864
s_waitcnt lgkmcnt(7)
v_mfma_f32_32x32x16_bf16 v[128:143], a[208:211], v[68:71], v[128:143]
ds_read_b64_tr_b16 v[76:77], v235 offset:61440
ds_read_b64_tr_b16 v[78:79], v235 offset:61952
v_mfma_f32_32x32x16_bf16 v[144:159], a[212:215], v[68:71], v[144:159]
ds_read_b128 v[184:187], v30 offset:192
ds_read_b128 v[188:191], v30 offset:224
ds_read_b32 v56, v31 offset:0
s_waitcnt lgkmcnt(0)
s_barrier
v_mfma_f32_32x32x16_bf16 v[96:111], a[216:219], v[72:75], v[96:111]
ds_read_b128 a[224:227], v230 offset:32768
ds_read_b64_tr_b16 v[64:65], v236 offset:49152
v_mfma_f32_32x32x16_bf16 v[112:127], a[220:223], v[72:75], v[112:127]
ds_read_b64_tr_b16 v[66:67], v236 offset:49664
ds_read_b128 a[228:231], v230 offset:36864
v_mfma_f32_32x32x16_bf16 v[128:143], a[216:219], v[76:79], v[128:143]
ds_read_b64_tr_b16 v[68:69], v236 offset:57344
ds_read_b64_tr_b16 v[70:71], v236 offset:57856
v_mfma_f32_32x32x16_bf16 v[144:159], a[220:223], v[76:79], v[144:159]
ds_read_b32 v57, v31 offset:32
ds_read_b128 v[192:195], v30 offset:256
ds_read_b128 v[196:199], v30 offset:288
s_waitcnt lgkmcnt(6)
v_mfma_f32_32x32x16_bf16 v[96:111], a[224:227], v[64:67], v[96:111]
ds_read_b128 a[232:235], v231 offset:32768
ds_read_b64_tr_b16 v[72:73], v237 offset:49152
s_waitcnt lgkmcnt(7)
v_mfma_f32_32x32x16_bf16 v[112:127], a[228:231], v[64:67], v[112:127]
ds_read_b64_tr_b16 v[74:75], v237 offset:49664
ds_read_b128 a[236:239], v231 offset:36864
s_waitcnt lgkmcnt(7)
v_mfma_f32_32x32x16_bf16 v[128:143], a[224:227], v[68:71], v[128:143]
ds_read_b64_tr_b16 v[76:77], v237 offset:57344
ds_read_b64_tr_b16 v[78:79], v237 offset:57856
v_mfma_f32_32x32x16_bf16 v[144:159], a[228:231], v[68:71], v[144:159]
ds_read_b128 v[200:203], v30 offset:320
ds_read_b128 v[204:207], v30 offset:352
s_waitcnt lgkmcnt(5)
v_mfma_f32_32x32x16_bf16 v[96:111], a[232:235], v[72:75], v[96:111]
ds_read_b128 a[240:243], v232 offset:32768
ds_read_b64_tr_b16 v[64:65], v236 offset:53248
s_waitcnt lgkmcnt(6)
v_mfma_f32_32x32x16_bf16 v[112:127], a[236:239], v[72:75], v[112:127]
ds_read_b64_tr_b16 v[66:67], v236 offset:53760
ds_read_b128 a[244:247], v232 offset:36864
s_waitcnt lgkmcnt(6)
v_mfma_f32_32x32x16_bf16 v[128:143], a[232:235], v[76:79], v[128:143]
ds_read_b64_tr_b16 v[68:69], v236 offset:61440
ds_read_b64_tr_b16 v[70:71], v236 offset:61952
v_mfma_f32_32x32x16_bf16 v[144:159], a[236:239], v[76:79], v[144:159]
ds_read_b128 v[208:211], v30 offset:384
ds_read_b128 v[212:215], v30 offset:416
s_waitcnt lgkmcnt(5)
v_mfma_f32_32x32x16_bf16 v[96:111], a[240:243], v[64:67], v[96:111]
ds_read_b128 a[248:251], v233 offset:32768
ds_read_b64_tr_b16 v[72:73], v237 offset:53248
s_waitcnt lgkmcnt(6)
v_mfma_f32_32x32x16_bf16 v[112:127], a[244:247], v[64:67], v[112:127]
ds_read_b64_tr_b16 v[74:75], v237 offset:53760
ds_read_b128 a[252:255], v233 offset:36864
s_waitcnt lgkmcnt(6)
v_mfma_f32_32x32x16_bf16 v[128:143], a[240:243], v[68:71], v[128:143]
ds_read_b64_tr_b16 v[76:77], v237 offset:61440
ds_read_b64_tr_b16 v[78:79], v237 offset:61952
v_mfma_f32_32x32x16_bf16 v[144:159], a[244:247], v[68:71], v[144:159]
ds_read_b128 v[216:219], v30 offset:448
ds_read_b128 v[220:223], v30 offset:480
s_waitcnt lgkmcnt(0)
s_barrier
v_mfma_f32_32x32x16_bf16 v[96:111], a[248:251], v[72:75], v[96:111]
v_mfma_f32_32x32x16_bf16 v[112:127], a[252:255], v[72:75], v[112:127]
v_mfma_f32_32x32x16_bf16 v[128:143], a[248:251], v[76:79], v[128:143]
v_mfma_f32_32x32x16_bf16 v[144:159], a[252:255], v[76:79], v[144:159]
ds_read_b32 v58, v31 offset:256
ds_read_b32 v59, v31 offset:288
s_waitcnt vmcnt(2) lgkmcnt(0)
v_pk_fma_f32 v[10:11], v[164:165], v[52:53], s[82:83] op_sel_hi:[1,0,0] neg_lo:[0,1,0] neg_hi:[0,1,0]
v_pk_fma_f32 v[12:13], v[166:167], v[52:53], s[82:83] op_sel_hi:[1,0,0] neg_lo:[0,1,0] neg_hi:[0,1,0]
v_pk_fma_f32 v[14:15], v[172:173], v[52:53], s[82:83] op_sel_hi:[1,0,0] neg_lo:[0,1,0] neg_hi:[0,1,0]
s_add_u32 m0, s62, 49152
s_nop 0
buffer_load_dwordx4 v240, s[48:51], s60 offen lds
v_pk_fma_f32 v[16:17], v[174:175], v[52:53], s[82:83] op_sel_hi:[1,0,0] neg_lo:[0,1,0] neg_hi:[0,1,0]
v_pk_fma_f32 v[10:11], v[96:97], v[160:161], v[10:11]
v_pk_fma_f32 v[12:13], v[98:99], v[162:163], v[12:13]
buffer_load_dwordx4 v241, s[48:51], s60 offen offset:1024 lds
v_pk_fma_f32 v[14:15], v[100:101], v[168:169], v[14:15]
v_pk_fma_f32 v[16:17], v[102:103], v[170:171], v[16:17]
v_pk_fma_f32 v[18:19], v[10:11], s[80:81], s[80:81] op_sel:[0,0,1] op_sel_hi:[1,0,1]
s_add_u32 m0, s62, 51200
s_add_u32 s60, s60, 65536
buffer_load_dwordx4 v240, s[48:51], s60 offen lds
v_pk_fma_f32 v[20:21], v[12:13], s[80:81], s[80:81] op_sel:[0,0,1] op_sel_hi:[1,0,1]
v_pk_fma_f32 v[22:23], v[14:15], s[80:81], s[80:81] op_sel:[0,0,1] op_sel_hi:[1,0,1]
v_pk_fma_f32 v[24:25], v[16:17], s[80:81], s[80:81] op_sel:[0,0,1] op_sel_hi:[1,0,1]
buffer_load_dwordx4 v241, s[48:51], s60 offen offset:1024 lds
v_exp_f32 v18, v18 clamp
v_max_f32 v10, s82, v10
v_exp_f32 v19, v19 clamp
s_add_u32 m0, s62, 53248
s_add_u32 s60, s60, 65536
s_cmp_eq_u32 s60, s1
s_cselect_b32 s60, s0, s60
buffer_load_dwordx4 v240, s[48:51], s60 offen lds
v_max_f32 v11, s82, v11
v_exp_f32 v20, v20 clamp
v_max_f32 v12, s82, v12
buffer_load_dwordx4 v241, s[48:51], s60 offen offset:1024 lds
v_exp_f32 v21, v21 clamp
v_max_f32 v13, s82, v13
v_exp_f32 v22, v22 clamp
s_add_u32 m0, s62, 55296
s_add_u32 s60, s60, 65536
buffer_load_dwordx4 v240, s[48:51], s60 offen lds
v_max_f32 v14, s82, v14
v_exp_f32 v23, v23 clamp
v_max_f32 v15, s82, v15
buffer_load_dwordx4 v241, s[48:51], s60 offen offset:1024 lds
v_exp_f32 v24, v24 clamp
v_max_f32 v16, s82, v16
v_exp_f32 v25, v25 clamp
v_max_f32_e64 v17, s82, v17
v_pk_add_f32 v[10:11], v[10:11], v[18:19]
v_pk_add_f32 v[12:13], v[12:13], v[20:21]
v_pk_add_f32 v[14:15], v[14:15], v[22:23]
v_pk_add_f32 v[16:17], v[16:17], v[24:25]
v_cvt_pk_bf16_f32 v64, v10, v11
v_mov_b64 v[60:61], v[10:11]
v_cvt_pk_bf16_f32 v65, v12, v13
v_mov_b64 v[62:63], v[12:13]
v_cvt_pk_bf16_f32 v66, v14, v15
v_pk_add_f32 v[60:61], v[60:61], v[14:15]
v_cvt_pk_bf16_f32 v67, v16, v17
v_pk_add_f32 v[62:63], v[62:63], v[16:17]
v_pk_fma_f32 v[10:11], v[180:181], v[52:53], s[82:83] op_sel_hi:[1,0,0] neg_lo:[0,1,0] neg_hi:[0,1,0]
v_pk_fma_f32 v[12:13], v[182:183], v[52:53], s[82:83] op_sel_hi:[1,0,0] neg_lo:[0,1,0] neg_hi:[0,1,0]
v_pk_fma_f32 v[14:15], v[188:189], v[52:53], s[82:83] op_sel_hi:[1,0,0] neg_lo:[0,1,0] neg_hi:[0,1,0]
v_pk_fma_f32 v[16:17], v[190:191], v[52:53], s[82:83] op_sel_hi:[1,0,0] neg_lo:[0,1,0] neg_hi:[0,1,0]
v_pk_fma_f32 v[10:11], v[104:105], v[176:177], v[10:11]
v_pk_fma_f32 v[12:13], v[106:107], v[178:179], v[12:13]
v_pk_fma_f32 v[14:15], v[108:109], v[184:185], v[14:15]
v_pk_fma_f32 v[16:17], v[110:111], v[186:187], v[16:17]
v_pk_fma_f32 v[18:19], v[10:11], s[80:81], s[80:81] op_sel:[0,0,1] op_sel_hi:[1,0,1]
v_pk_fma_f32 v[20:21], v[12:13], s[80:81], s[80:81] op_sel:[0,0,1] op_sel_hi:[1,0,1]
v_pk_fma_f32 v[22:23], v[14:15], s[80:81], s[80:81] op_sel:[0,0,1] op_sel_hi:[1,0,1]
v_pk_fma_f32 v[24:25], v[16:17], s[80:81], s[80:81] op_sel:[0,0,1] op_sel_hi:[1,0,1]
v_exp_f32 v18, v18 clamp
v_max_f32 v10, s82, v10
v_exp_f32 v19, v19 clamp
v_max_f32 v11, s82, v11
v_exp_f32 v20, v20 clamp
v_max_f32 v12, s82, v12
v_exp_f32 v21, v21 clamp
v_max_f32 v13, s82, v13
v_exp_f32 v22, v22 clamp
v_max_f32 v14, s82, v14
v_exp_f32 v23, v23 clamp
v_max_f32 v15, s82, v15
v_exp_f32 v24, v24 clamp
v_max_f32 v16, s82, v16
v_exp_f32 v25, v25 clamp
v_max_f32 v17, s82, v17
v_pk_add_f32 v[10:11], v[10:11], v[18:19]
v_pk_add_f32 v[12:13], v[12:13], v[20:21]
v_pk_add_f32 v[14:15], v[14:15], v[22:23]
v_pk_add_f32 v[16:17], v[16:17], v[24:25]
v_cvt_pk_bf16_f32 v68, v10, v11
v_pk_add_f32 v[60:61], v[60:61], v[10:11]
v_cvt_pk_bf16_f32 v69, v12, v13
v_pk_add_f32 v[62:63], v[62:63], v[12:13]
v_cvt_pk_bf16_f32 v70, v14, v15
v_pk_add_f32 v[60:61], v[60:61], v[14:15]
v_cvt_pk_bf16_f32 v71, v16, v17
v_pk_add_f32 v[62:63], v[62:63], v[16:17]
v_pk_fma_f32 v[10:11], v[196:197], v[52:53], s[82:83] op_sel_hi:[1,0,0] neg_lo:[0,1,0] neg_hi:[0,1,0]
v_pk_fma_f32 v[12:13], v[198:199], v[52:53], s[82:83] op_sel_hi:[1,0,0] neg_lo:[0,1,0] neg_hi:[0,1,0]
v_pk_fma_f32 v[14:15], v[204:205], v[52:53], s[82:83] op_sel_hi:[1,0,0] neg_lo:[0,1,0] neg_hi:[0,1,0]
v_pk_fma_f32 v[16:17], v[206:207], v[52:53], s[82:83] op_sel_hi:[1,0,0] neg_lo:[0,1,0] neg_hi:[0,1,0]
v_pk_fma_f32 v[10:11], v[112:113], v[192:193], v[10:11]
v_pk_fma_f32 v[12:13], v[114:115], v[194:195], v[12:13]
v_pk_fma_f32 v[14:15], v[116:117], v[200:201], v[14:15]
v_pk_fma_f32 v[16:17], v[118:119], v[202:203], v[16:17]
v_pk_fma_f32 v[18:19], v[10:11], s[80:81], s[80:81] op_sel:[0,0,1] op_sel_hi:[1,0,1]
v_pk_fma_f32 v[20:21], v[12:13], s[80:81], s[80:81] op_sel:[0,0,1] op_sel_hi:[1,0,1]
v_pk_fma_f32 v[22:23], v[14:15], s[80:81], s[80:81] op_sel:[0,0,1] op_sel_hi:[1,0,1]
v_pk_fma_f32 v[24:25], v[16:17], s[80:81], s[80:81] op_sel:[0,0,1] op_sel_hi:[1,0,1]
v_exp_f32 v18, v18 clamp
v_max_f32 v10, s82, v10
v_exp_f32 v19, v19 clamp
v_max_f32 v11, s82, v11
v_exp_f32 v20, v20 clamp
v_max_f32 v12, s82, v12
v_exp_f32 v21, v21 clamp
v_max_f32 v13, s82, v13
v_exp_f32 v22, v22 clamp
v_max_f32 v14, s82, v14
v_exp_f32 v23, v23 clamp
v_max_f32 v15, s82, v15
v_exp_f32 v24, v24 clamp
v_max_f32 v16, s82, v16
v_exp_f32 v25, v25 clamp
v_max_f32 v17, s82, v17
v_pk_add_f32 v[10:11], v[10:11], v[18:19]
v_pk_add_f32 v[12:13], v[12:13], v[20:21]
v_pk_add_f32 v[14:15], v[14:15], v[22:23]
v_pk_add_f32 v[16:17], v[16:17], v[24:25]
v_cvt_pk_bf16_f32 v72, v10, v11
v_pk_add_f32 v[60:61], v[60:61], v[10:11]
v_cvt_pk_bf16_f32 v73, v12, v13
v_pk_add_f32 v[62:63], v[62:63], v[12:13]
v_cvt_pk_bf16_f32 v74, v14, v15
v_pk_add_f32 v[60:61], v[60:61], v[14:15]
v_cvt_pk_bf16_f32 v75, v16, v17
v_pk_add_f32 v[62:63], v[62:63], v[16:17]
v_pk_fma_f32 v[10:11], v[212:213], v[52:53], s[82:83] op_sel_hi:[1,0,0] neg_lo:[0,1,0] neg_hi:[0,1,0]
v_pk_fma_f32 v[12:13], v[214:215], v[52:53], s[82:83] op_sel_hi:[1,0,0] neg_lo:[0,1,0] neg_hi:[0,1,0]
v_pk_fma_f32 v[14:15], v[220:221], v[52:53], s[82:83] op_sel_hi:[1,0,0] neg_lo:[0,1,0] neg_hi:[0,1,0]
v_pk_fma_f32 v[16:17], v[222:223], v[52:53], s[82:83] op_sel_hi:[1,0,0] neg_lo:[0,1,0] neg_hi:[0,1,0]
v_pk_fma_f32 v[10:11], v[120:121], v[208:209], v[10:11]
v_pk_fma_f32 v[12:13], v[122:123], v[210:211], v[12:13]
v_pk_fma_f32 v[14:15], v[124:125], v[216:217], v[14:15]
v_pk_fma_f32 v[16:17], v[126:127], v[218:219], v[16:17]
v_pk_fma_f32 v[18:19], v[10:11], s[80:81], s[80:81] op_sel:[0,0,1] op_sel_hi:[1,0,1]
v_pk_fma_f32 v[20:21], v[12:13], s[80:81], s[80:81] op_sel:[0,0,1] op_sel_hi:[1,0,1]
v_pk_fma_f32 v[22:23], v[14:15], s[80:81], s[80:81] op_sel:[0,0,1] op_sel_hi:[1,0,1]
v_pk_fma_f32 v[24:25], v[16:17], s[80:81], s[80:81] op_sel:[0,0,1] op_sel_hi:[1,0,1]
v_exp_f32 v18, v18 clamp
v_max_f32 v10, s82, v10
v_exp_f32 v19, v19 clamp
v_max_f32 v11, s82, v11
v_exp_f32 v20, v20 clamp
v_max_f32 v12, s82, v12
v_exp_f32 v21, v21 clamp
v_max_f32 v13, s82, v13
v_exp_f32 v22, v22 clamp
v_max_f32 v14, s82, v14
v_exp_f32 v23, v23 clamp
v_max_f32 v15, s82, v15
v_exp_f32 v24, v24 clamp
v_max_f32 v16, s82, v16
v_exp_f32 v25, v25 clamp
v_max_f32 v17, s82, v17
v_pk_add_f32 v[10:11], v[10:11], v[18:19]
v_pk_add_f32 v[12:13], v[12:13], v[20:21]
v_pk_add_f32 v[14:15], v[14:15], v[22:23]
v_pk_add_f32 v[16:17], v[16:17], v[24:25]
v_cvt_pk_bf16_f32 v76, v10, v11
v_pk_add_f32 v[60:61], v[60:61], v[10:11]
v_cvt_pk_bf16_f32 v77, v12, v13
v_pk_add_f32 v[62:63], v[62:63], v[12:13]
v_cvt_pk_bf16_f32 v78, v14, v15
v_pk_add_f32 v[60:61], v[60:61], v[14:15]
v_cvt_pk_bf16_f32 v79, v16, v17
v_pk_add_f32 v[62:63], v[62:63], v[16:17]
v_pk_mul_f32 v[10:11], v[164:165], v[54:55] op_sel_hi:[1,0] neg_lo:[0,1] neg_hi:[0,1]
v_pk_mul_f32 v[12:13], v[166:167], v[54:55] op_sel_hi:[1,0] neg_lo:[0,1] neg_hi:[0,1]
v_pk_mul_f32 v[14:15], v[172:173], v[54:55] op_sel_hi:[1,0] neg_lo:[0,1] neg_hi:[0,1]
v_pk_mul_f32 v[16:17], v[174:175], v[54:55] op_sel_hi:[1,0] neg_lo:[0,1] neg_hi:[0,1]
v_pk_fma_f32 v[10:11], v[128:129], v[160:161], v[10:11]
v_pk_fma_f32 v[12:13], v[130:131], v[162:163], v[12:13]
v_pk_fma_f32 v[14:15], v[132:133], v[168:169], v[14:15]
v_pk_fma_f32 v[16:17], v[134:135], v[170:171], v[16:17]
v_cvt_pk_bf16_f32 v96, v10, v11
v_cvt_pk_bf16_f32 v97, v12, v13
v_cvt_pk_bf16_f32 v98, v14, v15
v_cvt_pk_bf16_f32 v99, v16, v17
v_pk_mul_f32 v[10:11], v[180:181], v[54:55] op_sel_hi:[1,0] neg_lo:[0,1] neg_hi:[0,1]
v_pk_mul_f32 v[12:13], v[182:183], v[54:55] op_sel_hi:[1,0] neg_lo:[0,1] neg_hi:[0,1]
v_pk_mul_f32 v[14:15], v[188:189], v[54:55] op_sel_hi:[1,0] neg_lo:[0,1] neg_hi:[0,1]
v_pk_mul_f32 v[16:17], v[190:191], v[54:55] op_sel_hi:[1,0] neg_lo:[0,1] neg_hi:[0,1]
v_pk_fma_f32 v[10:11], v[136:137], v[176:177], v[10:11]
v_pk_fma_f32 v[12:13], v[138:139], v[178:179], v[12:13]
v_pk_fma_f32 v[14:15], v[140:141], v[184:185], v[14:15]
v_pk_fma_f32 v[16:17], v[142:143], v[186:187], v[16:17]
v_cvt_pk_bf16_f32 v100, v10, v11
v_cvt_pk_bf16_f32 v101, v12, v13
v_cvt_pk_bf16_f32 v102, v14, v15
v_cvt_pk_bf16_f32 v103, v16, v17
v_pk_mul_f32 v[10:11], v[196:197], v[54:55] op_sel_hi:[1,0] neg_lo:[0,1] neg_hi:[0,1]
v_pk_mul_f32 v[12:13], v[198:199], v[54:55] op_sel_hi:[1,0] neg_lo:[0,1] neg_hi:[0,1]
v_pk_mul_f32 v[14:15], v[204:205], v[54:55] op_sel_hi:[1,0] neg_lo:[0,1] neg_hi:[0,1]
v_pk_mul_f32 v[16:17], v[206:207], v[54:55] op_sel_hi:[1,0] neg_lo:[0,1] neg_hi:[0,1]
v_pk_fma_f32 v[10:11], v[144:145], v[192:193], v[10:11]
v_pk_fma_f32 v[12:13], v[146:147], v[194:195], v[12:13]
v_pk_fma_f32 v[14:15], v[148:149], v[200:201], v[14:15]
v_pk_fma_f32 v[16:17], v[150:151], v[202:203], v[16:17]
v_cvt_pk_bf16_f32 v104, v10, v11
v_cvt_pk_bf16_f32 v105, v12, v13
v_cvt_pk_bf16_f32 v106, v14, v15
v_cvt_pk_bf16_f32 v107, v16, v17
v_pk_mul_f32 v[10:11], v[212:213], v[54:55] op_sel_hi:[1,0] neg_lo:[0,1] neg_hi:[0,1]
v_pk_mul_f32 v[12:13], v[214:215], v[54:55] op_sel_hi:[1,0] neg_lo:[0,1] neg_hi:[0,1]
v_pk_mul_f32 v[14:15], v[220:221], v[54:55] op_sel_hi:[1,0] neg_lo:[0,1] neg_hi:[0,1]
v_pk_mul_f32 v[16:17], v[222:223], v[54:55] op_sel_hi:[1,0] neg_lo:[0,1] neg_hi:[0,1]
v_pk_fma_f32 v[10:11], v[152:153], v[208:209], v[10:11]
v_pk_fma_f32 v[12:13], v[154:155], v[210:211], v[12:13]
v_pk_fma_f32 v[14:15], v[156:157], v[216:217], v[14:15]
v_pk_fma_f32 v[16:17], v[158:159], v[218:219], v[16:17]
v_cvt_pk_bf16_f32 v108, v10, v11
v_cvt_pk_bf16_f32 v109, v12, v13
v_cvt_pk_bf16_f32 v110, v14, v15
v_cvt_pk_bf16_f32 v111, v16, v17
v_pk_add_f32 v[60:61], v[60:61], v[62:63]
v_mfma_f32_32x32x16_bf16 v[128:143], v[64:67], v[96:99], 0
v_mfma_f32_32x32x16_bf16 v[128:143], v[68:71], v[100:103], v[128:143]
v_mfma_f32_32x32x16_bf16 v[128:143], v[72:75], v[104:107], v[128:143]
v_mfma_f32_32x32x16_bf16 v[128:143], v[76:79], v[108:111], v[128:143]
v_add_f32 v60, v60, v61
v_mov_b32 v61, v60
s_nop 1
v_permlane32_swap_b32 v60, v61
v_add_f32 v60, v60, v61
s_mov_b32 exec_hi, 0
buffer_store_dword v60, v29, s[64:67], s72 offen sc1
s_mov_b64 exec, -1
s_nop 3
v_cndmask_b32 v12, v136, v128, s[84:85]
v_cndmask_b32 v13, v137, v129, s[84:85]
v_cndmask_b32 v14, v138, v130, s[84:85]
v_cndmask_b32 v15, v139, v131, s[84:85]
v_cndmask_b32 v16, v140, v132, s[84:85]
v_cndmask_b32 v17, v141, v133, s[84:85]
v_cndmask_b32 v18, v142, v134, s[84:85]
v_cndmask_b32 v19, v143, v135, s[84:85]
s_cmp_eq_u32 s18, 0
s_cbranch_scc0 L_mi1_6
ds_write_b128 v8, v[16:19]
s_branch L_mij_7
L_mi1_6:
ds_write_b128 v8, v[12:15]
s_nop 0
v_mov_b64 v[12:13], v[16:17]
v_mov_b64 v[14:15], v[18:19]
L_mij_7:
s_waitcnt vmcnt(8) lgkmcnt(0)
s_barrier
ds_read_b128 v[16:19], v9
s_waitcnt lgkmcnt(0)
s_nop 0
v_pk_add_f32 v[12:13], v[12:13], v[16:17]
v_pk_add_f32 v[14:15], v[14:15], v[18:19]
buffer_store_dwordx4 v[12:15], v246, s[64:67], s73 offen sc1
ds_read_b64_tr_b16 v[10:11], v234 offset:0
ds_read_b64_tr_b16 v[12:13], v234 offset:512
ds_read_b64_tr_b16 v[14:15], v235 offset:0
ds_read_b64_tr_b16 v[16:17], v235 offset:512
ds_read_b64_tr_b16 v[18:19], v234 offset:4096
ds_read_b64_tr_b16 v[20:21], v234 offset:4608
s_waitcnt lgkmcnt(4)
v_mfma_f32_32x32x16_bf16 v[64:79], v[10:13], a[0:3], 0
ds_read_b64_tr_b16 v[22:23], v235 offset:4096
s_add_u32 m0, s62, 57344
s_add_u32 s60, s60, 65536
s_cmp_eq_u32 s60, s1
s_cselect_b32 s60, s0, s60
buffer_load_dwordx4 v240, s[48:51], s60 offen lds
v_mfma_f32_32x32x16_bf16 v[80:95], v[10:13], a[4:7], 0
ds_read_b64_tr_b16 v[24:25], v235 offset:4608
s_waitcnt lgkmcnt(4)
v_mfma_f32_32x32x16_bf16 v[64:79], v[14:17], a[8:11], v[64:79]
ds_read_b64_tr_b16 v[10:11], v236 offset:0
buffer_load_dwordx4 v241, s[48:51], s60 offen offset:1024 lds
v_mfma_f32_32x32x16_bf16 v[80:95], v[14:17], a[12:15], v[80:95]
ds_read_b64_tr_b16 v[12:13], v236 offset:512
s_waitcnt lgkmcnt(4)
v_mfma_f32_32x32x16_bf16 v[64:79], v[18:21], a[16:19], v[64:79]
ds_read_b64_tr_b16 v[14:15], v237 offset:0
s_add_u32 m0, s62, 59392
s_add_u32 s60, s60, 65536
buffer_load_dwordx4 v240, s[48:51], s60 offen lds
v_mfma_f32_32x32x16_bf16 v[80:95], v[18:21], a[20:23], v[80:95]
ds_read_b64_tr_b16 v[16:17], v237 offset:512
s_waitcnt vmcnt(9)
ds_read_b64_tr_b16 a[0:1], v248 offset:49152
ds_read_b64_tr_b16 a[4:5], v249 offset:49152
ds_read_b64_tr_b16 a[8:9], v250 offset:49152
ds_read_b64_tr_b16 a[12:13], v251 offset:49152
s_waitcnt lgkmcnt(8)
v_mfma_f32_32x32x16_bf16 v[64:79], v[22:25], a[24:27], v[64:79]
ds_read_b64_tr_b16 v[18:19], v236 offset:4096
buffer_load_dwordx4 v241, s[48:51], s60 offen offset:1024 lds
v_mfma_f32_32x32x16_bf16 v[80:95], v[22:25], a[28:31], v[80:95]
ds_read_b64_tr_b16 v[20:21], v236 offset:4608
s_waitcnt lgkmcnt(8)
v_mfma_f32_32x32x16_bf16 v[64:79], v[10:13], a[32:35], v[64:79]
ds_read_b64_tr_b16 v[22:23], v237 offset:4096
s_add_u32 m0, s62, 24576
s_add_u32 s60, s60, 65536
s_cmp_eq_u32 s60, s1
s_cselect_b32 s60, s0, s60
buffer_load_dwordx4 v240, s[48:51], s60 offen lds
v_mfma_f32_32x32x16_bf16 v[80:95], v[10:13], a[36:39], v[80:95]
ds_read_b64_tr_b16 v[24:25], v237 offset:4608
s_waitcnt lgkmcnt(8)
v_mfma_f32_32x32x16_bf16 v[64:79], v[14:17], a[40:43], v[64:79]
ds_read_b64_tr_b16 v[10:11], v234 offset:8192
buffer_load_dwordx4 v241, s[48:51], s60 offen offset:1024 lds
v_mfma_f32_32x32x16_bf16 v[80:95], v[14:17], a[44:47], v[80:95]
ds_read_b64_tr_b16 v[12:13], v234 offset:8704
s_waitcnt lgkmcnt(4)
v_mfma_f32_32x32x16_bf16 v[64:79], v[18:21], a[48:51], v[64:79]
ds_read_b64_tr_b16 v[14:15], v235 offset:8192
s_add_u32 m0, s62, 26624
s_add_u32 s60, s60, 65536
buffer_load_dwordx4 v240, s[48:51], s60 offen lds
v_mfma_f32_32x32x16_bf16 v[80:95], v[18:21], a[52:55], v[80:95]
ds_read_b64_tr_b16 v[16:17], v235 offset:8704
s_waitcnt lgkmcnt(4)
v_mfma_f32_32x32x16_bf16 v[64:79], v[22:25], a[56:59], v[64:79]
ds_read_b64_tr_b16 v[18:19], v234 offset:12288
buffer_load_dwordx4 v241, s[48:51], s60 offen offset:1024 lds
v_mfma_f32_32x32x16_bf16 v[80:95], v[22:25], a[60:63], v[80:95]
ds_read_b64_tr_b16 v[20:21], v234 offset:12800
s_waitcnt vmcnt(12)
ds_read_b64_tr_b16 a[2:3], v248 offset:51200
ds_read_b64_tr_b16 a[6:7], v249 offset:51200
ds_read_b64_tr_b16 a[10:11], v250 offset:51200
ds_read_b64_tr_b16 a[14:15], v251 offset:51200
s_waitcnt lgkmcnt(8)
v_mfma_f32_32x32x16_bf16 v[64:79], v[10:13], a[64:67], v[64:79]
ds_read_b64_tr_b16 v[22:23], v235 offset:12288
s_add_u32 m0, s62, 28672
s_add_u32 s60, s60, 65536
s_cmp_eq_u32 s60, s1
s_cselect_b32 s60, s0, s60
buffer_load_dwordx4 v240, s[48:51], s60 offen lds
v_mfma_f32_32x32x16_bf16 v[80:95], v[10:13], a[68:71], v[80:95]
ds_read_b64_tr_b16 v[24:25], v235 offset:12800
s_waitcnt lgkmcnt(8)
v_mfma_f32_32x32x16_bf16 v[64:79], v[14:17], a[72:75], v[64:79]
ds_read_b64_tr_b16 v[10:11], v236 offset:8192
buffer_load_dwordx4 v241, s[48:51], s60 offen offset:1024 lds
v_mfma_f32_32x32x16_bf16 v[80:95], v[14:17], a[76:79], v[80:95]
ds_read_b64_tr_b16 v[12:13], v236 offset:8704
s_waitcnt vmcnt(10)
s_barrier
s_cmp_lg_u32 s26, 0
s_cbranch_scc1 L_pub_8
s_lshl_b32 s68, s76, 4
s_add_u32 s68, s68, 6922240
v_lshlrev_b32 v3, 11, v2
v_mov_b32 v4, s27
s_mov_b64 exec, 255
buffer_store_dword v4, v3, s[64:67], s68 offen sc1
s_mov_b64 exec, -1
L_pub_8:
s_waitcnt lgkmcnt(8)
v_mfma_f32_32x32x16_bf16 v[64:79], v[18:21], a[80:83], v[64:79]
ds_read_b64_tr_b16 v[14:15], v237 offset:8192
s_add_u32 m0, s16, 0
s_add_u32 s3, s10, 6
s_and_b32 s3, s3, 7
s_mul_i32 s3, s3, 196608
buffer_load_dwordx4 v224, s[32:35], s3 offen offset:0 lds
v_mfma_f32_32x32x16_bf16 v[80:95], v[18:21], a[84:87], v[80:95]
ds_read_b64_tr_b16 v[16:17], v237 offset:8704
buffer_load_dwordx4 v225, s[32:35], s3 offen offset:1024 lds
s_waitcnt lgkmcnt(4)
v_mfma_f32_32x32x16_bf16 v[64:79], v[22:25], a[88:91], v[64:79]
ds_read_b64_tr_b16 v[18:19], v236 offset:12288
s_add_u32 m0, s16, 73728
s_add_u32 s3, s10, 7
s_and_b32 s3, s3, 7
s_mul_i32 s3, s3, 196608
buffer_load_dwordx4 v224, s[32:35], s3 offen offset:0 lds
buffer_load_dword v7, v6, s[64:67], s11 offen sc1
v_mfma_f32_32x32x16_bf16 v[80:95], v[22:25], a[92:95], v[80:95]
ds_read_b64_tr_b16 v[20:21], v236 offset:12800
buffer_load_dwordx4 v225, s[32:35], s3 offen offset:1024 lds
s_waitcnt lgkmcnt(4)
v_mfma_f32_32x32x16_bf16 v[64:79], v[10:13], a[96:99], v[64:79]
ds_read_b64_tr_b16 v[22:23], v237 offset:12288
s_add_u32 m0, s62, 30720
s_add_u32 s60, s60, 65536
buffer_load_dwordx4 v240, s[48:51], s60 offen lds
v_mfma_f32_32x32x16_bf16 v[80:95], v[10:13], a[100:103], v[80:95]
ds_read_b64_tr_b16 v[24:25], v237 offset:12800
ds_read_b64_tr_b16 a[16:17], v248 offset:53248
ds_read_b64_tr_b16 a[20:21], v249 offset:53248
ds_read_b64_tr_b16 a[24:25], v250 offset:53248
ds_read_b64_tr_b16 a[28:29], v251 offset:53248
s_waitcnt lgkmcnt(8)
v_mfma_f32_32x32x16_bf16 v[64:79], v[14:17], a[104:107], v[64:79]
ds_read_b64_tr_b16 v[10:11], v234 offset:16384
buffer_load_dwordx4 v241, s[48:51], s60 offen offset:1024 lds
v_mfma_f32_32x32x16_bf16 v[80:95], v[14:17], a[108:111], v[80:95]
ds_read_b64_tr_b16 v[12:13], v234 offset:16896
s_waitcnt lgkmcnt(8)
v_mfma_f32_32x32x16_bf16 v[64:79], v[18:21], a[112:115], v[64:79]
ds_read_b64_tr_b16 v[14:15], v235 offset:16384
s_add_u32 m0, s62, 32768
s_add_u32 s60, s60, 65536
s_cmp_eq_u32 s60, s1
s_cselect_b32 s60, s0, s60
buffer_load_dwordx4 v240, s[48:51], s60 offen lds
v_mfma_f32_32x32x16_bf16 v[80:95], v[18:21], a[116:119], v[80:95]
ds_read_b64_tr_b16 v[16:17], v235 offset:16896
s_waitcnt lgkmcnt(8)
v_mfma_f32_32x32x16_bf16 v[64:79], v[22:25], a[120:123], v[64:79]
ds_read_b64_tr_b16 v[18:19], v234 offset:20480
buffer_load_dwordx4 v241, s[48:51], s60 offen offset:1024 lds
v_mfma_f32_32x32x16_bf16 v[80:95], v[22:25], a[124:127], v[80:95]
ds_read_b64_tr_b16 v[20:21], v234 offset:20992
s_waitcnt lgkmcnt(4)
v_mfma_f32_32x32x16_bf16 v[64:79], v[10:13], a[128:131], v[64:79]
ds_read_b64_tr_b16 v[22:23], v235 offset:20480
s_add_u32 m0, s62, 34816
s_add_u32 s60, s60, 65536
buffer_load_dwordx4 v240, s[48:51], s60 offen lds
v_mfma_f32_32x32x16_bf16 v[80:95], v[10:13], a[132:135], v[80:95]
ds_read_b64_tr_b16 v[24:25], v235 offset:20992
s_waitcnt lgkmcnt(4)
v_mfma_f32_32x32x16_bf16 v[64:79], v[14:17], a[136:139], v[64:79]
ds_read_b64_tr_b16 v[10:11], v236 offset:16384
buffer_load_dwordx4 v241, s[48:51], s60 offen offset:1024 lds
v_mfma_f32_32x32x16_bf16 v[80:95], v[14:17], a[140:143], v[80:95]
ds_read_b64_tr_b16 v[12:13], v236 offset:16896
ds_read_b64_tr_b16 a[18:19], v248 offset:55296
ds_read_b64_tr_b16 a[22:23], v249 offset:55296
ds_read_b64_tr_b16 a[26:27], v250 offset:55296
ds_read_b64_tr_b16 a[30:31], v251 offset:55296
s_waitcnt lgkmcnt(8)
v_mfma_f32_32x32x16_bf16 v[64:79], v[18:21], a[144:147], v[64:79]
ds_read_b64_tr_b16 v[14:15], v237 offset:16384
s_add_u32 m0, s62, 49152
s_add_u32 s60, s60, 65536
s_cmp_eq_u32 s60, s1
s_cselect_b32 s60, s0, s60
buffer_load_dwordx4 v240, s[48:51], s60 offen lds
v_mfma_f32_32x32x16_bf16 v[80:95], v[18:21], a[148:151], v[80:95]
ds_read_b64_tr_b16 v[16:17], v237 offset:16896
s_mov_b32 s25, 0
s_waitcnt vmcnt(8)
L_poll_9:
v_cmp_ne_u32 vcc, s27, v7
s_cbranch_vccz L_polld_10
s_add_u32 s25, s25, 1
s_cmp_lt_u32 s25, 262144
s_cbranch_scc0 L_polld_10
s_sleep 1
buffer_load_dword v7, v6, s[64:67], s11 offen sc1
s_waitcnt vmcnt(0)
s_branch L_poll_9
L_polld_10:
s_waitcnt lgkmcnt(8)
v_mfma_f32_32x32x16_bf16 v[64:79], v[22:25], a[152:155], v[64:79]
ds_read_b64_tr_b16 v[18:19], v236 offset:20480
buffer_load_dwordx4 v241, s[48:51], s60 offen offset:1024 lds
buffer_load_dwordx4 v[40:43], v53, s[64:67], s86 offen offset:32 sc1
buffer_load_dwordx4 v[48:51], v53, s[64:67], s86 offen offset:96 sc1
v_mfma_f32_32x32x16_bf16 v[80:95], v[22:25], a[156:159], v[80:95]
ds_read_b64_tr_b16 v[20:21], v236 offset:20992
buffer_load_dwordx4 v[36:39], v53, s[64:67], s86 offen offset:0 sc1
buffer_load_dwordx4 v[44:47], v53, s[64:67], s86 offen offset:64 sc1
s_waitcnt lgkmcnt(8)
v_mfma_f32_32x32x16_bf16 v[64:79], v[10:13], a[160:163], v[64:79]
ds_read_b64_tr_b16 v[22:23], v237 offset:20480
s_add_u32 m0, s62, 51200
s_add_u32 s60, s60, 65536
buffer_load_dwordx4 v240, s[48:51], s60 offen lds
v_mfma_f32_32x32x16_bf16 v[80:95], v[10:13], a[164:167], v[80:95]
ds_read_b64_tr_b16 v[24:25], v237 offset:20992
s_waitcnt vmcnt(13)
s_barrier
s_waitcnt lgkmcnt(4)
v_mfma_f32_32x32x16_bf16 v[64:79], v[14:17], a[168:171], v[64:79]
ds_read_b64_tr_b16 v[10:11], v234 offset:0
buffer_load_dwordx4 v241, s[48:51], s60 offen offset:1024 lds
v_mfma_f32_32x32x16_bf16 v[80:95], v[14:17], a[172:175], v[80:95]
ds_read_b64_tr_b16 v[12:13], v234 offset:512
s_waitcnt lgkmcnt(4)
v_mfma_f32_32x32x16_bf16 v[64:79], v[18:21], a[176:179], v[64:79]
ds_read_b64_tr_b16 v[14:15], v235 offset:0
s_add_u32 m0, s62, 53248
s_add_u32 s60, s60, 65536
s_cmp_eq_u32 s60, s1
s_cselect_b32 s60, s0, s60
buffer_load_dwordx4 v240, s[48:51], s60 offen lds
v_mfma_f32_32x32x16_bf16 v[80:95], v[18:21], a[180:183], v[80:95]
ds_read_b64_tr_b16 v[16:17], v235 offset:512
ds_read_b64_tr_b16 a[32:33], v248 offset:57344
ds_read_b64_tr_b16 a[36:37], v249 offset:57344
ds_read_b64_tr_b16 a[40:41], v250 offset:57344
ds_read_b64_tr_b16 a[44:45], v251 offset:57344
s_waitcnt lgkmcnt(8)
v_mfma_f32_32x32x16_bf16 v[64:79], v[22:25], a[184:187], v[64:79]
ds_read_b64_tr_b16 v[18:19], v234 offset:4096
buffer_load_dwordx4 v241, s[48:51], s60 offen offset:1024 lds
v_mfma_f32_32x32x16_bf16 v[80:95], v[22:25], a[188:191], v[80:95]
ds_read_b64_tr_b16 v[20:21], v234 offset:4608
s_waitcnt lgkmcnt(8)
v_mfma_f32_32x32x16_bf16 v[64:79], v[10:13], a[192:195], v[64:79]
ds_read_b64_tr_b16 v[22:23], v235 offset:4096
s_add_u32 m0, s62, 55296
s_add_u32 s60, s60, 65536
buffer_load_dwordx4 v240, s[48:51], s60 offen lds
v_mfma_f32_32x32x16_bf16 v[80:95], v[10:13], a[196:199], v[80:95]
ds_read_b64_tr_b16 v[24:25], v235 offset:4608
s_lshl_b32 s24, s78, 4
s_add_u32 s24, s24, 6922240
s_add_u32 s24, s24, s11
v_min_u32 v32, 15, v2
v_lshlrev_b32 v32, 4, v32
buffer_load_dword v33, v32, s[64:67], s24 offen sc1
s_waitcnt lgkmcnt(8)
v_mfma_f32_32x32x16_bf16 v[64:79], v[14:17], a[200:203], v[64:79]
ds_read_b64_tr_b16 v[10:11], v236 offset:0
buffer_load_dwordx4 v241, s[48:51], s60 offen offset:1024 lds
v_mfma_f32_32x32x16_bf16 v[80:95], v[14:17], a[204:207], v[80:95]
ds_read_b64_tr_b16 v[12:13], v236 offset:512
s_waitcnt lgkmcnt(4)
v_mfma_f32_32x32x16_bf16 v[64:79], v[18:21], a[208:211], v[64:79]
ds_read_b64_tr_b16 v[14:15], v237 offset:0
s_add_u32 m0, s62, 57344
s_add_u32 s61, s83, 0
s_and_b32 s61, s61, 7
s_lshl3_add_u32 s61, s26, s61
s_lshl_b32 s61, s61, 14
buffer_load_dwordx4 v242, s[36:39], s61 offen lds
v_mfma_f32_32x32x16_bf16 v[80:95], v[18:21], a[212:215], v[80:95]
ds_read_b64_tr_b16 v[16:17], v237 offset:512
s_waitcnt lgkmcnt(4)
v_mfma_f32_32x32x16_bf16 v[64:79], v[22:25], a[216:219], v[64:79]
ds_read_b64_tr_b16 v[18:19], v236 offset:4096
buffer_load_dwordx4 v243, s[36:39], s61 offen offset:1024 lds
v_mfma_f32_32x32x16_bf16 v[80:95], v[22:25], a[220:223], v[80:95]
ds_read_b64_tr_b16 v[20:21], v236 offset:4608
ds_read_b64_tr_b16 a[34:35], v248 offset:59392
ds_read_b64_tr_b16 a[38:39], v249 offset:59392
ds_read_b64_tr_b16 a[42:43], v250 offset:59392
ds_read_b64_tr_b16 a[46:47], v251 offset:59392
s_waitcnt lgkmcnt(8)
v_mfma_f32_32x32x16_bf16 v[64:79], v[10:13], a[224:227], v[64:79]
ds_read_b64_tr_b16 v[22:23], v237 offset:4096
s_waitcnt lgkmcnt(1)
s_add_u32 m0, s62, 59392
s_add_u32 s61, s83, 1
s_and_b32 s61, s61, 7
s_lshl3_add_u32 s61, s26, s61
s_lshl_b32 s61, s61, 14
buffer_load_dwordx4 v242, s[36:39], s61 offen lds
v_mfma_f32_32x32x16_bf16 v[80:95], v[10:13], a[228:231], v[80:95]
ds_read_b64_tr_b16 v[24:25], v237 offset:4608
v_mfma_f32_32x32x16_bf16 v[64:79], v[14:17], a[232:235], v[64:79]
buffer_load_dwordx4 v243, s[36:39], s61 offen offset:1024 lds
v_mfma_f32_32x32x16_bf16 v[80:95], v[14:17], a[236:239], v[80:95]
ds_read_b64_tr_b16 a[48:49], v248 offset:24576
ds_read_b64_tr_b16 a[52:53], v249 offset:24576
ds_read_b64_tr_b16 a[56:57], v250 offset:24576
ds_read_b64_tr_b16 a[60:61], v251 offset:24576
v_mfma_f32_32x32x16_bf16 v[64:79], v[18:21], a[240:243], v[64:79]
s_waitcnt lgkmcnt(0)
s_add_u32 m0, s62, 24576
s_add_u32 s61, s83, 2
s_and_b32 s61, s61, 7
s_lshl3_add_u32 s61, s26, s61
s_lshl_b32 s61, s61, 14
buffer_load_dwordx4 v242, s[36:39], s61 offen lds
v_mfma_f32_32x32x16_bf16 v[80:95], v[18:21], a[244:247], v[80:95]
ds_read_b64_tr_b16 a[50:51], v248 offset:26624
ds_read_b64_tr_b16 a[54:55], v249 offset:26624
ds_read_b64_tr_b16 a[58:59], v250 offset:26624
ds_read_b64_tr_b16 a[62:63], v251 offset:26624
v_mfma_f32_32x32x16_bf16 v[64:79], v[22:25], a[248:251], v[64:79]
buffer_load_dwordx4 v243, s[36:39], s61 offen offset:1024 lds
v_mfma_f32_32x32x16_bf16 v[80:95], v[22:25], a[252:255], v[80:95]
ds_read_b64_tr_b16 a[64:65], v248 offset:28672
ds_read_b64_tr_b16 a[68:69], v249 offset:28672
ds_read_b64_tr_b16 a[72:73], v250 offset:28672
ds_read_b64_tr_b16 a[76:77], v251 offset:28672
s_waitcnt lgkmcnt(0)
s_barrier
v_lshrrev_b32 v3, 9, v247
v_and_b32 v3, 0xffe, v3
v_add_u32 v4, 8192, v247
buffer_load_dwordx4 a[240:243], v247, s[28:31], 0 offen
buffer_load_dwordx4 a[244:247], v4, s[28:31], 0 offen
buffer_load_ushort v0, v3, s[52:55], 0 offen
buffer_load_ushort v1, v3, s[52:55], 0 offen offset:16
s_mov_b32 s25, 0
s_waitcnt vmcnt(11)
L_poll_11:
v_cmp_ne_u32 vcc, s27, v33
s_cbranch_vccz L_polld_12
s_add_u32 s25, s25, 1
s_cmp_lt_u32 s25, 262144
s_cbranch_scc0 L_polld_12
s_sleep 1
buffer_load_dword v33, v32, s[64:67], s24 offen sc1
s_waitcnt vmcnt(0)
s_branch L_poll_11
L_polld_12:
buffer_load_dwordx4 v[176:179], v246, s[64:67], s20 offen offset:0 sc1
buffer_load_dwordx4 v[180:183], v246, s[64:67], s20 offen offset:1024 sc1
buffer_load_dwordx4 v[184:187], v246, s[64:67], s20 offen offset:2048 sc1
buffer_load_dwordx4 v[188:191], v246, s[64:67], s20 offen offset:3072 sc1
v_pk_fma_f32 v[10:11], v[36:37], v[56:57], s[82:83] op_sel:[0,1,0] op_sel_hi:[1,1,0] neg_lo:[0,1,0] neg_hi:[0,1,0]
v_pk_fma_f32 v[12:13], v[38:39], v[56:57], s[82:83] op_sel:[0,1,0] op_sel_hi:[1,1,0] neg_lo:[0,1,0] neg_hi:[0,1,0]
v_pk_fma_f32 v[14:15], v[40:41], v[56:57], s[82:83] op_sel:[0,1,0] op_sel_hi:[1,1,0] neg_lo:[0,1,0] neg_hi:[0,1,0]
v_pk_fma_f32 v[16:17], v[42:43], v[56:57], s[82:83] op_sel:[0,1,0] op_sel_hi:[1,1,0] neg_lo:[0,1,0] neg_hi:[0,1,0]
v_pk_fma_f32 v[10:11], v[64:65], v[56:57], v[10:11] op_sel_hi:[1,0,1]
v_pk_fma_f32 v[12:13], v[66:67], v[56:57], v[12:13] op_sel_hi:[1,0,1]
buffer_load_dwordx4 v[96:99], v246, s[64:67], s21 offen sc1
s_add_u32 s21, s21, 4096
v_pk_fma_f32 v[14:15], v[68:69], v[56:57], v[14:15] op_sel_hi:[1,0,1]
v_pk_fma_f32 v[16:17], v[70:71], v[56:57], v[16:17] op_sel_hi:[1,0,1]
v_pk_fma_f32 v[18:19], v[10:11], s[80:81], s[80:81] op_sel:[0,0,1] op_sel_hi:[1,0,1]
v_pk_fma_f32 v[20:21], v[12:13], s[80:81], s[80:81] op_sel:[0,0,1] op_sel_hi:[1,0,1]
v_pk_fma_f32 v[22:23], v[14:15], s[80:81], s[80:81] op_sel:[0,0,1] op_sel_hi:[1,0,1]
v_pk_fma_f32 v[24:25], v[16:17], s[80:81], s[80:81] op_sel:[0,0,1] op_sel_hi:[1,0,1]
buffer_load_dwordx4 v[100:103], v246, s[64:67], s21 offen sc1
s_add_u32 s21, s21, 4096
v_exp_f32 v18, v18 clamp
v_max_f32 v10, s82, v10
v_exp_f32 v19, v19 clamp
v_max_f32 v11, s82, v11
v_exp_f32 v20, v20 clamp
v_max_f32 v12, s82, v12
buffer_load_dwordx4 v[104:107], v246, s[64:67], s21 offen sc1
s_add_u32 s21, s21, 4096
v_exp_f32 v21, v21 clamp
v_max_f32 v13, s82, v13
v_exp_f32 v22, v22 clamp
v_max_f32 v14, s82, v14
v_exp_f32 v23, v23 clamp
v_max_f32 v15, s82, v15
buffer_load_dwordx4 v[108:111], v246, s[64:67], s21 offen sc1
s_add_u32 s21, s21, 4096
v_exp_f32 v24, v24 clamp
v_max_f32 v16, s82, v16
v_exp_f32 v25, v25 clamp
v_max_f32_e64 v17, s82, v17
v_pk_add_f32 v[10:11], v[10:11], v[18:19]
v_pk_add_f32 v[12:13], v[12:13], v[20:21]
buffer_load_dwordx4 v[112:115], v246, s[64:67], s21 offen sc1
s_add_u32 s21, s21, 4096
v_pk_add_f32 v[14:15], v[14:15], v[22:23]
v_pk_add_f32 v[16:17], v[16:17], v[24:25]
v_cvt_pk_bf16_f32 v160, v10, v11
v_cvt_pk_bf16_f32 v161, v12, v13
v_cvt_pk_bf16_f32 v162, v14, v15
v_cvt_pk_bf16_f32 v163, v16, v17
buffer_load_dwordx4 v[116:119], v246, s[64:67], s21 offen sc1
s_add_u32 s21, s21, 4096
v_pk_fma_f32 v[10:11], v[44:45], v[56:57], s[82:83] op_sel:[0,1,0] op_sel_hi:[1,1,0] neg_lo:[0,1,0] neg_hi:[0,1,0]
v_pk_fma_f32 v[12:13], v[46:47], v[56:57], s[82:83] op_sel:[0,1,0] op_sel_hi:[1,1,0] neg_lo:[0,1,0] neg_hi:[0,1,0]
v_pk_fma_f32 v[14:15], v[48:49], v[56:57], s[82:83] op_sel:[0,1,0] op_sel_hi:[1,1,0] neg_lo:[0,1,0] neg_hi:[0,1,0]
v_pk_fma_f32 v[16:17], v[50:51], v[56:57], s[82:83] op_sel:[0,1,0] op_sel_hi:[1,1,0] neg_lo:[0,1,0] neg_hi:[0,1,0]
v_pk_fma_f32 v[10:11], v[72:73], v[56:57], v[10:11] op_sel_hi:[1,0,1]
v_pk_fma_f32 v[12:13], v[74:75], v[56:57], v[12:13] op_sel_hi:[1,0,1]
buffer_load_dwordx4 v[120:123], v246, s[64:67], s21 offen sc1
s_add_u32 s21, s21, 4096
v_pk_fma_f32 v[14:15], v[76:77], v[56:57], v[14:15] op_sel_hi:[1,0,1]
v_pk_fma_f32 v[16:17], v[78:79], v[56:57], v[16:17] op_sel_hi:[1,0,1]
v_pk_fma_f32 v[18:19], v[10:11], s[80:81], s[80:81] op_sel:[0,0,1] op_sel_hi:[1,0,1]
v_pk_fma_f32 v[20:21], v[12:13], s[80:81], s[80:81] op_sel:[0,0,1] op_sel_hi:[1,0,1]
v_pk_fma_f32 v[22:23], v[14:15], s[80:81], s[80:81] op_sel:[0,0,1] op_sel_hi:[1,0,1]
v_pk_fma_f32 v[24:25], v[16:17], s[80:81], s[80:81] op_sel:[0,0,1] op_sel_hi:[1,0,1]
buffer_load_dwordx4 v[124:127], v246, s[64:67], s21 offen sc1
s_add_u32 s21, s21, 4096
v_exp_f32 v18, v18 clamp
v_max_f32 v10, s82, v10
v_exp_f32 v19, v19 clamp
v_max_f32 v11, s82, v11
v_exp_f32 v20, v20 clamp
v_max_f32 v12, s82, v12
buffer_load_dwordx4 v[128:131], v246, s[64:67], s21 offen sc1
s_add_u32 s21, s21, 4096
v_exp_f32 v21, v21 clamp
v_max_f32 v13, s82, v13
v_exp_f32 v22, v22 clamp
v_max_f32 v14, s82, v14
v_exp_f32 v23, v23 clamp
v_max_f32 v15, s82, v15
buffer_load_dwordx4 v[132:135], v246, s[64:67], s21 offen sc1
s_add_u32 s21, s21, 4096
v_exp_f32 v24, v24 clamp
v_max_f32 v16, s82, v16
v_exp_f32 v25, v25 clamp
v_max_f32 v17, s82, v17
v_pk_add_f32 v[10:11], v[10:11], v[18:19]
v_pk_add_f32 v[12:13], v[12:13], v[20:21]
buffer_load_dwordx4 v[136:139], v246, s[64:67], s21 offen sc1
s_add_u32 s21, s21, 4096
v_pk_add_f32 v[14:15], v[14:15], v[22:23]
v_pk_add_f32 v[16:17], v[16:17], v[24:25]
v_cvt_pk_bf16_f32 v164, v10, v11
v_cvt_pk_bf16_f32 v165, v12, v13
v_cvt_pk_bf16_f32 v166, v14, v15
v_cvt_pk_bf16_f32 v167, v16, v17
buffer_load_dwordx4 v[140:143], v246, s[64:67], s21 offen sc1
s_add_u32 s21, s21, 4096
v_pk_fma_f32 v[10:11], v[36:37], v[58:59], s[82:83] op_sel:[0,1,0] op_sel_hi:[1,1,0] neg_lo:[0,1,0] neg_hi:[0,1,0]
v_pk_fma_f32 v[12:13], v[38:39], v[58:59], s[82:83] op_sel:[0,1,0] op_sel_hi:[1,1,0] neg_lo:[0,1,0] neg_hi:[0,1,0]
v_pk_fma_f32 v[14:15], v[40:41], v[58:59], s[82:83] op_sel:[0,1,0] op_sel_hi:[1,1,0] neg_lo:[0,1,0] neg_hi:[0,1,0]
v_pk_fma_f32 v[16:17], v[42:43], v[58:59], s[82:83] op_sel:[0,1,0] op_sel_hi:[1,1,0] neg_lo:[0,1,0] neg_hi:[0,1,0]
v_pk_fma_f32 v[10:11], v[80:81], v[58:59], v[10:11] op_sel_hi:[1,0,1]
v_pk_fma_f32 v[12:13], v[82:83], v[58:59], v[12:13] op_sel_hi:[1,0,1]
buffer_load_dwordx4 v[144:147], v246, s[64:67], s21 offen sc1
s_add_u32 s21, s21, 4096
v_pk_fma_f32 v[14:15], v[84:85], v[58:59], v[14:15] op_sel_hi:[1,0,1]
v_pk_fma_f32 v[16:17], v[86:87], v[58:59], v[16:17] op_sel_hi:[1,0,1]
v_pk_fma_f32 v[18:19], v[10:11], s[80:81], s[80:81] op_sel:[0,0,1] op_sel_hi:[1,0,1]
v_pk_fma_f32 v[20:21], v[12:13], s[80:81], s[80:81] op_sel:[0,0,1] op_sel_hi:[1,0,1]
v_pk_fma_f32 v[22:23], v[14:15], s[80:81], s[80:81] op_sel:[0,0,1] op_sel_hi:[1,0,1]
v_pk_fma_f32 v[24:25], v[16:17], s[80:81], s[80:81] op_sel:[0,0,1] op_sel_hi:[1,0,1]
buffer_load_dwordx4 v[148:151], v246, s[64:67], s21 offen sc1
s_add_u32 s21, s21, 4096
v_exp_f32 v18, v18 clamp
v_max_f32 v10, s82, v10
v_exp_f32 v19, v19 clamp
v_max_f32 v11, s82, v11
v_exp_f32 v20, v20 clamp
v_max_f32 v12, s82, v12
buffer_load_dwordx4 v[152:155], v246, s[64:67], s21 offen sc1
s_add_u32 s21, s21, 4096
v_exp_f32 v21, v21 clamp
v_max_f32 v13, s82, v13
v_exp_f32 v22, v22 clamp
v_max_f32 v14, s82, v14
v_exp_f32 v23, v23 clamp
v_max_f32 v15, s82, v15
buffer_load_dwordx4 v[156:159], v246, s[64:67], s21 offen sc1
s_add_u32 s21, s21, 4096
v_exp_f32 v24, v24 clamp
v_max_f32 v16, s82, v16
v_exp_f32 v25, v25 clamp
v_max_f32 v17, s82, v17
v_pk_add_f32 v[10:11], v[10:11], v[18:19]
v_pk_add_f32 v[12:13], v[12:13], v[20:21]
v_pk_add_f32 v[14:15], v[14:15], v[22:23]
v_pk_add_f32 v[16:17], v[16:17], v[24:25]
v_cvt_pk_bf16_f32 v168, v10, v11
v_cvt_pk_bf16_f32 v169, v12, v13
v_cvt_pk_bf16_f32 v170, v14, v15
v_cvt_pk_bf16_f32 v171, v16, v17
v_pk_fma_f32 v[10:11], v[44:45], v[58:59], s[82:83] op_sel:[0,1,0] op_sel_hi:[1,1,0] neg_lo:[0,1,0] neg_hi:[0,1,0]
v_pk_fma_f32 v[12:13], v[46:47], v[58:59], s[82:83] op_sel:[0,1,0] op_sel_hi:[1,1,0] neg_lo:[0,1,0] neg_hi:[0,1,0]
v_pk_fma_f32 v[14:15], v[48:49], v[58:59], s[82:83] op_sel:[0,1,0] op_sel_hi:[1,1,0] neg_lo:[0,1,0] neg_hi:[0,1,0]
v_pk_fma_f32 v[16:17], v[50:51], v[58:59], s[82:83] op_sel:[0,1,0] op_sel_hi:[1,1,0] neg_lo:[0,1,0] neg_hi:[0,1,0]
v_pk_fma_f32 v[10:11], v[88:89], v[58:59], v[10:11] op_sel_hi:[1,0,1]
v_pk_fma_f32 v[12:13], v[90:91], v[58:59], v[12:13] op_sel_hi:[1,0,1]
v_pk_fma_f32 v[14:15], v[92:93], v[58:59], v[14:15] op_sel_hi:[1,0,1]
v_pk_fma_f32 v[16:17], v[94:95], v[58:59], v[16:17] op_sel_hi:[1,0,1]
v_pk_fma_f32 v[18:19], v[10:11], s[80:81], s[80:81] op_sel:[0,0,1] op_sel_hi:[1,0,1]
v_pk_fma_f32 v[20:21], v[12:13], s[80:81], s[80:81] op_sel:[0,0,1] op_sel_hi:[1,0,1]
v_pk_fma_f32 v[22:23], v[14:15], s[80:81], s[80:81] op_sel:[0,0,1] op_sel_hi:[1,0,1]
v_pk_fma_f32 v[24:25], v[16:17], s[80:81], s[80:81] op_sel:[0,0,1] op_sel_hi:[1,0,1]
v_exp_f32 v18, v18 clamp
v_max_f32 v10, s82, v10
v_exp_f32 v19, v19 clamp
v_max_f32 v11, s82, v11
v_exp_f32 v20, v20 clamp
v_max_f32 v12, s82, v12
v_exp_f32 v21, v21 clamp
v_max_f32 v13, s82, v13
v_exp_f32 v22, v22 clamp
v_max_f32 v14, s82, v14
v_exp_f32 v23, v23 clamp
v_max_f32 v15, s82, v15
v_exp_f32 v24, v24 clamp
v_max_f32 v16, s82, v16
v_exp_f32 v25, v25 clamp
v_max_f32 v17, s82, v17
v_pk_add_f32 v[10:11], v[10:11], v[18:19]
v_pk_add_f32 v[12:13], v[12:13], v[20:21]
v_pk_add_f32 v[14:15], v[14:15], v[22:23]
v_pk_add_f32 v[16:17], v[16:17], v[24:25]
v_cvt_pk_bf16_f32 v172, v10, v11
v_cvt_pk_bf16_f32 v173, v12, v13
v_cvt_pk_bf16_f32 v174, v14, v15
v_cvt_pk_bf16_f32 v175, v16, v17
v_lshlrev_b32 v4, 4, v2
s_waitcnt vmcnt(16)
v_pk_add_f32 v[176:177], v[176:177], v[180:181]
v_pk_add_f32 v[184:185], v[184:185], v[188:189]
v_pk_add_f32 v[178:179], v[178:179], v[182:183]
v_pk_add_f32 v[186:187], v[186:187], v[190:191]
v_pk_add_f32 v[176:177], v[176:177], v[184:185]
s_add_u32 m0, s62, 26624
s_add_u32 s61, s83, 3
s_and_b32 s61, s61, 7
s_lshl3_add_u32 s61, s26, s61
s_lshl_b32 s61, s61, 14
buffer_load_dwordx4 v242, s[36:39], s61 offen lds
v_pk_add_f32 v[178:179], v[178:179], v[186:187]
s_nop 1
v_add_f32_dpp v176, v176, v176 row_ror:8 row_mask:0xf bank_mask:0xf
v_add_f32_dpp v177, v177, v177 row_ror:8 row_mask:0xf bank_mask:0xf
v_add_f32_dpp v178, v178, v178 row_ror:8 row_mask:0xf bank_mask:0xf
v_add_f32_dpp v179, v179, v179 row_ror:8 row_mask:0xf bank_mask:0xf
v_mov_b32 v180, v176
buffer_load_dwordx4 v243, s[36:39], s61 offen offset:1024 lds
v_mov_b32 v181, v177
v_mov_b32 v182, v178
v_mov_b32 v183, v179
s_nop 0
v_permlane16_swap_b32 v176, v180
v_permlane16_swap_b32 v177, v181
v_permlane16_swap_b32 v178, v182
s_add_u32 m0, s62, 28672
s_add_u32 s61, s83, 4
s_and_b32 s61, s61, 7
s_lshl3_add_u32 s61, s26, s61
s_lshl_b32 s61, s61, 14
buffer_load_dwordx4 v242, s[36:39], s61 offen lds
v_permlane16_swap_b32 v179, v183
v_add_f32 v176, v176, v180
v_add_f32 v177, v177, v181
v_add_f32 v178, v178, v182
v_add_f32 v179, v179, v183
v_mov_b32 v180, v176
buffer_load_dwordx4 v243, s[36:39], s61 offen offset:1024 lds
v_mov_b32 v181, v177
v_mov_b32 v182, v178
v_mov_b32 v183, v179
s_nop 0
v_permlane32_swap_b32 v176, v180
v_permlane32_swap_b32 v177, v181
v_permlane32_swap_b32 v178, v182
v_permlane32_swap_b32 v179, v183
v_add_f32 v176, v176, v180
v_add_f32 v177, v177, v181
v_add_f32 v178, v178, v182
v_add_f32 v179, v179, v183
s_lshl_b32 s70, s26, 10
s_add_u32 s70, s70, 147456
v_add_u32 v5, s70, v4
s_mov_b64 exec, 0xff
ds_write_b128 v5, v[176:179]
s_mov_b64 exec, -1
s_waitcnt lgkmcnt(0)
ds_read_b128 v[180:183], v30 offset:0
ds_read_b128 v[184:187], v30 offset:32
ds_read_b128 v[188:191], v30 offset:64
ds_read_b128 v[192:195], v30 offset:96
s_waitcnt vmcnt(16)
v_pk_add_f32 v[96:97], v[96:97], v[100:101]
v_pk_add_f32 v[104:105], v[104:105], v[108:109]
v_pk_add_f32 v[98:99], v[98:99], v[102:103]
v_pk_add_f32 v[106:107], v[106:107], v[110:111]
v_pk_add_f32 v[96:97], v[96:97], v[104:105]
v_pk_add_f32 v[98:99], v[98:99], v[106:107]
s_waitcnt vmcnt(12)
v_pk_add_f32 v[112:113], v[112:113], v[116:117]
v_pk_add_f32 v[120:121], v[120:121], v[124:125]
v_pk_add_f32 v[114:115], v[114:115], v[118:119]
v_pk_add_f32 v[122:123], v[122:123], v[126:127]
v_pk_add_f32 v[112:113], v[112:113], v[120:121]
v_pk_add_f32 v[114:115], v[114:115], v[122:123]
s_waitcnt vmcnt(8)
v_pk_add_f32 v[128:129], v[128:129], v[132:133]
v_pk_add_f32 v[136:137], v[136:137], v[140:141]
v_pk_add_f32 v[130:131], v[130:131], v[134:135]
v_pk_add_f32 v[138:139], v[138:139], v[142:143]
v_pk_add_f32 v[128:129], v[128:129], v[136:137]
v_pk_add_f32 v[130:131], v[130:131], v[138:139]
s_waitcnt vmcnt(4)
s_nop 0
v_pk_add_f32 v[144:145], v[144:145], v[148:149]
v_pk_add_f32 v[152:153], v[152:153], v[156:157]
v_pk_add_f32 v[146:147], v[146:147], v[150:151]
v_pk_add_f32 v[154:155], v[154:155], v[158:159]
v_pk_add_f32 v[144:145], v[144:145], v[152:153]
v_pk_add_f32 v[146:147], v[146:147], v[154:155]
v_pk_add_f32 v[96:97], v[96:97], v[112:113]
v_pk_add_f32 v[128:129], v[128:129], v[144:145]
v_pk_add_f32 v[98:99], v[98:99], v[114:115]
v_pk_add_f32 v[130:131], v[130:131], v[146:147]
v_pk_add_f32 v[96:97], v[96:97], v[128:129]
v_pk_add_f32 v[98:99], v[98:99], v[130:131]
v_cvt_pk_bf16_f32 v12, v96, v97
v_cvt_pk_bf16_f32 v13, v98, v99
ds_write_b64 v8, v[12:13]
s_waitcnt lgkmcnt(0)
s_nop 0
v_cvt_pk_bf16_f32 v20, v180, v181
v_cvt_pk_bf16_f32 v21, v182, v183
v_cvt_pk_bf16_f32 v22, v184, v185
v_cvt_pk_bf16_f32 v23, v186, v187
v_cvt_pk_bf16_f32 v24, v188, v189
v_cvt_pk_bf16_f32 v25, v190, v191
v_cvt_pk_bf16_f32 v26, v192, v193
v_cvt_pk_bf16_f32 v27, v194, v195
s_barrier
ds_read_b64 v[14:15], v9
s_waitcnt lgkmcnt(0)
s_cmp_eq_u32 s18, 0
s_cbranch_scc1 L_mik_13
v_swap_b32 v12, v14
v_swap_b32 v13, v15
L_mik_13:
v_cndmask_b32 v28, v20, v12, s[84:85]
v_cndmask_b32 v29, v21, v13, s[84:85]
v_cndmask_b32 v30, v22, v14, s[84:85]
v_cndmask_b32 v31, v23, v15, s[84:85]
v_cndmask_b32 v32, v12, v24, s[84:85]
v_cndmask_b32 v33, v13, v25, s[84:85]
v_cndmask_b32 v34, v14, v26, s[84:85]
v_cndmask_b32 v35, v15, v27, s[84:85]
s_nop 1
v_mfma_f32_32x32x16_bf16 v[64:79], v[28:31], v[160:163], 0
v_mfma_f32_32x32x16_bf16 v[80:95], v[32:35], v[164:167], 0
v_mfma_f32_32x32x16_bf16 v[96:111], v[28:31], v[168:171], 0
v_mfma_f32_32x32x16_bf16 v[112:127], v[32:35], v[172:175], 0
s_nop 8
v_add_f32 v12, s82, v72
v_rcp_f32 v12, v12
s_nop 0
s_nop 0
v_pk_mul_f32 v[64:65], v[64:65], v[12:13] op_sel_hi:[1,0]
v_pk_mul_f32 v[66:67], v[66:67], v[12:13] op_sel_hi:[1,0]
v_pk_mul_f32 v[68:69], v[68:69], v[12:13] op_sel_hi:[1,0]
v_pk_mul_f32 v[70:71], v[70:71], v[12:13] op_sel_hi:[1,0]
v_cvt_pk_bf16_f32 v128, v64, v65
v_cvt_pk_bf16_f32 v129, v66, v67
v_cvt_pk_bf16_f32 v132, v68, v69
v_cvt_pk_bf16_f32 v133, v70, v71
v_add_f32 v14, s82, v80
v_rcp_f32 v14, v14
s_nop 0
s_nop 0
v_pk_mul_f32 v[88:89], v[88:89], v[14:15] op_sel_hi:[1,0]
v_pk_mul_f32 v[90:91], v[90:91], v[14:15] op_sel_hi:[1,0]
v_pk_mul_f32 v[92:93], v[92:93], v[14:15] op_sel_hi:[1,0]
v_pk_mul_f32 v[94:95], v[94:95], v[14:15] op_sel_hi:[1,0]
v_cvt_pk_bf16_f32 v130, v88, v89
v_cvt_pk_bf16_f32 v131, v90, v91
v_cvt_pk_bf16_f32 v134, v92, v93
v_cvt_pk_bf16_f32 v135, v94, v95
buffer_store_dwordx4 v[128:131], v4, s[64:67], s74 offen offset:0 sc1
buffer_store_dwordx4 v[132:135], v4, s[64:67], s74 offen offset:1024 sc1
v_add_f32 v16, s82, v104
v_rcp_f32 v16, v16
s_nop 0
s_nop 0
v_pk_mul_f32 v[96:97], v[96:97], v[16:17] op_sel_hi:[1,0]
v_pk_mul_f32 v[98:99], v[98:99], v[16:17] op_sel_hi:[1,0]
v_pk_mul_f32 v[100:101], v[100:101], v[16:17] op_sel_hi:[1,0]
v_pk_mul_f32 v[102:103], v[102:103], v[16:17] op_sel_hi:[1,0]
v_cvt_pk_bf16_f32 v136, v96, v97
v_cvt_pk_bf16_f32 v137, v98, v99
v_cvt_pk_bf16_f32 v140, v100, v101
v_cvt_pk_bf16_f32 v141, v102, v103
v_add_f32 v18, s82, v112
v_rcp_f32 v18, v18
s_nop 0
s_nop 0
v_pk_mul_f32 v[120:121], v[120:121], v[18:19] op_sel_hi:[1,0]
v_pk_mul_f32 v[122:123], v[122:123], v[18:19] op_sel_hi:[1,0]
v_pk_mul_f32 v[124:125], v[124:125], v[18:19] op_sel_hi:[1,0]
v_pk_mul_f32 v[126:127], v[126:127], v[18:19] op_sel_hi:[1,0]
v_cvt_pk_bf16_f32 v138, v120, v121
v_cvt_pk_bf16_f32 v139, v122, v123
v_cvt_pk_bf16_f32 v142, v124, v125
v_cvt_pk_bf16_f32 v143, v126, v127
buffer_store_dwordx4 v[136:139], v4, s[64:67], s75 offen offset:0 sc1
buffer_store_dwordx4 v[140:143], v4, s[64:67], s75 offen offset:1024 sc1
ds_read_b64_tr_b16 a[66:67], v248 offset:30720
ds_read_b64_tr_b16 a[70:71], v249 offset:30720
ds_read_b64_tr_b16 a[74:75], v250 offset:30720
ds_read_b64_tr_b16 a[78:79], v251 offset:30720
ds_read_b64_tr_b16 a[80:81], v248 offset:32768
ds_read_b64_tr_b16 a[84:85], v249 offset:32768
ds_read_b64_tr_b16 a[88:89], v250 offset:32768
ds_read_b64_tr_b16 a[92:93], v251 offset:32768
ds_read_b64_tr_b16 a[82:83], v248 offset:34816
ds_read_b64_tr_b16 a[86:87], v249 offset:34816
ds_read_b64_tr_b16 a[90:91], v250 offset:34816
ds_read_b64_tr_b16 a[94:95], v251 offset:34816
s_waitcnt lgkmcnt(8)
ds_read_b64_tr_b16 a[96:97], v248 offset:49152
ds_read_b64_tr_b16 a[100:101], v249 offset:49152
ds_read_b64_tr_b16 a[104:105], v250 offset:49152
ds_read_b64_tr_b16 a[108:109], v251 offset:49152
s_waitcnt lgkmcnt(8)
ds_read_b64_tr_b16 a[98:99], v248 offset:51200
ds_read_b64_tr_b16 a[102:103], v249 offset:51200
ds_read_b64_tr_b16 a[106:107], v250 offset:51200
ds_read_b64_tr_b16 a[110:111], v251 offset:51200
s_waitcnt lgkmcnt(8)
ds_read_b64_tr_b16 a[112:113], v248 offset:53248
ds_read_b64_tr_b16 a[116:117], v249 offset:53248
ds_read_b64_tr_b16 a[120:121], v250 offset:53248
ds_read_b64_tr_b16 a[124:125], v251 offset:53248
s_waitcnt lgkmcnt(8)
ds_read_b64_tr_b16 a[114:115], v248 offset:55296
ds_read_b64_tr_b16 a[118:119], v249 offset:55296
ds_read_b64_tr_b16 a[122:123], v250 offset:55296
ds_read_b64_tr_b16 a[126:127], v251 offset:55296
s_waitcnt lgkmcnt(8)
ds_read_b64_tr_b16 a[176:177], v248 offset:57344
ds_read_b64_tr_b16 a[180:181], v249 offset:57344
ds_read_b64_tr_b16 a[184:185], v250 offset:57344
ds_read_b64_tr_b16 a[188:189], v251 offset:57344
s_waitcnt lgkmcnt(8)
ds_read_b64_tr_b16 a[178:179], v248 offset:59392
ds_read_b64_tr_b16 a[182:183], v249 offset:59392
ds_read_b64_tr_b16 a[186:187], v250 offset:59392
ds_read_b64_tr_b16 a[190:191], v251 offset:59392
s_waitcnt lgkmcnt(8)
ds_read_b64_tr_b16 a[192:193], v248 offset:24576
ds_read_b64_tr_b16 a[196:197], v249 offset:24576
ds_read_b64_tr_b16 a[200:201], v250 offset:24576
ds_read_b64_tr_b16 a[204:205], v251 offset:24576
s_waitcnt vmcnt(2) lgkmcnt(8)
ds_read_b64_tr_b16 a[194:195], v248 offset:26624
ds_read_b64_tr_b16 a[198:199], v249 offset:26624
ds_read_b64_tr_b16 a[202:203], v250 offset:26624
ds_read_b64_tr_b16 a[206:207], v251 offset:26624
s_waitcnt vmcnt(0) lgkmcnt(8)
ds_read_b64_tr_b16 a[208:209], v248 offset:28672
ds_read_b64_tr_b16 a[212:213], v249 offset:28672
ds_read_b64_tr_b16 a[216:217], v250 offset:28672
ds_read_b64_tr_b16 a[220:221], v251 offset:28672
s_lshl2_add_u32 s70, s8, s26
s_lshl_b32 s74, s70, 6
s_add_u32 s74, s74, 6955008
s_and_b32 s70, s4, 1
s_lshl_b32 s70, s70, 13
s_add_u32 s74, s74, s70
v_and_b32 v26, 3, v2
v_lshlrev_b32 v26, 4, v26
s_lshl_b32 s68, s8, 16
s_lshl_b32 s69, s26, 13
s_add_u32 s68, s68, s69
s_add_u32 s72, s68, 2097152
s_mul_i32 s71, s9, 176128
s_add_u32 s71, s71, 4194304
s_add_u32 s63, s63, s71
s_lshr_b32 s22, s0, 7
s_lshr_b32 s23, s1, 7
s_add_u32 s22, s22, s71
s_add_u32 s23, s23, s71
v_mov_b32 v18, v246
v_add_u32 v19, 44032, v18
v_add_u32 v20, 44032, v19
v_add_u32 v21, 44032, v20
v_lshrrev_b32 v24, 4, v2
v_and_b32 v25, 15, v2
v_lshlrev_b32 v25, 4, v25
v_lshl_add_u32 v22, v24, 9, v25
v_add_u32 v23, 32768, v22
s_add_u32 m0, s62, 30720
s_add_u32 s61, s83, 5
s_and_b32 s61, s61, 7
s_lshl3_add_u32 s61, s26, s61
s_lshl_b32 s61, s61, 14
buffer_load_dwordx4 v242, s[36:39], s61 offen lds
buffer_load_dwordx4 v243, s[36:39], s61 offen offset:1024 lds
s_add_u32 m0, s62, 32768
s_add_u32 s61, s83, 6
s_and_b32 s61, s61, 7
s_lshl3_add_u32 s61, s26, s61
s_lshl_b32 s61, s61, 14
buffer_load_dwordx4 v242, s[36:39], s61 offen lds
buffer_load_dwordx4 v243, s[36:39], s61 offen offset:1024 lds
s_add_u32 m0, s62, 34816
s_add_u32 s61, s83, 7
s_and_b32 s61, s61, 7
s_lshl3_add_u32 s61, s26, s61
s_lshl_b32 s61, s61, 14
buffer_load_dwordx4 v242, s[36:39], s61 offen lds
buffer_load_dwordx4 v243, s[36:39], s61 offen offset:1024 lds
s_waitcnt vmcnt(4) lgkmcnt(8)
ds_read_b64_tr_b16 a[210:211], v248 offset:30720
ds_read_b64_tr_b16 a[214:215], v249 offset:30720
ds_read_b64_tr_b16 a[218:219], v250 offset:30720
ds_read_b64_tr_b16 a[222:223], v251 offset:30720
s_waitcnt vmcnt(2) lgkmcnt(8)
ds_read_b64_tr_b16 a[224:225], v248 offset:32768
ds_read_b64_tr_b16 a[228:229], v249 offset:32768
ds_read_b64_tr_b16 a[232:233], v250 offset:32768
ds_read_b64_tr_b16 a[236:237], v251 offset:32768
s_waitcnt vmcnt(6)
v_lshlrev_b32 v3, 13, v2
v_mov_b32 v4, s27
s_mov_b64 exec, 3
buffer_store_dword v4, v3, s[64:67], s77 offen sc1
s_mov_b64 exec, -1
s_waitcnt vmcnt(0) lgkmcnt(8)
ds_read_b64_tr_b16 a[226:227], v248 offset:34816
ds_read_b64_tr_b16 a[230:231], v249 offset:34816
ds_read_b64_tr_b16 a[234:235], v250 offset:34816
ds_read_b64_tr_b16 a[238:239], v251 offset:34816
s_lshr_b32 s70, s9, 1
s_lshl_b32 s70, s70, 5
s_mul_i32 s71, s26, 7
s_and_b32 s71, s71, 30
s_add_u32 s70, s70, s71
s_lshl_b32 s24, s70, 4
s_add_u32 s24, s24, 6938624
s_add_u32 s24, s24, s11
v_min_u32 v6, 9, v2
v_lshlrev_b32 v6, 4, v6
buffer_load_dword v7, v6, s[64:67], s24 offen sc1
s_add_u32 m0, s62, 0
s_add_u32 s60, s60, 65536
s_cmp_eq_u32 s60, s1
s_cselect_b32 s60, s0, s60
buffer_load_dwordx4 v240, s[48:51], s60 offen lds
buffer_load_dwordx4 v241, s[48:51], s60 offen offset:1024 lds
s_add_u32 m0, s62, 2048
s_add_u32 s60, s60, 65536
buffer_load_dwordx4 v240, s[48:51], s60 offen lds
buffer_load_dwordx4 v241, s[48:51], s60 offen offset:1024 lds
s_add_u32 m0, s62, 4096
s_add_u32 s60, s60, 65536
s_cmp_eq_u32 s60, s1
s_cselect_b32 s60, s0, s60
buffer_load_dwordx4 v240, s[48:51], s60 offen lds
buffer_load_dwordx4 v241, s[48:51], s60 offen offset:1024 lds
s_add_u32 m0, s62, 6144
s_add_u32 s60, s60, 65536
buffer_load_dwordx4 v240, s[48:51], s60 offen lds
buffer_load_dwordx4 v241, s[48:51], s60 offen offset:1024 lds
s_add_u32 m0, s62, 8192
s_add_u32 s60, s60, 65536
s_cmp_eq_u32 s60, s1
s_cselect_b32 s60, s0, s60
s_cmp_eq_u32 s26, 3
s_cselect_b32 s60, 5636096, s60
buffer_load_dwordx4 v240, s[48:51], s60 offen lds
buffer_load_dwordx4 v241, s[48:51], s60 offen offset:1024 lds
s_add_u32 m0, s62, 10240
s_add_u32 s60, s60, 65536
buffer_load_dwordx4 v240, s[48:51], s60 offen lds
buffer_load_dwordx4 v241, s[48:51], s60 offen offset:1024 lds
s_waitcnt vmcnt(12) lgkmcnt(0)
v_cmp_ne_u32 vcc, s27, v7
s_cbranch_vccz L_go_14
s_mov_b32 s25, 0
L_poll_16:
v_cmp_ne_u32 vcc, s27, v7
s_cbranch_vccz L_polld_17
s_add_u32 s25, s25, 1
s_cmp_lt_u32 s25, 262144
s_cbranch_scc0 L_polld_17
s_sleep 1
buffer_load_dword v7, v6, s[64:67], s24 offen sc1
s_waitcnt vmcnt(0)
s_branch L_poll_16
L_polld_17:
L_go_14:
buffer_load_dwordx4 v[128:131], v18, s[64:67], s63 offen sc1
buffer_load_dwordx4 v[132:135], v19, s[64:67], s63 offen sc1
buffer_load_dwordx4 v[136:139], v20, s[64:67], s63 offen sc1
buffer_load_dwordx4 v[140:143], v21, s[64:67], s63 offen sc1
s_add_u32 s63, s63, 1024
s_cmp_eq_u32 s63, s23
s_cselect_b32 s63, s22, s63
buffer_load_dwordx4 v[144:147], v18, s[64:67], s63 offen sc1
buffer_load_dwordx4 v[148:151], v19, s[64:67], s63 offen sc1
buffer_load_dwordx4 v[152:155], v20, s[64:67], s63 offen sc1
buffer_load_dwordx4 v[156:159], v21, s[64:67], s63 offen sc1
s_add_u32 s63, s63, 1024
s_cmp_eq_u32 s63, s23
s_cselect_b32 s63, s22, s63
buffer_load_dwordx4 v[160:163], v18, s[64:67], s63 offen sc1
buffer_load_dwordx4 v[164:167], v19, s[64:67], s63 offen sc1
s_waitcnt vmcnt(9)
v_mfma_f32_16x16x32_bf16 v[64:67], v[128:131], a[0:3], 0
buffer_load_dwordx4 v[168:171], v20, s[64:67], s63 offen sc1
v_mfma_f32_16x16x32_bf16 v[68:71], v[128:131], a[4:7], 0
ds_read_b64_tr_b16 a[128:129], v248 offset:0
ds_read_b64_tr_b16 a[132:133], v249 offset:0
ds_read_b64_tr_b16 a[136:137], v250 offset:0
ds_read_b64_tr_b16 a[140:141], v251 offset:0
v_mfma_f32_16x16x32_bf16 v[72:75], v[128:131], a[8:11], 0
ds_read_b64_tr_b16 a[130:131], v248 offset:2048
ds_read_b64_tr_b16 a[134:135], v249 offset:2048
ds_read_b64_tr_b16 a[138:139], v250 offset:2048
ds_read_b64_tr_b16 a[142:143], v251 offset:2048
v_mfma_f32_16x16x32_bf16 v[76:79], v[128:131], a[12:15], 0
s_waitcnt vmcnt(9)
v_mfma_f32_16x16x32_bf16 v[92:95], v[132:135], a[12:15], 0
buffer_load_dwordx4 v[172:175], v21, s[64:67], s63 offen sc1
v_mfma_f32_16x16x32_bf16 v[88:91], v[132:135], a[8:11], 0
s_add_u32 s63, s63, 1024
v_mfma_f32_16x16x32_bf16 v[84:87], v[132:135], a[4:7], 0
s_cmp_eq_u32 s63, s23
s_cselect_b32 s63, s22, s63
v_mfma_f32_16x16x32_bf16 v[80:83], v[132:135], a[0:3], 0
s_waitcnt vmcnt(9)
v_mfma_f32_16x16x32_bf16 v[96:99], v[136:139], a[0:3], 0
buffer_load_dwordx4 v[176:179], v18, s[64:67], s63 offen sc1
v_mfma_f32_16x16x32_bf16 v[100:103], v[136:139], a[4:7], 0
v_mfma_f32_16x16x32_bf16 v[104:107], v[136:139], a[8:11], 0
v_mfma_f32_16x16x32_bf16 v[108:111], v[136:139], a[12:15], 0
s_waitcnt vmcnt(9)
v_mfma_f32_16x16x32_bf16 v[124:127], v[140:143], a[12:15], 0
buffer_load_dwordx4 v[180:183], v19, s[64:67], s63 offen sc1
v_mfma_f32_16x16x32_bf16 v[120:123], v[140:143], a[8:11], 0
v_mfma_f32_16x16x32_bf16 v[116:119], v[140:143], a[4:7], 0
v_mfma_f32_16x16x32_bf16 v[112:115], v[140:143], a[0:3], 0
s_waitcnt vmcnt(9)
v_mfma_f32_16x16x32_bf16 v[64:67], v[144:147], a[16:19], v[64:67]
buffer_load_dwordx4 v[184:187], v20, s[64:67], s63 offen sc1
v_mfma_f32_16x16x32_bf16 v[68:71], v[144:147], a[20:23], v[68:71]
ds_read_b64_tr_b16 a[144:145], v248 offset:4096
ds_read_b64_tr_b16 a[148:149], v249 offset:4096
ds_read_b64_tr_b16 a[152:153], v250 offset:4096
ds_read_b64_tr_b16 a[156:157], v251 offset:4096
v_mfma_f32_16x16x32_bf16 v[72:75], v[144:147], a[24:27], v[72:75]
s_waitcnt lgkmcnt(8)
ds_read_b64_tr_b16 a[146:147], v248 offset:6144
ds_read_b64_tr_b16 a[150:151], v249 offset:6144
ds_read_b64_tr_b16 a[154:155], v250 offset:6144
ds_read_b64_tr_b16 a[158:159], v251 offset:6144
v_mfma_f32_16x16x32_bf16 v[76:79], v[144:147], a[28:31], v[76:79]
s_waitcnt vmcnt(9)
v_mfma_f32_16x16x32_bf16 v[92:95], v[148:151], a[28:31], v[92:95]
buffer_load_dwordx4 v[188:191], v21, s[64:67], s63 offen sc1
v_mfma_f32_16x16x32_bf16 v[88:91], v[148:151], a[24:27], v[88:91]
s_add_u32 s63, s63, 1024
v_mfma_f32_16x16x32_bf16 v[84:87], v[148:151], a[20:23], v[84:87]
s_cmp_eq_u32 s63, s23
s_cselect_b32 s63, s22, s63
v_mfma_f32_16x16x32_bf16 v[80:83], v[148:151], a[16:19], v[80:83]
s_waitcnt vmcnt(9)
v_mfma_f32_16x16x32_bf16 v[96:99], v[152:155], a[16:19], v[96:99]
buffer_load_dwordx4 v[192:195], v18, s[64:67], s63 offen sc1
v_mfma_f32_16x16x32_bf16 v[100:103], v[152:155], a[20:23], v[100:103]
v_mfma_f32_16x16x32_bf16 v[104:107], v[152:155], a[24:27], v[104:107]
v_mfma_f32_16x16x32_bf16 v[108:111], v[152:155], a[28:31], v[108:111]
s_waitcnt vmcnt(9)
v_mfma_f32_16x16x32_bf16 v[124:127], v[156:159], a[28:31], v[124:127]
buffer_load_dwordx4 v[196:199], v19, s[64:67], s63 offen sc1
v_mfma_f32_16x16x32_bf16 v[120:123], v[156:159], a[24:27], v[120:123]
v_mfma_f32_16x16x32_bf16 v[116:119], v[156:159], a[20:23], v[116:119]
v_mfma_f32_16x16x32_bf16 v[112:115], v[156:159], a[16:19], v[112:115]
s_waitcnt vmcnt(9)
v_mfma_f32_16x16x32_bf16 v[64:67], v[160:163], a[32:35], v[64:67]
buffer_load_dwordx4 v[200:203], v20, s[64:67], s63 offen sc1
v_mfma_f32_16x16x32_bf16 v[68:71], v[160:163], a[36:39], v[68:71]
s_waitcnt lgkmcnt(8)
ds_read_b64_tr_b16 a[160:161], v248 offset:8192
ds_read_b64_tr_b16 a[164:165], v249 offset:8192
ds_read_b64_tr_b16 a[168:169], v250 offset:8192
ds_read_b64_tr_b16 a[172:173], v251 offset:8192
v_mfma_f32_16x16x32_bf16 v[72:75], v[160:163], a[40:43], v[72:75]
s_waitcnt lgkmcnt(8)
ds_read_b64_tr_b16 a[162:163], v248 offset:10240
ds_read_b64_tr_b16 a[166:167], v249 offset:10240
ds_read_b64_tr_b16 a[170:171], v250 offset:10240
ds_read_b64_tr_b16 a[174:175], v251 offset:10240
v_mfma_f32_16x16x32_bf16 v[76:79], v[160:163], a[44:47], v[76:79]
s_waitcnt vmcnt(9)
v_mfma_f32_16x16x32_bf16 v[92:95], v[164:167], a[44:47], v[92:95]
buffer_load_dwordx4 v[204:207], v21, s[64:67], s63 offen sc1
v_mfma_f32_16x16x32_bf16 v[88:91], v[164:167], a[40:43], v[88:91]
s_add_u32 s63, s63, 1024
v_mfma_f32_16x16x32_bf16 v[84:87], v[164:167], a[36:39], v[84:87]
s_cmp_eq_u32 s63, s23
s_cselect_b32 s63, s22, s63
v_mfma_f32_16x16x32_bf16 v[80:83], v[164:167], a[32:35], v[80:83]
s_waitcnt vmcnt(9)
v_mfma_f32_16x16x32_bf16 v[96:99], v[168:171], a[32:35], v[96:99]
buffer_load_dwordx4 v[208:211], v18, s[64:67], s63 offen sc1
v_mfma_f32_16x16x32_bf16 v[100:103], v[168:171], a[36:39], v[100:103]
v_mfma_f32_16x16x32_bf16 v[104:107], v[168:171], a[40:43], v[104:107]
v_mfma_f32_16x16x32_bf16 v[108:111], v[168:171], a[44:47], v[108:111]
s_waitcnt vmcnt(9)
v_mfma_f32_16x16x32_bf16 v[124:127], v[172:175], a[44:47], v[124:127]
buffer_load_dwordx4 v[212:215], v19, s[64:67], s63 offen sc1
v_mfma_f32_16x16x32_bf16 v[120:123], v[172:175], a[40:43], v[120:123]
v_mfma_f32_16x16x32_bf16 v[116:119], v[172:175], a[36:39], v[116:119]
v_mfma_f32_16x16x32_bf16 v[112:115], v[172:175], a[32:35], v[112:115]
s_waitcnt vmcnt(9)
v_mfma_f32_16x16x32_bf16 v[64:67], v[176:179], a[48:51], v[64:67]
buffer_load_dwordx4 v[216:219], v20, s[64:67], s63 offen sc1
v_mfma_f32_16x16x32_bf16 v[68:71], v[176:179], a[52:55], v[68:71]
v_mfma_f32_16x16x32_bf16 v[72:75], v[176:179], a[56:59], v[72:75]
v_mfma_f32_16x16x32_bf16 v[76:79], v[176:179], a[60:63], v[76:79]
s_waitcnt vmcnt(9)
v_mfma_f32_16x16x32_bf16 v[92:95], v[180:183], a[60:63], v[92:95]
buffer_load_dwordx4 v[220:223], v21, s[64:67], s63 offen sc1
v_mfma_f32_16x16x32_bf16 v[88:91], v[180:183], a[56:59], v[88:91]
s_add_u32 s63, s63, 1024
v_mfma_f32_16x16x32_bf16 v[84:87], v[180:183], a[52:55], v[84:87]
s_cmp_eq_u32 s63, s23
s_cselect_b32 s63, s22, s63
v_mfma_f32_16x16x32_bf16 v[80:83], v[180:183], a[48:51], v[80:83]
s_waitcnt vmcnt(9)
v_mfma_f32_16x16x32_bf16 v[96:99], v[184:187], a[48:51], v[96:99]
buffer_load_dwordx4 v[224:227], v18, s[64:67], s63 offen sc1
v_mfma_f32_16x16x32_bf16 v[100:103], v[184:187], a[52:55], v[100:103]
v_mfma_f32_16x16x32_bf16 v[104:107], v[184:187], a[56:59], v[104:107]
v_mfma_f32_16x16x32_bf16 v[108:111], v[184:187], a[60:63], v[108:111]
s_waitcnt vmcnt(9)
v_mfma_f32_16x16x32_bf16 v[124:127], v[188:191], a[60:63], v[124:127]
buffer_load_dwordx4 v[228:231], v19, s[64:67], s63 offen sc1
v_mfma_f32_16x16x32_bf16 v[120:123], v[188:191], a[56:59], v[120:123]
v_mfma_f32_16x16x32_bf16 v[116:119], v[188:191], a[52:55], v[116:119]
v_mfma_f32_16x16x32_bf16 v[112:115], v[188:191], a[48:51], v[112:115]
s_waitcnt vmcnt(9)
v_mfma_f32_16x16x32_bf16 v[64:67], v[192:195], a[64:67], v[64:67]
buffer_load_dwordx4 v[232:235], v20, s[64:67], s63 offen sc1
v_mfma_f32_16x16x32_bf16 v[68:71], v[192:195], a[68:71], v[68:71]
buffer_load_dword v27, v26, s[64:67], s74 offen sc1
v_mfma_f32_16x16x32_bf16 v[72:75], v[192:195], a[72:75], v[72:75]
v_mfma_f32_16x16x32_bf16 v[76:79], v[192:195], a[76:79], v[76:79]
s_waitcnt vmcnt(10)
v_mfma_f32_16x16x32_bf16 v[92:95], v[196:199], a[76:79], v[92:95]
buffer_load_dwordx4 v[236:239], v21, s[64:67], s63 offen sc1
v_mfma_f32_16x16x32_bf16 v[88:91], v[196:199], a[72:75], v[88:91]
s_add_u32 s63, s63, 1024
v_mfma_f32_16x16x32_bf16 v[84:87], v[196:199], a[68:71], v[84:87]
s_cmp_eq_u32 s63, s23
s_cselect_b32 s63, s22, s63
v_mfma_f32_16x16x32_bf16 v[80:83], v[196:199], a[64:67], v[80:83]
s_waitcnt vmcnt(10)
v_mfma_f32_16x16x32_bf16 v[96:99], v[200:203], a[64:67], v[96:99]
buffer_load_dwordx4 v[128:131], v18, s[64:67], s63 offen sc1
v_mfma_f32_16x16x32_bf16 v[100:103], v[200:203], a[68:71], v[100:103]
v_mfma_f32_16x16x32_bf16 v[104:107], v[200:203], a[72:75], v[104:107]
v_mfma_f32_16x16x32_bf16 v[108:111], v[200:203], a[76:79], v[108:111]
s_waitcnt vmcnt(10)
v_mfma_f32_16x16x32_bf16 v[124:127], v[204:207], a[76:79], v[124:127]
buffer_load_dwordx4 v[132:135], v19, s[64:67], s63 offen sc1
v_mfma_f32_16x16x32_bf16 v[120:123], v[204:207], a[72:75], v[120:123]
v_mfma_f32_16x16x32_bf16 v[116:119], v[204:207], a[68:71], v[116:119]
v_mfma_f32_16x16x32_bf16 v[112:115], v[204:207], a[64:67], v[112:115]
s_waitcnt vmcnt(10) lgkmcnt(0)
v_mfma_f32_16x16x32_bf16 v[64:67], v[208:211], a[80:83], v[64:67]
buffer_load_dwordx4 v[136:139], v20, s[64:67], s63 offen sc1
v_mfma_f32_16x16x32_bf16 v[68:71], v[208:211], a[84:87], v[68:71]
v_add_u32 v9, 8192, v247
v_mfma_f32_16x16x32_bf16 v[72:75], v[208:211], a[88:91], v[72:75]
v_accvgpr_read_b32 v10, a240
v_mfma_f32_16x16x32_bf16 v[76:79], v[208:211], a[92:95], v[76:79]
v_accvgpr_read_b32 v11, a241
s_waitcnt vmcnt(10)
v_mfma_f32_16x16x32_bf16 v[92:95], v[212:215], a[92:95], v[92:95]
buffer_load_dwordx4 v[140:143], v21, s[64:67], s63 offen sc1
v_mfma_f32_16x16x32_bf16 v[88:91], v[212:215], a[88:91], v[88:91]
s_add_u32 s63, s63, 1024
v_mfma_f32_16x16x32_bf16 v[84:87], v[212:215], a[84:87], v[84:87]
s_cmp_eq_u32 s63, s23
s_cselect_b32 s63, s22, s63
v_mfma_f32_16x16x32_bf16 v[80:83], v[212:215], a[80:83], v[80:83]
v_accvgpr_read_b32 v12, a242
s_waitcnt vmcnt(10)
v_mfma_f32_16x16x32_bf16 v[96:99], v[216:219], a[80:83], v[96:99]
buffer_load_dwordx4 v[144:147], v18, s[64:67], s63 offen sc1
v_mfma_f32_16x16x32_bf16 v[100:103], v[216:219], a[84:87], v[100:103]
v_accvgpr_read_b32 v13, a243
v_mfma_f32_16x16x32_bf16 v[104:107], v[216:219], a[88:91], v[104:107]
v_accvgpr_read_b32 v14, a244
v_mfma_f32_16x16x32_bf16 v[108:111], v[216:219], a[92:95], v[108:111]
v_accvgpr_read_b32 v15, a245
s_waitcnt vmcnt(10)
v_mfma_f32_16x16x32_bf16 v[124:127], v[220:223], a[92:95], v[124:127]
buffer_load_dwordx4 v[148:151], v19, s[64:67], s63 offen sc1
v_mfma_f32_16x16x32_bf16 v[120:123], v[220:223], a[88:91], v[120:123]
v_accvgpr_read_b32 v16, a246
v_mfma_f32_16x16x32_bf16 v[116:119], v[220:223], a[84:87], v[116:119]
v_accvgpr_read_b32 v17, a247
v_mfma_f32_16x16x32_bf16 v[112:115], v[220:223], a[80:83], v[112:115]
v_lshrrev_b32 v3, 5, v2
s_waitcnt vmcnt(10)
v_mfma_f32_16x16x32_bf16 v[64:67], v[224:227], a[96:99], v[64:67]
buffer_load_dwordx4 v[152:155], v20, s[64:67], s63 offen sc1
v_mfma_f32_16x16x32_bf16 v[68:71], v[224:227], a[100:103], v[68:71]
v_lshlrev_b32 v3, 5, v3
v_mfma_f32_16x16x32_bf16 v[72:75], v[224:227], a[104:107], v[72:75]
v_xor_b32 v3, v3, v246
v_mfma_f32_16x16x32_bf16 v[76:79], v[224:227], a[108:111], v[76:79]
v_xor_b32 v4, 0, v3
s_waitcnt vmcnt(10)
v_mfma_f32_16x16x32_bf16 v[92:95], v[228:231], a[108:111], v[92:95]
buffer_load_dwordx4 v[156:159], v21, s[64:67], s63 offen sc1
v_mfma_f32_16x16x32_bf16 v[88:91], v[228:231], a[104:107], v[88:91]
s_add_u32 s63, s63, 1024
v_mfma_f32_16x16x32_bf16 v[84:87], v[228:231], a[100:103], v[84:87]
s_cmp_eq_u32 s63, s23
s_cselect_b32 s63, s22, s63
v_mfma_f32_16x16x32_bf16 v[80:83], v[228:231], a[96:99], v[80:83]
v_add_u32 v56, s62, v4
s_waitcnt vmcnt(10)
v_mfma_f32_16x16x32_bf16 v[96:99], v[232:235], a[96:99], v[96:99]
buffer_load_dwordx4 v[160:163], v18, s[64:67], s63 offen sc1
v_mfma_f32_16x16x32_bf16 v[100:103], v[232:235], a[100:103], v[100:103]
v_xor_b32 v4, 64, v3
v_mfma_f32_16x16x32_bf16 v[104:107], v[232:235], a[104:107], v[104:107]
v_add_u32 v57, s62, v4
v_mfma_f32_16x16x32_bf16 v[108:111], v[232:235], a[108:111], v[108:111]
v_xor_b32 v4, 128, v3
s_waitcnt vmcnt(9)
v_mfma_f32_16x16x32_bf16 v[124:127], v[236:239], a[108:111], v[124:127]
buffer_load_dwordx4 v[164:167], v19, s[64:67], s63 offen sc1
v_mfma_f32_16x16x32_bf16 v[120:123], v[236:239], a[104:107], v[120:123]
v_add_u32 v58, s62, v4
v_mfma_f32_16x16x32_bf16 v[116:119], v[236:239], a[100:103], v[116:119]
v_xor_b32 v4, 192, v3
v_mfma_f32_16x16x32_bf16 v[112:115], v[236:239], a[96:99], v[112:115]
v_add_u32 v59, s62, v4
s_waitcnt vmcnt(9)
v_mfma_f32_16x16x32_bf16 v[64:67], v[128:131], a[112:115], v[64:67]
buffer_load_dwordx4 v[168:171], v20, s[64:67], s63 offen sc1
v_mfma_f32_16x16x32_bf16 v[68:71], v[128:131], a[116:119], v[68:71]
v_lshrrev_b32 v3, 3, v2
v_mfma_f32_16x16x32_bf16 v[72:75], v[128:131], a[120:123], v[72:75]
v_and_b32 v4, 7, v2
v_mfma_f32_16x16x32_bf16 v[76:79], v[128:131], a[124:127], v[76:79]
v_lshlrev_b32 v5, 1, v4
s_waitcnt vmcnt(9)
v_mfma_f32_16x16x32_bf16 v[92:95], v[132:135], a[124:127], v[92:95]
buffer_load_dwordx4 v[172:175], v21, s[64:67], s63 offen sc1
v_mfma_f32_16x16x32_bf16 v[88:91], v[132:135], a[120:123], v[88:91]
s_add_u32 s63, s63, 1024
v_mfma_f32_16x16x32_bf16 v[84:87], v[132:135], a[116:119], v[84:87]
s_cmp_eq_u32 s63, s23
s_cselect_b32 s63, s22, s63
v_mfma_f32_16x16x32_bf16 v[80:83], v[132:135], a[112:115], v[80:83]
v_xor_b32 v3, v3, v5
s_waitcnt vmcnt(9)
v_mfma_f32_16x16x32_bf16 v[96:99], v[136:139], a[112:115], v[96:99]
buffer_load_dwordx4 v[176:179], v18, s[64:67], s63 offen sc1
v_mfma_f32_16x16x32_bf16 v[100:103], v[136:139], a[116:119], v[100:103]
v_lshlrev_b32 v3, 4, v3
v_mfma_f32_16x16x32_bf16 v[104:107], v[136:139], a[120:123], v[104:107]
v_lshl_add_u32 v3, v4, 9, v3
v_mfma_f32_16x16x32_bf16 v[108:111], v[136:139], a[124:127], v[108:111]
s_lshl_b32 s68, s26, 12
s_waitcnt vmcnt(9)
v_mfma_f32_16x16x32_bf16 v[124:127], v[140:143], a[124:127], v[124:127]
buffer_load_dwordx4 v[180:183], v19, s[64:67], s63 offen sc1
v_mfma_f32_16x16x32_bf16 v[120:123], v[140:143], a[120:123], v[120:123]
s_cmp_eq_u32 s26, 3
s_cselect_b32 s68, 24576, s68
v_mfma_f32_16x16x32_bf16 v[116:119], v[140:143], a[116:119], v[116:119]
v_add_u32 v36, s68, v3
v_mfma_f32_16x16x32_bf16 v[112:115], v[140:143], a[112:115], v[112:115]
v_xor_b32 v37, 128, v36
s_waitcnt vmcnt(9)
v_mfma_f32_16x16x32_bf16 v[64:67], v[144:147], a[128:131], v[64:67]
buffer_load_dwordx4 v[184:187], v20, s[64:67], s63 offen sc1
v_mfma_f32_16x16x32_bf16 v[68:71], v[144:147], a[132:135], v[68:71]
v_add_u32 v38, 73728, v36
v_mfma_f32_16x16x32_bf16 v[72:75], v[144:147], a[136:139], v[72:75]
v_add_u32 v39, 73728, v37
v_mfma_f32_16x16x32_bf16 v[76:79], v[144:147], a[140:143], v[76:79]
v_lshlrev_b32 v8, 16, v0
s_waitcnt vmcnt(9)
v_mfma_f32_16x16x32_bf16 v[92:95], v[148:151], a[140:143], v[92:95]
buffer_load_dwordx4 v[188:191], v21, s[64:67], s63 offen sc1
v_mfma_f32_16x16x32_bf16 v[88:91], v[148:151], a[136:139], v[88:91]
s_add_u32 s63, s63, 1024
v_mfma_f32_16x16x32_bf16 v[84:87], v[148:151], a[132:135], v[84:87]
s_cmp_eq_u32 s63, s23
s_cselect_b32 s63, s22, s63
v_mfma_f32_16x16x32_bf16 v[80:83], v[148:151], a[128:131], v[80:83]
v_lshlrev_b32 v7, 16, v1
s_waitcnt vmcnt(9)
v_mfma_f32_16x16x32_bf16 v[96:99], v[152:155], a[128:131], v[96:99]
s_mov_b32 s25, 0
L_poll_18:
v_cmp_ne_u32 vcc, s27, v27
s_cbranch_vccz L_polld_19
s_add_u32 s25, s25, 1
s_cmp_lt_u32 s25, 262144
s_cbranch_scc0 L_polld_19
s_sleep 1
buffer_load_dword v27, v26, s[64:67], s74 offen sc1
s_waitcnt vmcnt(0)
s_branch L_poll_18
L_polld_19:
s_add_u32 s73, s83, 0
s_and_b32 s73, s73, 7
s_lshl_b32 s73, s73, 10
s_add_u32 s73, s73, s72
buffer_load_dwordx4 v[192:195], v22, s[64:67], s73 offen offset:0 sc1
v_mfma_f32_16x16x32_bf16 v[100:103], v[152:155], a[132:135], v[100:103]
v_lshlrev_b32 v40, 16, v10
v_mfma_f32_16x16x32_bf16 v[104:107], v[152:155], a[136:139], v[104:107]
v_and_b32 v41, 0xffff0000, v10
v_mfma_f32_16x16x32_bf16 v[108:111], v[152:155], a[140:143], v[108:111]
v_lshlrev_b32 v42, 16, v11
s_waitcnt vmcnt(9)
v_mfma_f32_16x16x32_bf16 v[124:127], v[156:159], a[140:143], v[124:127]
buffer_load_dwordx4 v[196:199], v22, s[64:67], s73 offen offset:256 sc1
v_mfma_f32_16x16x32_bf16 v[120:123], v[156:159], a[136:139], v[120:123]
v_and_b32 v43, 0xffff0000, v11
v_mfma_f32_16x16x32_bf16 v[116:119], v[156:159], a[132:135], v[116:119]
v_lshlrev_b32 v44, 16, v12
v_mfma_f32_16x16x32_bf16 v[112:115], v[156:159], a[128:131], v[112:115]
v_and_b32 v45, 0xffff0000, v12
s_waitcnt vmcnt(9)
v_mfma_f32_16x16x32_bf16 v[64:67], v[160:163], a[144:147], v[64:67]
buffer_load_dwordx4 v[200:203], v23, s[64:67], s73 offen offset:0 sc1
v_mfma_f32_16x16x32_bf16 v[68:71], v[160:163], a[148:151], v[68:71]
v_lshlrev_b32 v46, 16, v13
v_mfma_f32_16x16x32_bf16 v[72:75], v[160:163], a[152:155], v[72:75]
v_and_b32 v47, 0xffff0000, v13
v_mfma_f32_16x16x32_bf16 v[76:79], v[160:163], a[156:159], v[76:79]
v_lshlrev_b32 v48, 16, v14
s_waitcnt vmcnt(9)
v_mfma_f32_16x16x32_bf16 v[92:95], v[164:167], a[156:159], v[92:95]
buffer_load_dwordx4 v[204:207], v23, s[64:67], s73 offen offset:256 sc1
v_mfma_f32_16x16x32_bf16 v[88:91], v[164:167], a[152:155], v[88:91]
v_and_b32 v49, 0xffff0000, v14
v_mfma_f32_16x16x32_bf16 v[84:87], v[164:167], a[148:151], v[84:87]
v_lshlrev_b32 v50, 16, v15
v_mfma_f32_16x16x32_bf16 v[80:83], v[164:167], a[144:147], v[80:83]
v_and_b32 v51, 0xffff0000, v15
s_waitcnt vmcnt(9)
v_mfma_f32_16x16x32_bf16 v[96:99], v[168:171], a[144:147], v[96:99]
s_add_u32 s73, s83, 2
s_and_b32 s73, s73, 7
s_lshl_b32 s73, s73, 10
s_add_u32 s73, s73, s72
buffer_load_dwordx4 v[208:211], v22, s[64:67], s73 offen offset:0 sc1
v_mfma_f32_16x16x32_bf16 v[100:103], v[168:171], a[148:151], v[100:103]
v_lshlrev_b32 v52, 16, v16
v_mfma_f32_16x16x32_bf16 v[104:107], v[168:171], a[152:155], v[104:107]
v_and_b32 v53, 0xffff0000, v16
v_mfma_f32_16x16x32_bf16 v[108:111], v[168:171], a[156:159], v[108:111]
v_lshlrev_b32 v54, 16, v17
s_waitcnt vmcnt(9)
v_mfma_f32_16x16x32_bf16 v[124:127], v[172:175], a[156:159], v[124:127]
buffer_load_dwordx4 v[212:215], v22, s[64:67], s73 offen offset:256 sc1
v_mfma_f32_16x16x32_bf16 v[120:123], v[172:175], a[152:155], v[120:123]
v_and_b32 v55, 0xffff0000, v17
v_mfma_f32_16x16x32_bf16 v[116:119], v[172:175], a[148:151], v[116:119]
v_add_f32 v40, v40, v8
v_mfma_f32_16x16x32_bf16 v[112:115], v[172:175], a[144:147], v[112:115]
v_add_f32 v41, v41, v8
s_waitcnt vmcnt(9)
v_mfma_f32_16x16x32_bf16 v[64:67], v[176:179], a[160:163], v[64:67]
buffer_load_dwordx4 v[216:219], v23, s[64:67], s73 offen offset:0 sc1
v_mfma_f32_16x16x32_bf16 v[68:71], v[176:179], a[164:167], v[68:71]
v_add_f32 v42, v42, v8
v_mfma_f32_16x16x32_bf16 v[72:75], v[176:179], a[168:171], v[72:75]
v_add_f32 v43, v43, v8
v_mfma_f32_16x16x32_bf16 v[76:79], v[176:179], a[172:175], v[76:79]
v_add_f32 v44, v44, v8
s_waitcnt vmcnt(9)
v_mfma_f32_16x16x32_bf16 v[92:95], v[180:183], a[172:175], v[92:95]
buffer_load_dwordx4 v[220:223], v23, s[64:67], s73 offen offset:256 sc1
v_mfma_f32_16x16x32_bf16 v[88:91], v[180:183], a[168:171], v[88:91]
v_add_f32 v45, v45, v8
v_mfma_f32_16x16x32_bf16 v[84:87], v[180:183], a[164:167], v[84:87]
v_add_f32 v46, v46, v8
v_mfma_f32_16x16x32_bf16 v[80:83], v[180:183], a[160:163], v[80:83]
v_add_f32 v47, v47, v8
s_waitcnt vmcnt(9)
v_mfma_f32_16x16x32_bf16 v[96:99], v[184:187], a[160:163], v[96:99]
s_add_u32 s73, s83, 4
s_and_b32 s73, s73, 7
s_lshl_b32 s73, s73, 10
s_add_u32 s73, s73, s72
buffer_load_dwordx4 v[224:227], v22, s[64:67], s73 offen offset:0 sc1
v_mfma_f32_16x16x32_bf16 v[100:103], v[184:187], a[164:167], v[100:103]
v_add_f32 v48, v48, v7
v_mfma_f32_16x16x32_bf16 v[104:107], v[184:187], a[168:171], v[104:107]
v_add_f32 v49, v49, v7
v_mfma_f32_16x16x32_bf16 v[108:111], v[184:187], a[172:175], v[108:111]
v_add_f32 v50, v50, v7
s_waitcnt vmcnt(9)
v_mfma_f32_16x16x32_bf16 v[124:127], v[188:191], a[172:175], v[124:127]
buffer_load_dwordx4 v[228:231], v22, s[64:67], s73 offen offset:256 sc1
v_mfma_f32_16x16x32_bf16 v[120:123], v[188:191], a[168:171], v[120:123]
v_add_f32 v51, v51, v7
v_mfma_f32_16x16x32_bf16 v[116:119], v[188:191], a[164:167], v[116:119]
v_add_f32 v52, v52, v7
v_mfma_f32_16x16x32_bf16 v[112:115], v[188:191], a[160:163], v[112:115]
v_add_f32 v53, v53, v7
s_waitcnt vmcnt(9)
v_mfma_f32_16x16x32_bf16 v[64:67], a[176:179], v[192:195], v[64:67]
buffer_load_dwordx4 v[232:235], v23, s[64:67], s73 offen offset:0 sc1
v_mfma_f32_16x16x32_bf16 v[80:83], a[180:183], v[192:195], v[80:83]
v_add_f32 v54, v54, v7
v_mfma_f32_16x16x32_bf16 v[96:99], a[184:187], v[192:195], v[96:99]
v_add_f32 v55, v55, v7
v_mfma_f32_16x16x32_bf16 v[112:115], a[188:191], v[192:195], v[112:115]
s_waitcnt vmcnt(9)
v_mfma_f32_16x16x32_bf16 v[116:119], a[188:191], v[196:199], v[116:119]
buffer_load_dwordx4 v[236:239], v23, s[64:67], s73 offen offset:256 sc1
v_mfma_f32_16x16x32_bf16 v[100:103], a[184:187], v[196:199], v[100:103]
v_mfma_f32_16x16x32_bf16 v[84:87], a[180:183], v[196:199], v[84:87]
v_mfma_f32_16x16x32_bf16 v[68:71], a[176:179], v[196:199], v[68:71]
s_waitcnt vmcnt(9)
v_mfma_f32_16x16x32_bf16 v[72:75], a[176:179], v[200:203], v[72:75]
s_add_u32 s73, s83, 6
s_and_b32 s73, s73, 7
s_lshl_b32 s73, s73, 10
s_add_u32 s73, s73, s72
buffer_load_dwordx4 v[128:131], v22, s[64:67], s73 offen offset:0 sc1
v_mfma_f32_16x16x32_bf16 v[88:91], a[180:183], v[200:203], v[88:91]
v_mfma_f32_16x16x32_bf16 v[104:107], a[184:187], v[200:203], v[104:107]
v_mfma_f32_16x16x32_bf16 v[120:123], a[188:191], v[200:203], v[120:123]
s_waitcnt vmcnt(9)
v_mfma_f32_16x16x32_bf16 v[124:127], a[188:191], v[204:207], v[124:127]
buffer_load_dwordx4 v[132:135], v22, s[64:67], s73 offen offset:256 sc1
v_mfma_f32_16x16x32_bf16 v[108:111], a[184:187], v[204:207], v[108:111]
v_mfma_f32_16x16x32_bf16 v[92:95], a[180:183], v[204:207], v[92:95]
v_mfma_f32_16x16x32_bf16 v[76:79], a[176:179], v[204:207], v[76:79]
s_waitcnt vmcnt(9)
v_mfma_f32_16x16x32_bf16 v[64:67], a[192:195], v[208:211], v[64:67]
buffer_load_dwordx4 v[136:139], v23, s[64:67], s73 offen offset:0 sc1
v_mfma_f32_16x16x32_bf16 v[80:83], a[196:199], v[208:211], v[80:83]
v_mfma_f32_16x16x32_bf16 v[96:99], a[200:203], v[208:211], v[96:99]
v_mfma_f32_16x16x32_bf16 v[112:115], a[204:207], v[208:211], v[112:115]
s_waitcnt vmcnt(9)
v_mfma_f32_16x16x32_bf16 v[116:119], a[204:207], v[212:215], v[116:119]
buffer_load_dwordx4 v[140:143], v23, s[64:67], s73 offen offset:256 sc1
v_mfma_f32_16x16x32_bf16 v[100:103], a[200:203], v[212:215], v[100:103]
v_mfma_f32_16x16x32_bf16 v[84:87], a[196:199], v[212:215], v[84:87]
v_mfma_f32_16x16x32_bf16 v[68:71], a[192:195], v[212:215], v[68:71]
s_waitcnt vmcnt(9)
v_mfma_f32_16x16x32_bf16 v[72:75], a[192:195], v[216:219], v[72:75]
v_mfma_f32_16x16x32_bf16 v[88:91], a[196:199], v[216:219], v[88:91]
v_mfma_f32_16x16x32_bf16 v[104:107], a[200:203], v[216:219], v[104:107]
v_mfma_f32_16x16x32_bf16 v[120:123], a[204:207], v[216:219], v[120:123]
s_waitcnt vmcnt(8)
v_mfma_f32_16x16x32_bf16 v[124:127], a[204:207], v[220:223], v[124:127]
v_mfma_f32_16x16x32_bf16 v[108:111], a[200:203], v[220:223], v[108:111]
v_mfma_f32_16x16x32_bf16 v[92:95], a[196:199], v[220:223], v[92:95]
v_mfma_f32_16x16x32_bf16 v[76:79], a[192:195], v[220:223], v[76:79]
s_waitcnt vmcnt(7) lgkmcnt(0)
v_mfma_f32_16x16x32_bf16 v[64:67], a[208:211], v[224:227], v[64:67]
s_waitcnt vmcnt(3)
v_mfma_f32_16x16x32_bf16 v[64:67], a[224:227], v[128:131], v[64:67]
v_mfma_f32_16x16x32_bf16 v[80:83], a[212:215], v[224:227], v[80:83]
v_mfma_f32_16x16x32_bf16 v[80:83], a[228:231], v[128:131], v[80:83]
v_mfma_f32_16x16x32_bf16 v[96:99], a[216:219], v[224:227], v[96:99]
v_mfma_f32_16x16x32_bf16 v[96:99], a[232:235], v[128:131], v[96:99]
v_mfma_f32_16x16x32_bf16 v[112:115], a[220:223], v[224:227], v[112:115]
s_nop 2
ds_write_b128 v56, v[64:67] offset:0
v_mfma_f32_16x16x32_bf16 v[112:115], a[236:239], v[128:131], v[112:115]
v_mfma_f32_16x16x32_bf16 v[68:71], a[208:211], v[228:231], v[68:71]
ds_write_b128 v57, v[80:83] offset:1024
s_waitcnt vmcnt(2)
v_mfma_f32_16x16x32_bf16 v[68:71], a[224:227], v[132:135], v[68:71]
v_mfma_f32_16x16x32_bf16 v[84:87], a[212:215], v[228:231], v[84:87]
ds_write_b128 v58, v[96:99] offset:2048
v_mfma_f32_16x16x32_bf16 v[84:87], a[228:231], v[132:135], v[84:87]
v_mfma_f32_16x16x32_bf16 v[100:103], a[216:219], v[228:231], v[100:103]
ds_write_b128 v59, v[112:115] offset:3072
v_mfma_f32_16x16x32_bf16 v[100:103], a[232:235], v[132:135], v[100:103]
v_mfma_f32_16x16x32_bf16 v[116:119], a[220:223], v[228:231], v[116:119]
s_nop 0
ds_write_b128 v56, v[68:71] offset:4096
v_mfma_f32_16x16x32_bf16 v[116:119], a[236:239], v[132:135], v[116:119]
v_mfma_f32_16x16x32_bf16 v[72:75], a[208:211], v[232:235], v[72:75]
ds_write_b128 v57, v[84:87] offset:5120
s_waitcnt vmcnt(1)
v_mfma_f32_16x16x32_bf16 v[72:75], a[224:227], v[136:139], v[72:75]
v_mfma_f32_16x16x32_bf16 v[88:91], a[212:215], v[232:235], v[88:91]
ds_write_b128 v58, v[100:103] offset:6144
v_mfma_f32_16x16x32_bf16 v[88:91], a[228:231], v[136:139], v[88:91]
v_mfma_f32_16x16x32_bf16 v[104:107], a[216:219], v[232:235], v[104:107]
ds_write_b128 v59, v[116:119] offset:7168
v_mfma_f32_16x16x32_bf16 v[104:107], a[232:235], v[136:139], v[104:107]
v_mfma_f32_16x16x32_bf16 v[120:123], a[220:223], v[232:235], v[120:123]
s_nop 0
ds_write_b128 v56, v[72:75] offset:8192
v_mfma_f32_16x16x32_bf16 v[120:123], a[236:239], v[136:139], v[120:123]
v_mfma_f32_16x16x32_bf16 v[76:79], a[208:211], v[236:239], v[76:79]
ds_write_b128 v57, v[88:91] offset:9216
s_waitcnt vmcnt(0)
v_mfma_f32_16x16x32_bf16 v[76:79], a[224:227], v[140:143], v[76:79]
v_mfma_f32_16x16x32_bf16 v[92:95], a[212:215], v[236:239], v[92:95]
ds_write_b128 v58, v[104:107] offset:10240
v_mfma_f32_16x16x32_bf16 v[92:95], a[228:231], v[140:143], v[92:95]
v_mfma_f32_16x16x32_bf16 v[108:111], a[216:219], v[236:239], v[108:111]
ds_write_b128 v59, v[120:123] offset:11264
v_mfma_f32_16x16x32_bf16 v[108:111], a[232:235], v[140:143], v[108:111]
v_mfma_f32_16x16x32_bf16 v[124:127], a[220:223], v[236:239], v[124:127]
s_nop 0
ds_write_b128 v56, v[76:79] offset:24576
v_mfma_f32_16x16x32_bf16 v[124:127], a[236:239], v[140:143], v[124:127]
s_nop 0
ds_write_b128 v57, v[92:95] offset:25600
s_nop 1
ds_write_b128 v58, v[108:111] offset:26624
s_nop 2
ds_write_b128 v59, v[124:127] offset:27648
s_waitcnt lgkmcnt(0)
s_barrier
ds_read_b128 v[128:131], v36 offset:0
ds_read_b128 v[132:135], v36 offset:256
ds_read_b128 v[136:139], v36 offset:12288
ds_read_b128 v[140:143], v36 offset:12544
ds_read_b128 v[144:147], v38 offset:0
ds_read_b128 v[148:151], v38 offset:256
ds_read_b128 v[152:155], v38 offset:12288
ds_read_b128 v[156:159], v38 offset:12544
ds_read_b128 v[160:163], v37 offset:0
ds_read_b128 v[164:167], v37 offset:256
ds_read_b128 v[168:171], v37 offset:12288
ds_read_b128 v[172:175], v37 offset:12544
s_waitcnt lgkmcnt(11)
v_pk_add_f32 v[40:41], v[40:41], v[128:129]
v_pk_add_f32 v[42:43], v[42:43], v[130:131]
ds_read_b128 v[176:179], v39 offset:0
s_waitcnt lgkmcnt(11)
v_pk_add_f32 v[44:45], v[44:45], v[132:133]
v_pk_add_f32 v[46:47], v[46:47], v[134:135]
ds_read_b128 v[180:183], v39 offset:256
s_waitcnt lgkmcnt(11)
v_pk_add_f32 v[40:41], v[40:41], v[136:137]
v_pk_add_f32 v[42:43], v[42:43], v[138:139]
ds_read_b128 v[184:187], v39 offset:12288
s_waitcnt lgkmcnt(11)
v_pk_add_f32 v[44:45], v[44:45], v[140:141]
v_pk_add_f32 v[46:47], v[46:47], v[142:143]
ds_read_b128 v[188:191], v39 offset:12544
s_waitcnt lgkmcnt(11)
v_pk_add_f32 v[40:41], v[40:41], v[144:145]
v_pk_add_f32 v[42:43], v[42:43], v[146:147]
s_waitcnt lgkmcnt(10)
v_pk_add_f32 v[44:45], v[44:45], v[148:149]
v_pk_add_f32 v[46:47], v[46:47], v[150:151]
s_waitcnt lgkmcnt(9)
v_pk_add_f32 v[40:41], v[40:41], v[152:153]
v_pk_add_f32 v[42:43], v[42:43], v[154:155]
s_waitcnt lgkmcnt(8)
v_pk_add_f32 v[44:45], v[44:45], v[156:157]
v_pk_add_f32 v[46:47], v[46:47], v[158:159]
v_cvt_pk_bf16_f32 v28, v40, v41
v_cvt_pk_bf16_f32 v29, v42, v43
v_cvt_pk_bf16_f32 v30, v44, v45
v_cvt_pk_bf16_f32 v31, v46, v47
buffer_store_dwordx4 v[28:31], v247, s[56:59], 0 offen sc1 nt
s_waitcnt lgkmcnt(7)
v_pk_add_f32 v[48:49], v[48:49], v[160:161]
v_pk_add_f32 v[50:51], v[50:51], v[162:163]
s_waitcnt lgkmcnt(6)
v_pk_add_f32 v[52:53], v[52:53], v[164:165]
v_pk_add_f32 v[54:55], v[54:55], v[166:167]
s_waitcnt lgkmcnt(5)
v_pk_add_f32 v[48:49], v[48:49], v[168:169]
v_pk_add_f32 v[50:51], v[50:51], v[170:171]
s_waitcnt lgkmcnt(4)
v_pk_add_f32 v[52:53], v[52:53], v[172:173]
v_pk_add_f32 v[54:55], v[54:55], v[174:175]
s_waitcnt lgkmcnt(3)
v_pk_add_f32 v[48:49], v[48:49], v[176:177]
v_pk_add_f32 v[50:51], v[50:51], v[178:179]
s_waitcnt lgkmcnt(2)
v_pk_add_f32 v[52:53], v[52:53], v[180:181]
v_pk_add_f32 v[54:55], v[54:55], v[182:183]
s_waitcnt lgkmcnt(1)
v_pk_add_f32 v[48:49], v[48:49], v[184:185]
v_pk_add_f32 v[50:51], v[50:51], v[186:187]
s_waitcnt lgkmcnt(0)
v_pk_add_f32 v[52:53], v[52:53], v[188:189]
v_pk_add_f32 v[54:55], v[54:55], v[190:191]
v_cvt_pk_bf16_f32 v32, v48, v49
v_cvt_pk_bf16_f32 v33, v50, v51
v_cvt_pk_bf16_f32 v34, v52, v53
v_cvt_pk_bf16_f32 v35, v54, v55
buffer_store_dwordx4 v[32:35], v9, s[56:59], 0 offen sc1 nt
s_endpgm
L_g2:
s_lshr_b32 s18, s26, 1
s_and_b32 s19, s26, 1
s_and_b32 s6, s5, 3
s_and_b32 s3, s4, 1
s_lshr_b32 s68, s4, 1
s_bfe_u32 s69, s5, 0x20002
s_lshl2_add_u32 s7, s68, s69
s_cmp_eq_u32 s7, 15
s_cbranch_scc1 L_spare
s_add_u32 s10, s6, s7
s_lshl_b32 s10, s10, 1
s_and_b32 s10, s10, 7
s_mul_i32 s68, s7, 192
v_mul_u32_u24 v4, 171, v2
v_lshrrev_b32 v4, 11, v4
v_mul_u32_u24 v4, 2560, v4
v_lshl_add_u32 v4, v2, 4, v4
v_add_u32 v34, s68, v4
v_add_u32 v3, 64, v2
v_mul_u32_u24 v4, 171, v3
v_lshrrev_b32 v4, 11, v4
v_mul_u32_u24 v5, 12, v4
v_sub_u32 v5, v3, v5
v_lshrrev_b32 v6, 3, v4
v_lshlrev_b32 v6, 1, v6
v_xor_b32 v5, v5, v6
v_mul_u32_u24 v4, 2752, v4
v_lshl_add_u32 v4, v5, 4, v4
v_subrev_u32 v4, 1024, v4
v_add_u32 v35, s68, v4
v_add_u32 v3, 128, v2
v_mul_u32_u24 v4, 171, v3
v_lshrrev_b32 v4, 11, v4
v_mul_u32_u24 v5, 12, v4
v_sub_u32 v5, v3, v5
v_lshrrev_b32 v6, 3, v4
v_lshlrev_b32 v6, 1, v6
v_xor_b32 v5, v5, v6
v_mul_u32_u24 v4, 2752, v4
v_lshl_add_u32 v4, v5, 4, v4
v_subrev_u32 v4, 2048, v4
v_add_u32 v36, s68, v4
s_lshl1_add_u32 s21, s3, s18
s_lshl3_add_u32 s68, s21, s10
s_lshl2_add_u32 s68, s68, s19
s_mul_i32 s13, s68, 44032
s_mul_i32 s24, s18, 73728
s_mul_i32 s15, s19, 3072
s_add_u32 s15, s15, s24
s_mov_b32 s42, 5636096
s_mov_b32 s43, 0x20000
s_waitcnt lgkmcnt(0)
s_mov_b64 s[40:41], s[84:85]
s_add_u32 m0, s15, 0
s_nop 0
buffer_load_dwordx4 v34, s[40:43], s13 offen offset:0 lds
buffer_load_dwordx4 v35, s[40:43], s13 offen offset:1024 lds
buffer_load_dwordx4 v36, s[40:43], s13 offen offset:2048 lds
s_add_u32 s13, s13, 88064
s_add_u32 m0, s15, 6144
s_nop 0
buffer_load_dwordx4 v34, s[40:43], s13 offen offset:0 lds
buffer_load_dwordx4 v35, s[40:43], s13 offen offset:1024 lds
buffer_load_dwordx4 v36, s[40:43], s13 offen offset:2048 lds
s_add_u32 s13, s13, 88064
s_mov_b64 s[28:29], s[76:77]
s_mov_b64 s[32:33], s[78:79]
s_mov_b64 s[36:37], s[80:81]
s_mov_b64 s[44:45], s[86:87]
s_mov_b64 s[48:49], s[88:89]
s_mov_b64 s[52:53], s[90:91]
s_mov_b32 s22, 6905728
s_mov_b32 s23, 11534336
s_load_dword s27, s[64:65], s22
s_load_dword s82, s[64:65], s23
s_mov_b32 s30, 2097152
s_mov_b32 s31, 0x20000
s_mov_b32 s34, 1572864
s_mov_b32 s35, 0x20000
s_mov_b32 s66, 11534464
s_mov_b32 s67, 0x20000
s_mov_b32 s38, 524288
s_mov_b32 s39, 0x20000
s_mov_b32 s46, 2752
s_mov_b32 s47, 0x20000
s_mov_b32 s50, 5636096
s_mov_b32 s51, 0x20000
s_mov_b32 s54, 4096
s_mov_b32 s55, 0x20000
s_mov_b32 s58, 2097152
s_mov_b32 s59, 0x20000
s_lshl_b32 s11, s4, 11
s_lshr_b32 s18, s26, 1
s_and_b32 s19, s26, 1
s_and_b32 s68, s5, 7
s_lshr_b32 s8, s4, 1
s_lshl3_add_u32 s8, s8, s68
s_lshr_b32 s9, s5, 3
s_and_b32 s68, s5, 1
s_lshl1_add_u32 s9, s68, s9
s_and_b32 s9, s9, 3
s_and_b32 s68, s4, 1
s_lshl2_add_u32 s9, s68, s9
s_lshr_b32 s62, s26, 1
s_mul_i32 s62, s62, 73728
s_and_b32 s69, s26, 1
s_mul_i32 s69, s69, 12288
s_add_u32 s62, s62, s69
v_lshrrev_b32 v3, 3, v2
v_and_b32 v4, 7, v2
v_lshrrev_b32 v5, 4, v2
v_lshlrev_b32 v6, 1, v5
v_xor_b32 v6, v4, v6
v_lshlrev_b32 v6, 4, v6
s_lshl_b32 s68, s8, 7
v_lshl_add_u32 v240, v3, 12, v6
v_add_u32 v240, s68, v240
v_add_u32 v241, 31744, v240
s_lshl_b32 s69, s9, 7
v_lshl_add_u32 v242, v3, 10, v6
v_add_u32 v242, s69, v242
v_add_u32 v243, 7168, v242
s_lshl2_add_u32 s68, s8, s26
s_lshl_b32 s68, s68, 14
s_add_u32 s68, s68, s69
v_lshl_add_u32 v3, v3, 10, s68
v_lshl_add_u32 v247, v4, 4, v3
s_mul_i32 s68, s26, 11
s_add_u32 s69, s68, 11
s_min_u32 s69, s69, 43
s_lshl_b32 s0, s68, 17
s_lshl_b32 s1, s69, 17
s_and_b32 s70, s9, 1
s_lshl_b32 s70, s70, 2
s_and_b32 s71, s9, 2
s_add_u32 s70, s70, s71
s_add_u32 s70, s70, s8
s_and_b32 s71, s4, 1
s_lshl1_add_u32 s70, s71, s70
s_and_b32 s70, s70, 7
s_mul_i32 s70, s70, 10
s_lshr_b32 s70, s70, 3
s_add_u32 s68, s68, s70
s_lshl_b32 s60, s68, 17
s_lshl_b32 s63, s68, 10
s_add_u32 s70, s9, s8
s_lshl_b32 s70, s70, 1
s_and_b32 s83, s70, 6
v_bfe_u32 v3, v2, 2, 2
v_lshl_add_u32 v3, v5, 2, v3
v_bfe_u32 v4, v3, 1, 2
v_lshlrev_b32 v3, 7, v3
v_and_b32 v6, 3, v2
v_lshl_add_u32 v3, v6, 3, v3
v_add_u32 v3, s62, v3
v_xor_b32 v6, 0, v4
v_lshl_add_u32 v248, v6, 5, v3
v_xor_b32 v6, 1, v4
v_lshl_add_u32 v249, v6, 5, v3
v_xor_b32 v6, 2, v4
v_lshl_add_u32 v250, v6, 5, v3
v_xor_b32 v6, 3, v4
v_lshl_add_u32 v251, v6, 5, v3
v_lshlrev_b32 v246, 4, v2
v_lshrrev_b32 v4, 4, v2
s_mul_i32 s68, s7, 192
v_lshlrev_b32 v3, 3, v4
buffer_load_dwordx2 v[10:11], v3, s[44:47], s68 offen offset:0
buffer_load_dwordx2 v[12:13], v3, s[44:47], s68 offen offset:32
buffer_load_dwordx2 v[14:15], v3, s[44:47], s68 offen offset:64
buffer_load_dwordx2 v[16:17], v3, s[44:47], s68 offen offset:96
buffer_load_dwordx2 v[18:19], v3, s[44:47], s68 offen offset:128
buffer_load_dwordx2 v[20:21], v3, s[44:47], s68 offen offset:160
s_lshl_b32 s16, s21, 19
v_and_b32 v3, 15, v2
s_lshl1_add_u32 s68, s6, s19
s_lshl1_add_u32 s68, s68, s3
s_lshl1_add_u32 s68, s68, s18
s_lshl_b32 s69, s68, 8
s_nop 0
v_lshl_add_u32 v3, v3, 4, s69
v_lshl_add_u32 v27, v4, 13, v3
v_xor_b32 v26, 256, v27
v_xor_b32 v23, 512, v27
v_xor_b32 v22, 512, v26
v_add_u32 v24, 32768, v22
v_add_u32 v25, 32768, v23
v_add_u32 v28, 32768, v26
v_add_u32 v29, 32768, v27
s_mul_i32 s68, s68, 43
s_mul_i32 s72, s7, 3
s_add_u32 s68, s68, s72
s_lshl_b32 s68, s68, 10
s_add_u32 s73, s68, 4194304
v_bfe_u32 v3, v2, 2, 2
v_and_b32 v5, 1, v4
v_lshl_add_u32 v3, v5, 3, v3
v_mul_u32_u24 v3, 192, v3
v_lshrrev_b32 v6, 1, v4
v_mul_u32_u24 v6, 3072, v6
v_and_b32 v4, 3, v2
v_lshl_add_u32 v3, v4, 3, v3
v_add3_u32 v3, v3, v6, s24
v_lshl_add_u32 v43, v5, 5, v3
v_xor_b32 v5, 1, v5
v_lshl_add_u32 v44, v5, 5, v3
v_add_u32 v45, 36864, v43
v_add_u32 v46, 36864, v44
s_mul_i32 s68, s19, 6144
s_add_u32 s68, s68, 24576
s_add_u32 s69, s68, s24
v_add_u32 v47, s69, v246
s_sub_u32 s69, 73728, s24
s_add_u32 s69, s69, s68
v_add_u32 v48, s69, v246
s_lshl4_add_u32 s20, s6, s7
s_lshl1_add_u32 s20, s20, s3
s_lshl2_add_u32 s70, s12, s26
s_xor_b32 s75, s70, 64
s_lshl_b32 s76, s70, 13
s_add_u32 s76, s76, 7340032
s_add_u32 s77, s76, 4096
s_lshl_b32 s78, s75, 13
s_add_u32 s78, s78, 7340032
s_add_u32 s79, s78, 4096
s_mov_b32 s80, 0xbdd2d3e8
s_mov_b32 s81, 0xc0135761
s_waitcnt lgkmcnt(0)
s_mul_i32 s27, s27, 0x9E3779B1
s_mul_i32 s82, s82, 0x85EBCA6C
s_add_u32 s27, s27, s82
s_add_u32 s27, s27, 0x7F4A7C15
s_cmp_lg_u32 s26, 0
s_cbranch_scc1 L_pub_20
s_lshl_b32 s68, s12, 4
s_add_u32 s68, s68, 6987776
v_lshlrev_b32 v3, 11, v2
v_mov_b32 v4, s27
s_mov_b64 exec, 1
buffer_store_dword v4, v3, s[64:67], s68 offen sc1
s_mov_b64 exec, -1
L_pub_20:
v_mov_b32 v211, s27
v_mov_b32 v215, s27
v_mov_b32 v219, s27
v_mov_b32 v223, s27
s_add_u32 m0, s15, 12288
s_nop 0
buffer_load_dwordx4 v34, s[40:43], s13 offen offset:0 lds
v_mov_b32 v227, s27
v_mov_b32 v231, s27
v_mov_b32 v235, s27
v_mov_b32 v239, s27
buffer_load_dwordx4 v35, s[40:43], s13 offen offset:1024 lds
buffer_load_dwordx4 v36, s[40:43], s13 offen offset:2048 lds
s_add_u32 s13, s13, 88064
s_add_u32 m0, s15, 18432
s_nop 0
buffer_load_dwordx4 v34, s[40:43], s13 offen offset:0 lds
buffer_load_dwordx4 v35, s[40:43], s13 offen offset:1024 lds
buffer_load_dwordx4 v36, s[40:43], s13 offen offset:2048 lds
s_add_u32 s13, s13, 88064
s_cmp_eq_u32 s10, 6
s_cselect_b32 s17, 1409024, 0
s_sub_u32 s13, s13, s17
s_add_u32 m0, s15, 24576
s_nop 0
buffer_load_dwordx4 v34, s[40:43], s13 offen offset:0 lds
buffer_load_dwordx4 v35, s[40:43], s13 offen offset:1024 lds
buffer_load_dwordx4 v36, s[40:43], s13 offen offset:2048 lds
s_add_u32 s13, s13, 88064
s_add_u32 m0, s15, 30720
s_nop 0
buffer_load_dwordx4 v34, s[40:43], s13 offen offset:0 lds
buffer_load_dwordx4 v35, s[40:43], s13 offen offset:1024 lds
buffer_load_dwordx4 v36, s[40:43], s13 offen offset:2048 lds
s_add_u32 s13, s13, 88064
s_add_u32 m0, s15, 36864
s_nop 0
buffer_load_dwordx4 v34, s[40:43], s13 offen offset:0 lds
buffer_load_dwordx4 v35, s[40:43], s13 offen offset:1024 lds
buffer_load_dwordx4 v36, s[40:43], s13 offen offset:2048 lds
s_add_u32 s13, s13, 88064
s_add_u32 m0, s15, 43008
s_nop 0
buffer_load_dwordx4 v34, s[40:43], s13 offen offset:0 lds
buffer_load_dwordx4 v35, s[40:43], s13 offen offset:1024 lds
buffer_load_dwordx4 v36, s[40:43], s13 offen offset:2048 lds
s_add_u32 s13, s13, 88064
s_cmp_eq_u32 s10, 4
s_cselect_b32 s17, 1409024, 0
s_sub_u32 s13, s13, s17
s_add_u32 m0, s15, 49152
s_nop 0
buffer_load_dwordx4 v34, s[40:43], s13 offen offset:0 lds
buffer_load_dwordx4 v35, s[40:43], s13 offen offset:1024 lds
buffer_load_dwordx4 v36, s[40:43], s13 offen offset:2048 lds
s_add_u32 s13, s13, 88064
s_waitcnt vmcnt(21)
v_lshlrev_b32 v160, 16, v10
v_and_b32 v161, 0xffff0000, v10
v_lshlrev_b32 v162, 16, v11
v_and_b32 v163, 0xffff0000, v11
s_add_u32 m0, s15, 55296
s_nop 0
buffer_load_dwordx4 v34, s[40:43], s13 offen offset:0 lds
v_lshlrev_b32 v164, 16, v12
v_and_b32 v165, 0xffff0000, v12
v_lshlrev_b32 v166, 16, v13
v_and_b32 v167, 0xffff0000, v13
buffer_load_dwordx4 v35, s[40:43], s13 offen offset:1024 lds
v_lshlrev_b32 v168, 16, v14
v_and_b32 v169, 0xffff0000, v14
v_lshlrev_b32 v170, 16, v15
v_and_b32 v171, 0xffff0000, v15
buffer_load_dwordx4 v36, s[40:43], s13 offen offset:2048 lds
s_add_u32 s13, s13, 88064
v_lshlrev_b32 v172, 16, v16
v_and_b32 v173, 0xffff0000, v16
v_lshlrev_b32 v174, 16, v17
v_and_b32 v175, 0xffff0000, v17
s_add_u32 m0, s15, 61440
s_nop 0
buffer_load_dwordx4 v34, s[40:43], s13 offen offset:0 lds
v_lshlrev_b32 v176, 16, v18
v_and_b32 v177, 0xffff0000, v18
v_lshlrev_b32 v178, 16, v19
v_and_b32 v179, 0xffff0000, v19
buffer_load_dwordx4 v35, s[40:43], s13 offen offset:1024 lds
v_lshlrev_b32 v180, 16, v20
v_and_b32 v181, 0xffff0000, v20
v_lshlrev_b32 v182, 16, v21
v_and_b32 v183, 0xffff0000, v21
buffer_load_dwordx4 v36, s[40:43], s13 offen offset:2048 lds
s_add_u32 s13, s13, 88064
v_lshrrev_b32 v3, 9, v247
v_and_b32 v3, 0xffe, v3
v_add_u32 v4, 8192, v247
buffer_load_dwordx4 a[240:243], v247, s[28:31], 0 offen
buffer_load_dwordx4 a[244:247], v4, s[28:31], 0 offen
buffer_load_ushort v0, v3, s[52:55], 0 offen
buffer_load_ushort v1, v3, s[52:55], 0 offen offset:16
s_lshl_b32 s70, s21, 5
s_lshl_b32 s24, s70, 4
s_add_u32 s24, s24, 6905856
s_add_u32 s24, s24, s11
v_min_u32 v6, 31, v2
v_lshlrev_b32 v6, 4, v6
buffer_load_dword v7, v6, s[64:67], s24 offen sc1
s_add_u32 m0, s15, 67584
s_nop 0
buffer_load_dwordx4 v34, s[40:43], s13 offen offset:0 lds
buffer_load_dwordx4 v35, s[40:43], s13 offen offset:1024 lds
buffer_load_dwordx4 v36, s[40:43], s13 offen offset:2048 lds
s_add_u32 s13, s13, 88064
s_cmp_eq_u32 s10, 2
s_cselect_b32 s17, 1409024, 0
s_sub_u32 s13, s13, s17
s_mov_b32 s25, 0
s_waitcnt vmcnt(3)
L_poll_21:
v_cmp_ne_u32 vcc, s27, v7
s_cbranch_vccz L_polld_22
s_add_u32 s25, s25, 1
s_cmp_lt_u32 s25, 262144
s_cbranch_scc0 L_polld_22
s_sleep 1
buffer_load_dword v7, v6, s[64:67], s24 offen sc1
s_waitcnt vmcnt(0)
s_branch L_poll_21
L_polld_22:
s_add_u32 s14, s10, 0
s_and_b32 s14, s14, 7
s_lshl_b32 s14, s14, 16
s_add_u32 s14, s14, s16
buffer_load_dwordx4 a[104:107], v22, s[64:67], s14 offen sc1
buffer_load_dwordx4 a[108:111], v23, s[64:67], s14 offen sc1
buffer_load_dwordx4 a[112:115], v26, s[64:67], s14 offen sc1
buffer_load_dwordx4 a[116:119], v27, s[64:67], s14 offen sc1
buffer_load_dwordx4 a[120:123], v24, s[64:67], s14 offen sc1
buffer_load_dwordx4 a[124:127], v25, s[64:67], s14 offen sc1
buffer_load_dwordx4 a[128:131], v28, s[64:67], s14 offen sc1
buffer_load_dwordx4 a[132:135], v29, s[64:67], s14 offen sc1
s_waitcnt vmcnt(8)
s_barrier
ds_read_b64_tr_b16 a[176:177], v43 offset:0
ds_read_b64_tr_b16 a[178:179], v43 offset:768
ds_read_b64_tr_b16 a[180:181], v44 offset:0
ds_read_b64_tr_b16 a[182:183], v44 offset:768
ds_read_b64_tr_b16 a[184:185], v43 offset:64
ds_read_b64_tr_b16 a[186:187], v43 offset:832
ds_read_b64_tr_b16 a[188:189], v44 offset:64
ds_read_b64_tr_b16 a[190:191], v44 offset:832
ds_read_b64_tr_b16 a[192:193], v43 offset:128
ds_read_b64_tr_b16 a[194:195], v43 offset:896
ds_read_b64_tr_b16 a[196:197], v44 offset:128
ds_read_b64_tr_b16 a[198:199], v44 offset:896
s_waitcnt vmcnt(6) lgkmcnt(8)
v_mfma_f32_16x16x32_bf16 v[64:67], a[176:179], a[104:107], 0
ds_read_b64_tr_b16 a[200:201], v43 offset:6144
v_mfma_f32_16x16x32_bf16 v[88:91], a[176:179], a[108:111], 0
ds_read_b64_tr_b16 a[202:203], v43 offset:6912
s_add_u32 s14, s10, 1
s_and_b32 s14, s14, 7
s_lshl_b32 s14, s14, 16
s_add_u32 s14, s14, s16
buffer_load_dwordx4 a[136:139], v22, s[64:67], s14 offen sc1
v_mfma_f32_16x16x32_bf16 v[92:95], a[180:183], a[108:111], 0
ds_read_b64_tr_b16 a[204:205], v44 offset:6144
v_mfma_f32_16x16x32_bf16 v[68:71], a[180:183], a[104:107], 0
ds_read_b64_tr_b16 a[206:207], v44 offset:6912
s_waitcnt lgkmcnt(8)
v_mfma_f32_16x16x32_bf16 v[72:75], a[184:187], a[104:107], 0
ds_read_b64_tr_b16 a[208:209], v43 offset:6208
v_mfma_f32_16x16x32_bf16 v[96:99], a[184:187], a[108:111], 0
ds_read_b64_tr_b16 a[210:211], v43 offset:6976
buffer_load_dwordx4 a[140:143], v23, s[64:67], s14 offen sc1
v_mfma_f32_16x16x32_bf16 v[100:103], a[188:191], a[108:111], 0
ds_read_b64_tr_b16 a[212:213], v44 offset:6208
v_mfma_f32_16x16x32_bf16 v[76:79], a[188:191], a[104:107], 0
ds_read_b64_tr_b16 a[214:215], v44 offset:6976
s_waitcnt lgkmcnt(8)
v_mfma_f32_16x16x32_bf16 v[80:83], a[192:195], a[104:107], 0
ds_read_b64_tr_b16 a[216:217], v43 offset:6272
v_mfma_f32_16x16x32_bf16 v[104:107], a[192:195], a[108:111], 0
ds_read_b64_tr_b16 a[218:219], v43 offset:7040
buffer_load_dwordx4 a[144:147], v26, s[64:67], s14 offen sc1
v_mfma_f32_16x16x32_bf16 v[108:111], a[196:199], a[108:111], 0
ds_read_b64_tr_b16 a[220:221], v44 offset:6272
v_mfma_f32_16x16x32_bf16 v[84:87], a[196:199], a[104:107], 0
ds_read_b64_tr_b16 a[222:223], v44 offset:7040
s_waitcnt vmcnt(7)
v_mfma_f32_16x16x32_bf16 v[112:115], a[176:179], a[112:115], 0
v_mfma_f32_16x16x32_bf16 v[136:139], a[176:179], a[116:119], 0
buffer_load_dwordx4 a[148:151], v27, s[64:67], s14 offen sc1
v_mfma_f32_16x16x32_bf16 v[140:143], a[180:183], a[116:119], 0
v_mfma_f32_16x16x32_bf16 v[116:119], a[180:183], a[112:115], 0
v_mfma_f32_16x16x32_bf16 v[120:123], a[184:187], a[112:115], 0
v_mfma_f32_16x16x32_bf16 v[144:147], a[184:187], a[116:119], 0
buffer_load_dwordx4 a[152:155], v24, s[64:67], s14 offen sc1
v_mfma_f32_16x16x32_bf16 v[148:151], a[188:191], a[116:119], 0
v_mfma_f32_16x16x32_bf16 v[124:127], a[188:191], a[112:115], 0
v_mfma_f32_16x16x32_bf16 v[128:131], a[192:195], a[112:115], 0
v_mfma_f32_16x16x32_bf16 v[152:155], a[192:195], a[116:119], 0
buffer_load_dwordx4 a[156:159], v25, s[64:67], s14 offen sc1
v_mfma_f32_16x16x32_bf16 v[156:159], a[196:199], a[116:119], 0
v_mfma_f32_16x16x32_bf16 v[132:135], a[196:199], a[112:115], 0
s_waitcnt vmcnt(8) lgkmcnt(8)
v_mfma_f32_16x16x32_bf16 v[64:67], a[200:203], a[120:123], v[64:67]
ds_read_b64_tr_b16 a[176:177], v43 offset:12288
v_mfma_f32_16x16x32_bf16 v[88:91], a[200:203], a[124:127], v[88:91]
ds_read_b64_tr_b16 a[178:179], v43 offset:13056
buffer_load_dwordx4 a[160:163], v28, s[64:67], s14 offen sc1
v_mfma_f32_16x16x32_bf16 v[92:95], a[204:207], a[124:127], v[92:95]
ds_read_b64_tr_b16 a[180:181], v44 offset:12288
v_mfma_f32_16x16x32_bf16 v[68:71], a[204:207], a[120:123], v[68:71]
ds_read_b64_tr_b16 a[182:183], v44 offset:13056
s_waitcnt lgkmcnt(8)
v_mfma_f32_16x16x32_bf16 v[72:75], a[208:211], a[120:123], v[72:75]
ds_read_b64_tr_b16 a[184:185], v43 offset:12352
v_mfma_f32_16x16x32_bf16 v[96:99], a[208:211], a[124:127], v[96:99]
ds_read_b64_tr_b16 a[186:187], v43 offset:13120
buffer_load_dwordx4 a[164:167], v29, s[64:67], s14 offen sc1
v_mfma_f32_16x16x32_bf16 v[100:103], a[212:215], a[124:127], v[100:103]
ds_read_b64_tr_b16 a[188:189], v44 offset:12352
v_mfma_f32_16x16x32_bf16 v[76:79], a[212:215], a[120:123], v[76:79]
ds_read_b64_tr_b16 a[190:191], v44 offset:13120
s_waitcnt lgkmcnt(8)
v_mfma_f32_16x16x32_bf16 v[80:83], a[216:219], a[120:123], v[80:83]
ds_read_b64_tr_b16 a[192:193], v43 offset:12416
v_mfma_f32_16x16x32_bf16 v[104:107], a[216:219], a[124:127], v[104:107]
ds_read_b64_tr_b16 a[194:195], v43 offset:13184
s_add_u32 s14, s10, 2
s_and_b32 s14, s14, 7
s_lshl_b32 s14, s14, 16
s_add_u32 s14, s14, s16
buffer_load_dwordx4 a[168:171], v22, s[64:67], s14 offen sc1
v_mfma_f32_16x16x32_bf16 v[108:111], a[220:223], a[124:127], v[108:111]
ds_read_b64_tr_b16 a[196:197], v44 offset:12416
v_mfma_f32_16x16x32_bf16 v[84:87], a[220:223], a[120:123], v[84:87]
ds_read_b64_tr_b16 a[198:199], v44 offset:13184
s_waitcnt vmcnt(9)
v_mfma_f32_16x16x32_bf16 v[112:115], a[200:203], a[128:131], v[112:115]
v_mfma_f32_16x16x32_bf16 v[136:139], a[200:203], a[132:135], v[136:139]
buffer_load_dwordx4 a[172:175], v23, s[64:67], s14 offen sc1
v_mfma_f32_16x16x32_bf16 v[140:143], a[204:207], a[132:135], v[140:143]
v_mfma_f32_16x16x32_bf16 v[116:119], a[204:207], a[128:131], v[116:119]
v_mfma_f32_16x16x32_bf16 v[120:123], a[208:211], a[128:131], v[120:123]
v_mfma_f32_16x16x32_bf16 v[144:147], a[208:211], a[132:135], v[144:147]
buffer_load_dwordx4 a[104:107], v26, s[64:67], s14 offen sc1
v_mfma_f32_16x16x32_bf16 v[148:151], a[212:215], a[132:135], v[148:151]
v_mfma_f32_16x16x32_bf16 v[124:127], a[212:215], a[128:131], v[124:127]
v_mfma_f32_16x16x32_bf16 v[128:131], a[216:219], a[128:131], v[128:131]
v_mfma_f32_16x16x32_bf16 v[152:155], a[216:219], a[132:135], v[152:155]
buffer_load_dwordx4 a[108:111], v27, s[64:67], s14 offen sc1
v_mfma_f32_16x16x32_bf16 v[156:159], a[220:223], a[132:135], v[156:159]
v_mfma_f32_16x16x32_bf16 v[132:135], a[220:223], a[128:131], v[132:135]
s_waitcnt vmcnt(10) lgkmcnt(8)
v_mfma_f32_16x16x32_bf16 v[64:67], a[176:179], a[136:139], v[64:67]
ds_read_b64_tr_b16 a[200:201], v43 offset:18432
v_mfma_f32_16x16x32_bf16 v[88:91], a[176:179], a[140:143], v[88:91]
ds_read_b64_tr_b16 a[202:203], v43 offset:19200
buffer_load_dwordx4 a[112:115], v24, s[64:67], s14 offen sc1
v_mfma_f32_16x16x32_bf16 v[92:95], a[180:183], a[140:143], v[92:95]
ds_read_b64_tr_b16 a[204:205], v44 offset:18432
v_mfma_f32_16x16x32_bf16 v[68:71], a[180:183], a[136:139], v[68:71]
ds_read_b64_tr_b16 a[206:207], v44 offset:19200
s_waitcnt lgkmcnt(8)
v_mfma_f32_16x16x32_bf16 v[72:75], a[184:187], a[136:139], v[72:75]
ds_read_b64_tr_b16 a[208:209], v43 offset:18496
v_mfma_f32_16x16x32_bf16 v[96:99], a[184:187], a[140:143], v[96:99]
ds_read_b64_tr_b16 a[210:211], v43 offset:19264
buffer_load_dwordx4 a[116:119], v25, s[64:67], s14 offen sc1
v_mfma_f32_16x16x32_bf16 v[100:103], a[188:191], a[140:143], v[100:103]
ds_read_b64_tr_b16 a[212:213], v44 offset:18496
v_mfma_f32_16x16x32_bf16 v[76:79], a[188:191], a[136:139], v[76:79]
ds_read_b64_tr_b16 a[214:215], v44 offset:19264
s_waitcnt lgkmcnt(8)
v_mfma_f32_16x16x32_bf16 v[80:83], a[192:195], a[136:139], v[80:83]
ds_read_b64_tr_b16 a[216:217], v43 offset:18560
v_mfma_f32_16x16x32_bf16 v[104:107], a[192:195], a[140:143], v[104:107]
ds_read_b64_tr_b16 a[218:219], v43 offset:19328
buffer_load_dwordx4 a[120:123], v28, s[64:67], s14 offen sc1
v_mfma_f32_16x16x32_bf16 v[108:111], a[196:199], a[140:143], v[108:111]
ds_read_b64_tr_b16 a[220:221], v44 offset:18560
v_mfma_f32_16x16x32_bf16 v[84:87], a[196:199], a[136:139], v[84:87]
ds_read_b64_tr_b16 a[222:223], v44 offset:19328
s_waitcnt vmcnt(11)
v_mfma_f32_16x16x32_bf16 v[112:115], a[176:179], a[144:147], v[112:115]
v_mfma_f32_16x16x32_bf16 v[136:139], a[176:179], a[148:151], v[136:139]
buffer_load_dwordx4 a[124:127], v29, s[64:67], s14 offen sc1
v_mfma_f32_16x16x32_bf16 v[140:143], a[180:183], a[148:151], v[140:143]
v_mfma_f32_16x16x32_bf16 v[116:119], a[180:183], a[144:147], v[116:119]
v_mfma_f32_16x16x32_bf16 v[120:123], a[184:187], a[144:147], v[120:123]
v_mfma_f32_16x16x32_bf16 v[144:147], a[184:187], a[148:151], v[144:147]
s_add_u32 s14, s10, 3
s_and_b32 s14, s14, 7
s_lshl_b32 s14, s14, 16
s_add_u32 s14, s14, s16
buffer_load_dwordx4 a[128:131], v22, s[64:67], s14 offen sc1
v_mfma_f32_16x16x32_bf16 v[148:151], a[188:191], a[148:151], v[148:151]
v_mfma_f32_16x16x32_bf16 v[124:127], a[188:191], a[144:147], v[124:127]
v_mfma_f32_16x16x32_bf16 v[128:131], a[192:195], a[144:147], v[128:131]
v_mfma_f32_16x16x32_bf16 v[152:155], a[192:195], a[148:151], v[152:155]
buffer_load_dwordx4 a[132:135], v23, s[64:67], s14 offen sc1
v_mfma_f32_16x16x32_bf16 v[156:159], a[196:199], a[148:151], v[156:159]
v_mfma_f32_16x16x32_bf16 v[132:135], a[196:199], a[144:147], v[132:135]
s_waitcnt vmcnt(12) lgkmcnt(8)
v_mfma_f32_16x16x32_bf16 v[64:67], a[200:203], a[152:155], v[64:67]
ds_read_b64_tr_b16 a[176:177], v43 offset:24576
v_mfma_f32_16x16x32_bf16 v[88:91], a[200:203], a[156:159], v[88:91]
ds_read_b64_tr_b16 a[178:179], v43 offset:25344
buffer_load_dwordx4 a[136:139], v24, s[64:67], s14 offen sc1
v_mfma_f32_16x16x32_bf16 v[92:95], a[204:207], a[156:159], v[92:95]
ds_read_b64_tr_b16 a[180:181], v44 offset:24576
v_mfma_f32_16x16x32_bf16 v[68:71], a[204:207], a[152:155], v[68:71]
ds_read_b64_tr_b16 a[182:183], v44 offset:25344
s_waitcnt lgkmcnt(8)
v_mfma_f32_16x16x32_bf16 v[72:75], a[208:211], a[152:155], v[72:75]
ds_read_b64_tr_b16 a[184:185], v43 offset:24640
v_mfma_f32_16x16x32_bf16 v[96:99], a[208:211], a[156:159], v[96:99]
ds_read_b64_tr_b16 a[186:187], v43 offset:25408
buffer_load_dwordx4 a[140:143], v25, s[64:67], s14 offen sc1
v_mfma_f32_16x16x32_bf16 v[100:103], a[212:215], a[156:159], v[100:103]
ds_read_b64_tr_b16 a[188:189], v44 offset:24640
v_mfma_f32_16x16x32_bf16 v[76:79], a[212:215], a[152:155], v[76:79]
ds_read_b64_tr_b16 a[190:191], v44 offset:25408
s_waitcnt lgkmcnt(8)
v_mfma_f32_16x16x32_bf16 v[80:83], a[216:219], a[152:155], v[80:83]
ds_read_b64_tr_b16 a[192:193], v43 offset:24704
v_mfma_f32_16x16x32_bf16 v[104:107], a[216:219], a[156:159], v[104:107]
ds_read_b64_tr_b16 a[194:195], v43 offset:25472
s_add_u32 s14, s10, 4
s_and_b32 s14, s14, 7
s_lshl_b32 s14, s14, 16
s_add_u32 s14, s14, s16
buffer_load_dwordx4 a[144:147], v22, s[64:67], s14 offen sc1
v_mfma_f32_16x16x32_bf16 v[108:111], a[220:223], a[156:159], v[108:111]
ds_read_b64_tr_b16 a[196:197], v44 offset:24704
v_mfma_f32_16x16x32_bf16 v[84:87], a[220:223], a[152:155], v[84:87]
ds_read_b64_tr_b16 a[198:199], v44 offset:25472
s_barrier
s_waitcnt vmcnt(13)
v_mfma_f32_16x16x32_bf16 v[112:115], a[200:203], a[160:163], v[112:115]
v_mfma_f32_16x16x32_bf16 v[136:139], a[200:203], a[164:167], v[136:139]
s_add_u32 m0, s15, 0
s_nop 0
buffer_load_dwordx4 v34, s[40:43], s13 offen offset:0 lds
v_mfma_f32_16x16x32_bf16 v[140:143], a[204:207], a[164:167], v[140:143]
v_mfma_f32_16x16x32_bf16 v[116:119], a[204:207], a[160:163], v[116:119]
v_mfma_f32_16x16x32_bf16 v[120:123], a[208:211], a[160:163], v[120:123]
v_mfma_f32_16x16x32_bf16 v[144:147], a[208:211], a[164:167], v[144:147]
buffer_load_dwordx4 v35, s[40:43], s13 offen offset:1024 lds
v_mfma_f32_16x16x32_bf16 v[148:151], a[212:215], a[164:167], v[148:151]
v_mfma_f32_16x16x32_bf16 v[124:127], a[212:215], a[160:163], v[124:127]
v_mfma_f32_16x16x32_bf16 v[128:131], a[216:219], a[160:163], v[128:131]
v_mfma_f32_16x16x32_bf16 v[152:155], a[216:219], a[164:167], v[152:155]
buffer_load_dwordx4 v36, s[40:43], s13 offen offset:2048 lds
s_add_u32 s13, s13, 88064
v_mfma_f32_16x16x32_bf16 v[156:159], a[220:223], a[164:167], v[156:159]
v_mfma_f32_16x16x32_bf16 v[132:135], a[220:223], a[160:163], v[132:135]
s_waitcnt vmcnt(14) lgkmcnt(8)
v_mfma_f32_16x16x32_bf16 v[64:67], a[176:179], a[168:171], v[64:67]
ds_read_b64_tr_b16 a[200:201], v43 offset:30720
v_mfma_f32_16x16x32_bf16 v[88:91], a[176:179], a[172:175], v[88:91]
ds_read_b64_tr_b16 a[202:203], v43 offset:31488
s_add_u32 m0, s15, 6144
s_nop 0
buffer_load_dwordx4 v34, s[40:43], s13 offen offset:0 lds
v_mfma_f32_16x16x32_bf16 v[92:95], a[180:183], a[172:175], v[92:95]
ds_read_b64_tr_b16 a[204:205], v44 offset:30720
v_mfma_f32_16x16x32_bf16 v[68:71], a[180:183], a[168:171], v[68:71]
ds_read_b64_tr_b16 a[206:207], v44 offset:31488
s_waitcnt lgkmcnt(8)
v_mfma_f32_16x16x32_bf16 v[72:75], a[184:187], a[168:171], v[72:75]
ds_read_b64_tr_b16 a[208:209], v43 offset:30784
v_mfma_f32_16x16x32_bf16 v[96:99], a[184:187], a[172:175], v[96:99]
ds_read_b64_tr_b16 a[210:211], v43 offset:31552
buffer_load_dwordx4 v35, s[40:43], s13 offen offset:1024 lds
v_mfma_f32_16x16x32_bf16 v[100:103], a[188:191], a[172:175], v[100:103]
ds_read_b64_tr_b16 a[212:213], v44 offset:30784
v_mfma_f32_16x16x32_bf16 v[76:79], a[188:191], a[168:171], v[76:79]
ds_read_b64_tr_b16 a[214:215], v44 offset:31552
s_waitcnt lgkmcnt(8)
v_mfma_f32_16x16x32_bf16 v[80:83], a[192:195], a[168:171], v[80:83]
ds_read_b64_tr_b16 a[216:217], v43 offset:30848
v_mfma_f32_16x16x32_bf16 v[104:107], a[192:195], a[172:175], v[104:107]
ds_read_b64_tr_b16 a[218:219], v43 offset:31616
buffer_load_dwordx4 v36, s[40:43], s13 offen offset:2048 lds
s_add_u32 s13, s13, 88064
v_mfma_f32_16x16x32_bf16 v[108:111], a[196:199], a[172:175], v[108:111]
ds_read_b64_tr_b16 a[220:221], v44 offset:30848
v_mfma_f32_16x16x32_bf16 v[84:87], a[196:199], a[168:171], v[84:87]
ds_read_b64_tr_b16 a[222:223], v44 offset:31616
s_waitcnt vmcnt(15)
v_mfma_f32_16x16x32_bf16 v[112:115], a[176:179], a[104:107], v[112:115]
v_mfma_f32_16x16x32_bf16 v[136:139], a[176:179], a[108:111], v[136:139]
s_add_u32 m0, s15, 12288
s_nop 0
buffer_load_dwordx4 v34, s[40:43], s13 offen offset:0 lds
v_mfma_f32_16x16x32_bf16 v[140:143], a[180:183], a[108:111], v[140:143]
v_mfma_f32_16x16x32_bf16 v[116:119], a[180:183], a[104:107], v[116:119]
v_mfma_f32_16x16x32_bf16 v[120:123], a[184:187], a[104:107], v[120:123]
v_mfma_f32_16x16x32_bf16 v[144:147], a[184:187], a[108:111], v[144:147]
buffer_load_dwordx4 v35, s[40:43], s13 offen offset:1024 lds
v_mfma_f32_16x16x32_bf16 v[148:151], a[188:191], a[108:111], v[148:151]
v_mfma_f32_16x16x32_bf16 v[124:127], a[188:191], a[104:107], v[124:127]
v_mfma_f32_16x16x32_bf16 v[128:131], a[192:195], a[104:107], v[128:131]
v_mfma_f32_16x16x32_bf16 v[152:155], a[192:195], a[108:111], v[152:155]
buffer_load_dwordx4 v36, s[40:43], s13 offen offset:2048 lds
s_add_u32 s13, s13, 88064
v_mfma_f32_16x16x32_bf16 v[156:159], a[196:199], a[108:111], v[156:159]
v_mfma_f32_16x16x32_bf16 v[132:135], a[196:199], a[104:107], v[132:135]
s_waitcnt vmcnt(16) lgkmcnt(8)
v_mfma_f32_16x16x32_bf16 v[64:67], a[200:203], a[112:115], v[64:67]
ds_read_b64_tr_b16 a[176:177], v45 offset:0
v_mfma_f32_16x16x32_bf16 v[88:91], a[200:203], a[116:119], v[88:91]
ds_read_b64_tr_b16 a[178:179], v45 offset:768
s_add_u32 m0, s15, 18432
s_nop 0
buffer_load_dwordx4 v34, s[40:43], s13 offen offset:0 lds
v_mfma_f32_16x16x32_bf16 v[92:95], a[204:207], a[116:119], v[92:95]
ds_read_b64_tr_b16 a[180:181], v46 offset:0
v_mfma_f32_16x16x32_bf16 v[68:71], a[204:207], a[112:115], v[68:71]
ds_read_b64_tr_b16 a[182:183], v46 offset:768
s_waitcnt lgkmcnt(8)
v_mfma_f32_16x16x32_bf16 v[72:75], a[208:211], a[112:115], v[72:75]
ds_read_b64_tr_b16 a[184:185], v45 offset:64
v_mfma_f32_16x16x32_bf16 v[96:99], a[208:211], a[116:119], v[96:99]
ds_read_b64_tr_b16 a[186:187], v45 offset:832
buffer_load_dwordx4 v35, s[40:43], s13 offen offset:1024 lds
v_mfma_f32_16x16x32_bf16 v[100:103], a[212:215], a[116:119], v[100:103]
ds_read_b64_tr_b16 a[188:189], v46 offset:64
v_mfma_f32_16x16x32_bf16 v[76:79], a[212:215], a[112:115], v[76:79]
ds_read_b64_tr_b16 a[190:191], v46 offset:832
s_waitcnt lgkmcnt(8)
v_mfma_f32_16x16x32_bf16 v[80:83], a[216:219], a[112:115], v[80:83]
ds_read_b64_tr_b16 a[192:193], v45 offset:128
v_mfma_f32_16x16x32_bf16 v[104:107], a[216:219], a[116:119], v[104:107]
ds_read_b64_tr_b16 a[194:195], v45 offset:896
buffer_load_dwordx4 v36, s[40:43], s13 offen offset:2048 lds
v_mfma_f32_16x16x32_bf16 v[108:111], a[220:223], a[116:119], v[108:111]
ds_read_b64_tr_b16 a[196:197], v46 offset:128
v_mfma_f32_16x16x32_bf16 v[84:87], a[220:223], a[112:115], v[84:87]
ds_read_b64_tr_b16 a[198:199], v46 offset:896
s_waitcnt vmcnt(17)
v_mfma_f32_16x16x32_bf16 v[112:115], a[200:203], a[120:123], v[112:115]
v_mfma_f32_16x16x32_bf16 v[136:139], a[200:203], a[124:127], v[136:139]
buffer_load_dwordx4 a[148:151], v23, s[64:67], s14 offen sc1
v_mfma_f32_16x16x32_bf16 v[140:143], a[204:207], a[124:127], v[140:143]
v_mfma_f32_16x16x32_bf16 v[116:119], a[204:207], a[120:123], v[116:119]
v_mfma_f32_16x16x32_bf16 v[120:123], a[208:211], a[120:123], v[120:123]
v_mfma_f32_16x16x32_bf16 v[144:147], a[208:211], a[124:127], v[144:147]
buffer_load_dwordx4 a[152:155], v24, s[64:67], s14 offen sc1
v_mfma_f32_16x16x32_bf16 v[148:151], a[212:215], a[124:127], v[148:151]
v_mfma_f32_16x16x32_bf16 v[124:127], a[212:215], a[120:123], v[124:127]
v_mfma_f32_16x16x32_bf16 v[128:131], a[216:219], a[120:123], v[128:131]
v_mfma_f32_16x16x32_bf16 v[152:155], a[216:219], a[124:127], v[152:155]
buffer_load_dwordx4 a[156:159], v25, s[64:67], s14 offen sc1
v_mfma_f32_16x16x32_bf16 v[156:159], a[220:223], a[124:127], v[156:159]
v_mfma_f32_16x16x32_bf16 v[132:135], a[220:223], a[120:123], v[132:135]
s_waitcnt vmcnt(18) lgkmcnt(8)
v_mfma_f32_16x16x32_bf16 v[64:67], a[176:179], a[128:131], v[64:67]
ds_read_b64_tr_b16 a[200:201], v45 offset:6144
v_mfma_f32_16x16x32_bf16 v[88:91], a[176:179], a[132:135], v[88:91]
ds_read_b64_tr_b16 a[202:203], v45 offset:6912
s_add_u32 s14, s10, 5
s_and_b32 s14, s14, 7
s_lshl_b32 s14, s14, 16
s_add_u32 s14, s14, s16
buffer_load_dwordx4 a[160:163], v22, s[64:67], s14 offen sc1
v_mfma_f32_16x16x32_bf16 v[92:95], a[180:183], a[132:135], v[92:95]
ds_read_b64_tr_b16 a[204:205], v46 offset:6144
v_mfma_f32_16x16x32_bf16 v[68:71], a[180:183], a[128:131], v[68:71]
ds_read_b64_tr_b16 a[206:207], v46 offset:6912
s_waitcnt lgkmcnt(8)
v_mfma_f32_16x16x32_bf16 v[72:75], a[184:187], a[128:131], v[72:75]
ds_read_b64_tr_b16 a[208:209], v45 offset:6208
v_mfma_f32_16x16x32_bf16 v[96:99], a[184:187], a[132:135], v[96:99]
ds_read_b64_tr_b16 a[210:211], v45 offset:6976
buffer_load_dwordx4 a[164:167], v23, s[64:67], s14 offen sc1
v_mfma_f32_16x16x32_bf16 v[100:103], a[188:191], a[132:135], v[100:103]
ds_read_b64_tr_b16 a[212:213], v46 offset:6208
v_mfma_f32_16x16x32_bf16 v[76:79], a[188:191], a[128:131], v[76:79]
ds_read_b64_tr_b16 a[214:215], v46 offset:6976
s_waitcnt lgkmcnt(8)
v_mfma_f32_16x16x32_bf16 v[80:83], a[192:195], a[128:131], v[80:83]
ds_read_b64_tr_b16 a[216:217], v45 offset:6272
v_mfma_f32_16x16x32_bf16 v[104:107], a[192:195], a[132:135], v[104:107]
ds_read_b64_tr_b16 a[218:219], v45 offset:7040
buffer_load_dwordx4 a[168:171], v24, s[64:67], s14 offen sc1
v_mfma_f32_16x16x32_bf16 v[108:111], a[196:199], a[132:135], v[108:111]
ds_read_b64_tr_b16 a[220:221], v46 offset:6272
v_mfma_f32_16x16x32_bf16 v[84:87], a[196:199], a[128:131], v[84:87]
ds_read_b64_tr_b16 a[222:223], v46 offset:7040
s_waitcnt vmcnt(19) lgkmcnt(8)
v_mfma_f32_16x16x32_bf16 v[64:67], a[200:203], a[136:139], v[64:67]
ds_read_b64_tr_b16 a[176:177], v45 offset:12288
v_mfma_f32_16x16x32_bf16 v[88:91], a[200:203], a[140:143], v[88:91]
ds_read_b64_tr_b16 a[178:179], v45 offset:13056
buffer_load_dwordx4 a[172:175], v25, s[64:67], s14 offen sc1
v_mfma_f32_16x16x32_bf16 v[92:95], a[204:207], a[140:143], v[92:95]
ds_read_b64_tr_b16 a[180:181], v46 offset:12288
v_mfma_f32_16x16x32_bf16 v[68:71], a[204:207], a[136:139], v[68:71]
ds_read_b64_tr_b16 a[182:183], v46 offset:13056
s_waitcnt lgkmcnt(8)
v_mfma_f32_16x16x32_bf16 v[72:75], a[208:211], a[136:139], v[72:75]
ds_read_b64_tr_b16 a[184:185], v45 offset:12352
v_mfma_f32_16x16x32_bf16 v[96:99], a[208:211], a[140:143], v[96:99]
ds_read_b64_tr_b16 a[186:187], v45 offset:13120
s_add_u32 s14, s10, 6
s_and_b32 s14, s14, 7
s_lshl_b32 s14, s14, 16
s_add_u32 s14, s14, s16
buffer_load_dwordx4 a[104:107], v22, s[64:67], s14 offen sc1
v_mfma_f32_16x16x32_bf16 v[100:103], a[212:215], a[140:143], v[100:103]
ds_read_b64_tr_b16 a[188:189], v46 offset:12352
v_mfma_f32_16x16x32_bf16 v[76:79], a[212:215], a[136:139], v[76:79]
ds_read_b64_tr_b16 a[190:191], v46 offset:13120
s_waitcnt lgkmcnt(8)
v_mfma_f32_16x16x32_bf16 v[80:83], a[216:219], a[136:139], v[80:83]
ds_read_b64_tr_b16 a[192:193], v45 offset:12416
v_mfma_f32_16x16x32_bf16 v[104:107], a[216:219], a[140:143], v[104:107]
ds_read_b64_tr_b16 a[194:195], v45 offset:13184
buffer_load_dwordx4 a[108:111], v23, s[64:67], s14 offen sc1
v_mfma_f32_16x16x32_bf16 v[108:111], a[220:223], a[140:143], v[108:111]
ds_read_b64_tr_b16 a[196:197], v46 offset:12416
v_mfma_f32_16x16x32_bf16 v[84:87], a[220:223], a[136:139], v[84:87]
ds_read_b64_tr_b16 a[198:199], v46 offset:13184
s_waitcnt vmcnt(8) lgkmcnt(8)
v_mfma_f32_16x16x32_bf16 v[64:67], a[176:179], a[144:147], v[64:67]
ds_read_b64_tr_b16 a[200:201], v45 offset:18432
v_mfma_f32_16x16x32_bf16 v[88:91], a[176:179], a[148:151], v[88:91]
ds_read_b64_tr_b16 a[202:203], v45 offset:19200
buffer_load_dwordx4 a[112:115], v24, s[64:67], s14 offen sc1
v_mfma_f32_16x16x32_bf16 v[92:95], a[180:183], a[148:151], v[92:95]
ds_read_b64_tr_b16 a[204:205], v46 offset:18432
v_mfma_f32_16x16x32_bf16 v[68:71], a[180:183], a[144:147], v[68:71]
ds_read_b64_tr_b16 a[206:207], v46 offset:19200
s_waitcnt lgkmcnt(8)
v_mfma_f32_16x16x32_bf16 v[72:75], a[184:187], a[144:147], v[72:75]
ds_read_b64_tr_b16 a[208:209], v45 offset:18496
v_mfma_f32_16x16x32_bf16 v[96:99], a[184:187], a[148:151], v[96:99]
ds_read_b64_tr_b16 a[210:211], v45 offset:19264
buffer_load_dwordx4 a[116:119], v25, s[64:67], s14 offen sc1
v_mfma_f32_16x16x32_bf16 v[100:103], a[188:191], a[148:151], v[100:103]
ds_read_b64_tr_b16 a[212:213], v46 offset:18496
v_mfma_f32_16x16x32_bf16 v[76:79], a[188:191], a[144:147], v[76:79]
ds_read_b64_tr_b16 a[214:215], v46 offset:19264
s_waitcnt lgkmcnt(8)
v_mfma_f32_16x16x32_bf16 v[80:83], a[192:195], a[144:147], v[80:83]
ds_read_b64_tr_b16 a[216:217], v45 offset:18560
v_mfma_f32_16x16x32_bf16 v[104:107], a[192:195], a[148:151], v[104:107]
ds_read_b64_tr_b16 a[218:219], v45 offset:19328
s_add_u32 s14, s10, 7
s_and_b32 s14, s14, 7
s_lshl_b32 s14, s14, 16
s_add_u32 s14, s14, s16
buffer_load_dwordx4 a[120:123], v22, s[64:67], s14 offen sc1
v_mfma_f32_16x16x32_bf16 v[108:111], a[196:199], a[148:151], v[108:111]
ds_read_b64_tr_b16 a[220:221], v46 offset:18560
v_mfma_f32_16x16x32_bf16 v[84:87], a[196:199], a[144:147], v[84:87]
ds_read_b64_tr_b16 a[222:223], v46 offset:19328
s_waitcnt vmcnt(9) lgkmcnt(8)
v_mfma_f32_16x16x32_bf16 v[64:67], a[200:203], a[152:155], v[64:67]
ds_read_b64_tr_b16 a[176:177], v45 offset:24576
v_mfma_f32_16x16x32_bf16 v[88:91], a[200:203], a[156:159], v[88:91]
ds_read_b64_tr_b16 a[178:179], v45 offset:25344
buffer_load_dwordx4 a[124:127], v23, s[64:67], s14 offen sc1
v_mfma_f32_16x16x32_bf16 v[92:95], a[204:207], a[156:159], v[92:95]
ds_read_b64_tr_b16 a[180:181], v46 offset:24576
v_mfma_f32_16x16x32_bf16 v[68:71], a[204:207], a[152:155], v[68:71]
ds_read_b64_tr_b16 a[182:183], v46 offset:25344
s_waitcnt lgkmcnt(8)
v_mfma_f32_16x16x32_bf16 v[72:75], a[208:211], a[152:155], v[72:75]
ds_read_b64_tr_b16 a[184:185], v45 offset:24640
v_mfma_f32_16x16x32_bf16 v[96:99], a[208:211], a[156:159], v[96:99]
ds_read_b64_tr_b16 a[186:187], v45 offset:25408
buffer_load_dwordx4 a[128:131], v24, s[64:67], s14 offen sc1
v_mfma_f32_16x16x32_bf16 v[100:103], a[212:215], a[156:159], v[100:103]
ds_read_b64_tr_b16 a[188:189], v46 offset:24640
v_mfma_f32_16x16x32_bf16 v[76:79], a[212:215], a[152:155], v[76:79]
ds_read_b64_tr_b16 a[190:191], v46 offset:25408
s_waitcnt lgkmcnt(8)
v_mfma_f32_16x16x32_bf16 v[80:83], a[216:219], a[152:155], v[80:83]
ds_read_b64_tr_b16 a[192:193], v45 offset:24704
v_mfma_f32_16x16x32_bf16 v[104:107], a[216:219], a[156:159], v[104:107]
ds_read_b64_tr_b16 a[194:195], v45 offset:25472
buffer_load_dwordx4 a[132:135], v25, s[64:67], s14 offen sc1
v_mfma_f32_16x16x32_bf16 v[108:111], a[220:223], a[156:159], v[108:111]
ds_read_b64_tr_b16 a[196:197], v46 offset:24704
v_mfma_f32_16x16x32_bf16 v[84:87], a[220:223], a[152:155], v[84:87]
ds_read_b64_tr_b16 a[198:199], v46 offset:25472
s_waitcnt vmcnt(10) lgkmcnt(8)
v_mfma_f32_16x16x32_bf16 v[64:67], a[176:179], a[160:163], v[64:67]
ds_read_b64_tr_b16 a[200:201], v45 offset:30720
v_mfma_f32_16x16x32_bf16 v[88:91], a[176:179], a[164:167], v[88:91]
ds_read_b64_tr_b16 a[202:203], v45 offset:31488
s_add_u32 s14, s10, 6
s_and_b32 s14, s14, 7
s_lshl_b32 s14, s14, 16
s_add_u32 s14, s14, s16
buffer_load_dwordx4 a[136:139], v26, s[64:67], s14 offen sc1
v_mfma_f32_16x16x32_bf16 v[92:95], a[180:183], a[164:167], v[92:95]
ds_read_b64_tr_b16 a[204:205], v46 offset:30720
v_mfma_f32_16x16x32_bf16 v[68:71], a[180:183], a[160:163], v[68:71]
ds_read_b64_tr_b16 a[206:207], v46 offset:31488
s_waitcnt lgkmcnt(8)
v_mfma_f32_16x16x32_bf16 v[72:75], a[184:187], a[160:163], v[72:75]
ds_read_b64_tr_b16 a[208:209], v45 offset:30784
v_mfma_f32_16x16x32_bf16 v[96:99], a[184:187], a[164:167], v[96:99]
ds_read_b64_tr_b16 a[210:211], v45 offset:31552
buffer_load_dwordx4 a[140:143], v27, s[64:67], s14 offen sc1
v_mfma_f32_16x16x32_bf16 v[100:103], a[188:191], a[164:167], v[100:103]
ds_read_b64_tr_b16 a[212:213], v46 offset:30784
v_mfma_f32_16x16x32_bf16 v[76:79], a[188:191], a[160:163], v[76:79]
ds_read_b64_tr_b16 a[214:215], v46 offset:31552
s_waitcnt lgkmcnt(8)
v_mfma_f32_16x16x32_bf16 v[80:83], a[192:195], a[160:163], v[80:83]
ds_read_b64_tr_b16 a[216:217], v45 offset:30848
v_mfma_f32_16x16x32_bf16 v[104:107], a[192:195], a[164:167], v[104:107]
ds_read_b64_tr_b16 a[218:219], v45 offset:31616
buffer_load_dwordx4 a[144:147], v28, s[64:67], s14 offen sc1
v_mfma_f32_16x16x32_bf16 v[108:111], a[196:199], a[164:167], v[108:111]
ds_read_b64_tr_b16 a[220:221], v46 offset:30848
v_mfma_f32_16x16x32_bf16 v[84:87], a[196:199], a[160:163], v[84:87]
ds_read_b64_tr_b16 a[222:223], v46 offset:31616
s_barrier
s_waitcnt vmcnt(11) lgkmcnt(8)
v_mfma_f32_16x16x32_bf16 v[64:67], a[200:203], a[168:171], v[64:67]
ds_read_b64_tr_b16 a[0:1], v43 offset:0
v_mfma_f32_16x16x32_bf16 v[88:91], a[200:203], a[172:175], v[88:91]
ds_read_b64_tr_b16 a[2:3], v43 offset:768
buffer_load_dwordx4 a[148:151], v29, s[64:67], s14 offen sc1
v_mfma_f32_16x16x32_bf16 v[92:95], a[204:207], a[172:175], v[92:95]
ds_read_b64_tr_b16 a[4:5], v44 offset:0
v_mfma_f32_16x16x32_bf16 v[68:71], a[204:207], a[168:171], v[68:71]
ds_read_b64_tr_b16 a[6:7], v44 offset:768
s_waitcnt lgkmcnt(8)
v_mfma_f32_16x16x32_bf16 v[72:75], a[208:211], a[168:171], v[72:75]
ds_read_b64_tr_b16 a[8:9], v43 offset:64
v_mfma_f32_16x16x32_bf16 v[96:99], a[208:211], a[172:175], v[96:99]
ds_read_b64_tr_b16 a[10:11], v43 offset:832
s_add_u32 s14, s10, 7
s_and_b32 s14, s14, 7
s_lshl_b32 s14, s14, 16
s_add_u32 s14, s14, s16
buffer_load_dwordx4 a[152:155], v26, s[64:67], s14 offen sc1
v_mfma_f32_16x16x32_bf16 v[100:103], a[212:215], a[172:175], v[100:103]
ds_read_b64_tr_b16 a[12:13], v44 offset:64
v_mfma_f32_16x16x32_bf16 v[76:79], a[212:215], a[168:171], v[76:79]
ds_read_b64_tr_b16 a[14:15], v44 offset:832
s_waitcnt lgkmcnt(8)
v_mfma_f32_16x16x32_bf16 v[80:83], a[216:219], a[168:171], v[80:83]
ds_read_b64_tr_b16 a[16:17], v43 offset:128
v_mfma_f32_16x16x32_bf16 v[104:107], a[216:219], a[172:175], v[104:107]
ds_read_b64_tr_b16 a[18:19], v43 offset:896
buffer_load_dwordx4 a[156:159], v27, s[64:67], s14 offen sc1
v_mfma_f32_16x16x32_bf16 v[108:111], a[220:223], a[172:175], v[108:111]
ds_read_b64_tr_b16 a[20:21], v44 offset:128
v_mfma_f32_16x16x32_bf16 v[84:87], a[220:223], a[168:171], v[84:87]
ds_read_b64_tr_b16 a[22:23], v44 offset:896
s_waitcnt vmcnt(12) lgkmcnt(8)
v_mfma_f32_16x16x32_bf16 v[64:67], a[0:3], a[104:107], v[64:67]
ds_read_b64_tr_b16 a[24:25], v43 offset:6144
v_mfma_f32_16x16x32_bf16 v[88:91], a[0:3], a[108:111], v[88:91]
ds_read_b64_tr_b16 a[26:27], v43 offset:6912
buffer_load_dwordx4 a[160:163], v28, s[64:67], s14 offen sc1
v_mfma_f32_16x16x32_bf16 v[92:95], a[4:7], a[108:111], v[92:95]
ds_read_b64_tr_b16 a[28:29], v44 offset:6144
v_mfma_f32_16x16x32_bf16 v[68:71], a[4:7], a[104:107], v[68:71]
ds_read_b64_tr_b16 a[30:31], v44 offset:6912
s_waitcnt lgkmcnt(8)
v_mfma_f32_16x16x32_bf16 v[72:75], a[8:11], a[104:107], v[72:75]
ds_read_b64_tr_b16 a[32:33], v43 offset:6208
v_mfma_f32_16x16x32_bf16 v[96:99], a[8:11], a[108:111], v[96:99]
ds_read_b64_tr_b16 a[34:35], v43 offset:6976
buffer_load_dwordx4 a[164:167], v29, s[64:67], s14 offen sc1
v_mfma_f32_16x16x32_bf16 v[100:103], a[12:15], a[108:111], v[100:103]
ds_read_b64_tr_b16 a[36:37], v44 offset:6208
v_mfma_f32_16x16x32_bf16 v[76:79], a[12:15], a[104:107], v[76:79]
ds_read_b64_tr_b16 a[38:39], v44 offset:6976
s_waitcnt lgkmcnt(8)
v_mfma_f32_16x16x32_bf16 v[80:83], a[16:19], a[104:107], v[80:83]
ds_read_b64_tr_b16 a[40:41], v43 offset:6272
v_mfma_f32_16x16x32_bf16 v[104:107], a[16:19], a[108:111], v[104:107]
ds_read_b64_tr_b16 a[42:43], v43 offset:7040
s_add_u32 s14, s10, 3
s_and_b32 s14, s14, 7
s_lshl_b32 s14, s14, 16
s_add_u32 s14, s14, s16
buffer_load_dwordx4 a[168:171], v26, s[64:67], s14 offen sc1
v_mfma_f32_16x16x32_bf16 v[108:111], a[20:23], a[108:111], v[108:111]
ds_read_b64_tr_b16 a[44:45], v44 offset:6272
v_mfma_f32_16x16x32_bf16 v[84:87], a[20:23], a[104:107], v[84:87]
ds_read_b64_tr_b16 a[46:47], v44 offset:7040
s_waitcnt vmcnt(13) lgkmcnt(8)
v_mfma_f32_16x16x32_bf16 v[64:67], a[24:27], a[112:115], v[64:67]
ds_read_b64_tr_b16 a[48:49], v43 offset:12288
v_mfma_f32_16x16x32_bf16 v[88:91], a[24:27], a[116:119], v[88:91]
ds_read_b64_tr_b16 a[50:51], v43 offset:13056
buffer_load_dwordx4 a[172:175], v27, s[64:67], s14 offen sc1
v_mfma_f32_16x16x32_bf16 v[92:95], a[28:31], a[116:119], v[92:95]
ds_read_b64_tr_b16 a[52:53], v44 offset:12288
v_mfma_f32_16x16x32_bf16 v[68:71], a[28:31], a[112:115], v[68:71]
ds_read_b64_tr_b16 a[54:55], v44 offset:13056
s_waitcnt lgkmcnt(8)
v_mfma_f32_16x16x32_bf16 v[72:75], a[32:35], a[112:115], v[72:75]
ds_read_b64_tr_b16 a[56:57], v43 offset:12352
v_mfma_f32_16x16x32_bf16 v[96:99], a[32:35], a[116:119], v[96:99]
ds_read_b64_tr_b16 a[58:59], v43 offset:13120
buffer_load_dwordx4 a[104:107], v28, s[64:67], s14 offen sc1
v_mfma_f32_16x16x32_bf16 v[100:103], a[36:39], a[116:119], v[100:103]
ds_read_b64_tr_b16 a[60:61], v44 offset:12352
v_mfma_f32_16x16x32_bf16 v[76:79], a[36:39], a[112:115], v[76:79]
ds_read_b64_tr_b16 a[62:63], v44 offset:13120
s_waitcnt lgkmcnt(8)
v_mfma_f32_16x16x32_bf16 v[80:83], a[40:43], a[112:115], v[80:83]
ds_read_b64_tr_b16 a[64:65], v43 offset:12416
v_mfma_f32_16x16x32_bf16 v[104:107], a[40:43], a[116:119], v[104:107]
ds_read_b64_tr_b16 a[66:67], v43 offset:13184
buffer_load_dwordx4 a[108:111], v29, s[64:67], s14 offen sc1
v_mfma_f32_16x16x32_bf16 v[108:111], a[44:47], a[116:119], v[108:111]
ds_read_b64_tr_b16 a[68:69], v44 offset:12416
v_mfma_f32_16x16x32_bf16 v[84:87], a[44:47], a[112:115], v[84:87]
ds_read_b64_tr_b16 a[70:71], v44 offset:13184
s_waitcnt vmcnt(14) lgkmcnt(8)
v_mfma_f32_16x16x32_bf16 v[64:67], a[48:51], a[120:123], v[64:67]
ds_read_b64_tr_b16 a[72:73], v43 offset:18432
v_mfma_f32_16x16x32_bf16 v[88:91], a[48:51], a[124:127], v[88:91]
ds_read_b64_tr_b16 a[74:75], v43 offset:19200
s_add_u32 s14, s10, 4
s_and_b32 s14, s14, 7
s_lshl_b32 s14, s14, 16
s_add_u32 s14, s14, s16
buffer_load_dwordx4 a[112:115], v26, s[64:67], s14 offen sc1
v_mfma_f32_16x16x32_bf16 v[92:95], a[52:55], a[124:127], v[92:95]
ds_read_b64_tr_b16 a[76:77], v44 offset:18432
v_mfma_f32_16x16x32_bf16 v[68:71], a[52:55], a[120:123], v[68:71]
ds_read_b64_tr_b16 a[78:79], v44 offset:19200
s_waitcnt lgkmcnt(8)
v_mfma_f32_16x16x32_bf16 v[72:75], a[56:59], a[120:123], v[72:75]
ds_read_b64_tr_b16 a[80:81], v43 offset:18496
v_mfma_f32_16x16x32_bf16 v[96:99], a[56:59], a[124:127], v[96:99]
ds_read_b64_tr_b16 a[82:83], v43 offset:19264
v_mfma_f32_16x16x32_bf16 v[100:103], a[60:63], a[124:127], v[100:103]
ds_read_b64_tr_b16 a[84:85], v44 offset:18496
v_mfma_f32_16x16x32_bf16 v[76:79], a[60:63], a[120:123], v[76:79]
ds_read_b64_tr_b16 a[86:87], v44 offset:19264
buffer_load_dwordx4 a[116:119], v27, s[64:67], s14 offen sc1
s_waitcnt lgkmcnt(8)
v_mfma_f32_16x16x32_bf16 v[80:83], a[64:67], a[120:123], v[80:83]
ds_read_b64_tr_b16 a[88:89], v43 offset:18560
v_mfma_f32_16x16x32_bf16 v[104:107], a[64:67], a[124:127], v[104:107]
ds_read_b64_tr_b16 a[90:91], v43 offset:19328
v_mfma_f32_16x16x32_bf16 v[108:111], a[68:71], a[124:127], v[108:111]
ds_read_b64_tr_b16 a[92:93], v44 offset:18560
v_mfma_f32_16x16x32_bf16 v[84:87], a[68:71], a[120:123], v[84:87]
ds_read_b64_tr_b16 a[94:95], v44 offset:19328
s_waitcnt vmcnt(14) lgkmcnt(8)
v_mfma_f32_16x16x32_bf16 v[64:67], a[72:75], a[128:131], v[64:67]
v_mfma_f32_16x16x32_bf16 v[88:91], a[72:75], a[132:135], v[88:91]
buffer_load_dwordx4 a[120:123], v28, s[64:67], s14 offen sc1
v_mfma_f32_16x16x32_bf16 v[92:95], a[76:79], a[132:135], v[92:95]
v_mfma_f32_16x16x32_bf16 v[68:71], a[76:79], a[128:131], v[68:71]
s_waitcnt lgkmcnt(4)
v_mfma_f32_16x16x32_bf16 v[72:75], a[80:83], a[128:131], v[72:75]
v_mfma_f32_16x16x32_bf16 v[96:99], a[80:83], a[132:135], v[96:99]
v_mfma_f32_16x16x32_bf16 v[100:103], a[84:87], a[132:135], v[100:103]
v_mfma_f32_16x16x32_bf16 v[76:79], a[84:87], a[128:131], v[76:79]
buffer_load_dwordx4 a[124:127], v29, s[64:67], s14 offen sc1
s_waitcnt lgkmcnt(0)
v_mfma_f32_16x16x32_bf16 v[80:83], a[88:91], a[128:131], v[80:83]
v_mfma_f32_16x16x32_bf16 v[104:107], a[88:91], a[132:135], v[104:107]
v_mfma_f32_16x16x32_bf16 v[108:111], a[92:95], a[132:135], v[108:111]
v_mfma_f32_16x16x32_bf16 v[84:87], a[92:95], a[128:131], v[84:87]
s_waitcnt vmcnt(14)
v_mfma_f32_16x16x32_bf16 v[112:115], a[0:3], a[136:139], v[112:115]
v_mfma_f32_16x16x32_bf16 v[136:139], a[0:3], a[140:143], v[136:139]
s_add_u32 s14, s10, 5
s_and_b32 s14, s14, 7
s_lshl_b32 s14, s14, 16
s_add_u32 s14, s14, s16
buffer_load_dwordx4 a[128:131], v26, s[64:67], s14 offen sc1
v_mfma_f32_16x16x32_bf16 v[140:143], a[4:7], a[140:143], v[140:143]
ds_write_b128 v47, v[64:67] offset:0
v_mfma_f32_16x16x32_bf16 v[116:119], a[4:7], a[136:139], v[116:119]
ds_write_b128 v47, v[68:71] offset:1024
v_mfma_f32_16x16x32_bf16 v[120:123], a[8:11], a[136:139], v[120:123]
ds_write_b128 v47, v[72:75] offset:2048
v_mfma_f32_16x16x32_bf16 v[144:147], a[8:11], a[140:143], v[144:147]
ds_write_b128 v47, v[76:79] offset:3072
v_mfma_f32_16x16x32_bf16 v[148:151], a[12:15], a[140:143], v[148:151]
ds_write_b128 v47, v[80:83] offset:4096
v_mfma_f32_16x16x32_bf16 v[124:127], a[12:15], a[136:139], v[124:127]
buffer_load_dwordx4 a[132:135], v27, s[64:67], s14 offen sc1
ds_write_b128 v47, v[84:87] offset:5120
v_mfma_f32_16x16x32_bf16 v[128:131], a[16:19], a[136:139], v[128:131]
v_mfma_f32_16x16x32_bf16 v[152:155], a[16:19], a[140:143], v[152:155]
v_mfma_f32_16x16x32_bf16 v[156:159], a[20:23], a[140:143], v[156:159]
v_mfma_f32_16x16x32_bf16 v[132:135], a[20:23], a[136:139], v[132:135]
s_waitcnt lgkmcnt(0)
s_barrier
s_waitcnt vmcnt(14)
v_mfma_f32_16x16x32_bf16 v[112:115], a[24:27], a[144:147], v[112:115]
ds_read_b128 v[184:187], v48 offset:0
v_mfma_f32_16x16x32_bf16 v[136:139], a[24:27], a[148:151], v[136:139]
buffer_load_dwordx4 a[136:139], v28, s[64:67], s14 offen sc1
ds_read_b128 v[188:191], v48 offset:1024
v_mfma_f32_16x16x32_bf16 v[140:143], a[28:31], a[148:151], v[140:143]
ds_read_b128 v[192:195], v48 offset:2048
v_mfma_f32_16x16x32_bf16 v[116:119], a[28:31], a[144:147], v[116:119]
ds_read_b128 v[196:199], v48 offset:3072
v_mfma_f32_16x16x32_bf16 v[120:123], a[32:35], a[144:147], v[120:123]
ds_read_b128 v[200:203], v48 offset:4096
v_mfma_f32_16x16x32_bf16 v[144:147], a[32:35], a[148:151], v[144:147]
ds_read_b128 v[204:207], v48 offset:5120
v_mfma_f32_16x16x32_bf16 v[148:151], a[36:39], a[148:151], v[148:151]
s_waitcnt lgkmcnt(5)
v_add_f32 v184, v88, v184
v_add_f32 v185, v89, v185
v_add_f32 v186, v90, v186
v_mfma_f32_16x16x32_bf16 v[124:127], a[36:39], a[144:147], v[124:127]
buffer_load_dwordx4 a[140:143], v29, s[64:67], s14 offen sc1
v_mfma_f32_16x16x32_bf16 v[128:131], a[40:43], a[144:147], v[128:131]
s_waitcnt lgkmcnt(4)
v_add_f32 v187, v91, v187
v_add_f32 v188, v92, v188
v_add_f32 v189, v93, v189
v_mfma_f32_16x16x32_bf16 v[152:155], a[40:43], a[148:151], v[152:155]
v_mfma_f32_16x16x32_bf16 v[156:159], a[44:47], a[148:151], v[156:159]
v_cvt_pk_bf16_f32 v208, v184, v185
v_cvt_pk_bf16_f32 v209, v186, v187
v_cvt_pk_bf16_f32 v210, v188, v189
v_mfma_f32_16x16x32_bf16 v[132:135], a[44:47], a[144:147], v[132:135]
buffer_store_dwordx4 v[208:211], v246, s[64:67], s76 offen offset:0 sc1
s_waitcnt vmcnt(15)
v_mfma_f32_16x16x32_bf16 v[112:115], a[48:51], a[152:155], v[112:115]
s_waitcnt lgkmcnt(3)
v_add_f32 v190, v94, v190
v_add_f32 v191, v95, v191
v_add_f32 v192, v96, v192
v_mfma_f32_16x16x32_bf16 v[136:139], a[48:51], a[156:159], v[136:139]
v_mfma_f32_16x16x32_bf16 v[140:143], a[52:55], a[156:159], v[140:143]
v_add_f32 v193, v97, v193
v_add_f32 v194, v98, v194
v_add_f32 v195, v99, v195
v_mfma_f32_16x16x32_bf16 v[116:119], a[52:55], a[152:155], v[116:119]
v_mfma_f32_16x16x32_bf16 v[120:123], a[56:59], a[152:155], v[120:123]
v_cvt_pk_bf16_f32 v212, v190, v191
v_cvt_pk_bf16_f32 v213, v192, v193
v_cvt_pk_bf16_f32 v214, v194, v195
v_mfma_f32_16x16x32_bf16 v[144:147], a[56:59], a[156:159], v[144:147]
buffer_store_dwordx4 v[212:215], v246, s[64:67], s76 offen offset:1024 sc1
v_mfma_f32_16x16x32_bf16 v[148:151], a[60:63], a[156:159], v[148:151]
s_waitcnt lgkmcnt(2)
v_add_f32 v196, v100, v196
v_add_f32 v197, v101, v197
v_add_f32 v198, v102, v198
v_mfma_f32_16x16x32_bf16 v[124:127], a[60:63], a[152:155], v[124:127]
v_mfma_f32_16x16x32_bf16 v[128:131], a[64:67], a[152:155], v[128:131]
s_waitcnt lgkmcnt(1)
v_add_f32 v199, v103, v199
v_add_f32 v200, v104, v200
v_add_f32 v201, v105, v201
v_mfma_f32_16x16x32_bf16 v[152:155], a[64:67], a[156:159], v[152:155]
v_mfma_f32_16x16x32_bf16 v[156:159], a[68:71], a[156:159], v[156:159]
v_cvt_pk_bf16_f32 v216, v196, v197
v_cvt_pk_bf16_f32 v217, v198, v199
v_cvt_pk_bf16_f32 v218, v200, v201
v_mfma_f32_16x16x32_bf16 v[132:135], a[68:71], a[152:155], v[132:135]
buffer_store_dwordx4 v[216:219], v246, s[64:67], s76 offen offset:2048 sc1
s_waitcnt vmcnt(15)
v_mfma_f32_16x16x32_bf16 v[112:115], a[72:75], a[160:163], v[112:115]
ds_read_b64_tr_b16 a[176:177], v45 offset:0
s_waitcnt lgkmcnt(1)
v_add_f32 v202, v106, v202
v_add_f32 v203, v107, v203
v_add_f32 v204, v108, v204
v_mfma_f32_16x16x32_bf16 v[136:139], a[72:75], a[164:167], v[136:139]
ds_read_b64_tr_b16 a[178:179], v45 offset:768
v_mfma_f32_16x16x32_bf16 v[140:143], a[76:79], a[164:167], v[140:143]
ds_read_b64_tr_b16 a[180:181], v46 offset:0
v_add_f32 v205, v109, v205
v_add_f32 v206, v110, v206
v_add_f32 v207, v111, v207
v_mfma_f32_16x16x32_bf16 v[116:119], a[76:79], a[160:163], v[116:119]
ds_read_b64_tr_b16 a[182:183], v46 offset:768
v_mfma_f32_16x16x32_bf16 v[120:123], a[80:83], a[160:163], v[120:123]
ds_read_b64_tr_b16 a[184:185], v45 offset:64
v_cvt_pk_bf16_f32 v220, v202, v203
v_cvt_pk_bf16_f32 v221, v204, v205
v_cvt_pk_bf16_f32 v222, v206, v207
v_mfma_f32_16x16x32_bf16 v[144:147], a[80:83], a[164:167], v[144:147]
ds_read_b64_tr_b16 a[186:187], v45 offset:832
buffer_store_dwordx4 v[220:223], v246, s[64:67], s76 offen offset:3072 sc1
v_mfma_f32_16x16x32_bf16 v[148:151], a[84:87], a[164:167], v[148:151]
ds_read_b64_tr_b16 a[188:189], v46 offset:64
v_mfma_f32_16x16x32_bf16 v[124:127], a[84:87], a[160:163], v[124:127]
ds_read_b64_tr_b16 a[190:191], v46 offset:832
v_mfma_f32_16x16x32_bf16 v[128:131], a[88:91], a[160:163], v[128:131]
ds_read_b64_tr_b16 a[192:193], v45 offset:128
v_mfma_f32_16x16x32_bf16 v[152:155], a[88:91], a[164:167], v[152:155]
ds_read_b64_tr_b16 a[194:195], v45 offset:896
v_mfma_f32_16x16x32_bf16 v[156:159], a[92:95], a[164:167], v[156:159]
ds_read_b64_tr_b16 a[196:197], v46 offset:128
v_mfma_f32_16x16x32_bf16 v[132:135], a[92:95], a[160:163], v[132:135]
ds_read_b64_tr_b16 a[198:199], v46 offset:896
s_barrier
s_waitcnt vmcnt(14) lgkmcnt(8)
v_mfma_f32_16x16x32_bf16 v[112:115], a[176:179], a[168:171], v[112:115]
ds_read_b64_tr_b16 a[200:201], v45 offset:6144
v_mfma_f32_16x16x32_bf16 v[136:139], a[176:179], a[172:175], v[136:139]
ds_read_b64_tr_b16 a[202:203], v45 offset:6912
s_add_u32 m0, s62, 0
s_nop 0
buffer_load_dwordx4 v240, s[48:51], s60 offen lds
v_mfma_f32_16x16x32_bf16 v[140:143], a[180:183], a[172:175], v[140:143]
ds_read_b64_tr_b16 a[204:205], v46 offset:6144
v_mfma_f32_16x16x32_bf16 v[116:119], a[180:183], a[168:171], v[116:119]
ds_read_b64_tr_b16 a[206:207], v46 offset:6912
s_waitcnt lgkmcnt(8)
v_mfma_f32_16x16x32_bf16 v[120:123], a[184:187], a[168:171], v[120:123]
ds_read_b64_tr_b16 a[208:209], v45 offset:6208
buffer_load_dwordx4 v241, s[48:51], s60 offen offset:1024 lds
v_mfma_f32_16x16x32_bf16 v[144:147], a[184:187], a[172:175], v[144:147]
ds_read_b64_tr_b16 a[210:211], v45 offset:6976
v_mfma_f32_16x16x32_bf16 v[148:151], a[188:191], a[172:175], v[148:151]
ds_read_b64_tr_b16 a[212:213], v46 offset:6208
v_mfma_f32_16x16x32_bf16 v[124:127], a[188:191], a[168:171], v[124:127]
ds_read_b64_tr_b16 a[214:215], v46 offset:6976
s_add_u32 m0, s62, 2048
s_add_u32 s60, s60, 65536
buffer_load_dwordx4 v240, s[48:51], s60 offen lds
s_waitcnt lgkmcnt(8)
v_mfma_f32_16x16x32_bf16 v[128:131], a[192:195], a[168:171], v[128:131]
ds_read_b64_tr_b16 a[216:217], v45 offset:6272
v_mfma_f32_16x16x32_bf16 v[152:155], a[192:195], a[172:175], v[152:155]
ds_read_b64_tr_b16 a[218:219], v45 offset:7040
v_mfma_f32_16x16x32_bf16 v[156:159], a[196:199], a[172:175], v[156:159]
ds_read_b64_tr_b16 a[220:221], v46 offset:6272
buffer_load_dwordx4 v241, s[48:51], s60 offen offset:1024 lds
v_mfma_f32_16x16x32_bf16 v[132:135], a[196:199], a[168:171], v[132:135]
ds_read_b64_tr_b16 a[222:223], v46 offset:7040
s_waitcnt vmcnt(16) lgkmcnt(8)
v_mfma_f32_16x16x32_bf16 v[112:115], a[200:203], a[104:107], v[112:115]
ds_read_b64_tr_b16 a[176:177], v45 offset:12288
v_mfma_f32_16x16x32_bf16 v[136:139], a[200:203], a[108:111], v[136:139]
ds_read_b64_tr_b16 a[178:179], v45 offset:13056
s_add_u32 m0, s62, 4096
s_add_u32 s60, s60, 65536
s_cmp_eq_u32 s60, s1
s_cselect_b32 s60, s0, s60
buffer_load_dwordx4 v240, s[48:51], s60 offen lds
v_mfma_f32_16x16x32_bf16 v[140:143], a[204:207], a[108:111], v[140:143]
ds_read_b64_tr_b16 a[180:181], v46 offset:12288
v_mfma_f32_16x16x32_bf16 v[116:119], a[204:207], a[104:107], v[116:119]
ds_read_b64_tr_b16 a[182:183], v46 offset:13056
s_waitcnt lgkmcnt(8)
v_mfma_f32_16x16x32_bf16 v[120:123], a[208:211], a[104:107], v[120:123]
ds_read_b64_tr_b16 a[184:185], v45 offset:12352
v_mfma_f32_16x16x32_bf16 v[144:147], a[208:211], a[108:111], v[144:147]
ds_read_b64_tr_b16 a[186:187], v45 offset:13120
buffer_load_dwordx4 v241, s[48:51], s60 offen offset:1024 lds
v_mfma_f32_16x16x32_bf16 v[148:151], a[212:215], a[108:111], v[148:151]
ds_read_b64_tr_b16 a[188:189], v46 offset:12352
v_mfma_f32_16x16x32_bf16 v[124:127], a[212:215], a[104:107], v[124:127]
ds_read_b64_tr_b16 a[190:191], v46 offset:13120
s_waitcnt lgkmcnt(8)
v_mfma_f32_16x16x32_bf16 v[128:131], a[216:219], a[104:107], v[128:131]
ds_read_b64_tr_b16 a[192:193], v45 offset:12416
v_mfma_f32_16x16x32_bf16 v[152:155], a[216:219], a[108:111], v[152:155]
ds_read_b64_tr_b16 a[194:195], v45 offset:13184
s_add_u32 m0, s62, 6144
s_add_u32 s60, s60, 65536
buffer_load_dwordx4 v240, s[48:51], s60 offen lds
v_mfma_f32_16x16x32_bf16 v[156:159], a[220:223], a[108:111], v[156:159]
ds_read_b64_tr_b16 a[196:197], v46 offset:12416
v_mfma_f32_16x16x32_bf16 v[132:135], a[220:223], a[104:107], v[132:135]
ds_read_b64_tr_b16 a[198:199], v46 offset:13184
s_waitcnt vmcnt(17) lgkmcnt(8)
v_mfma_f32_16x16x32_bf16 v[112:115], a[176:179], a[112:115], v[112:115]
ds_read_b64_tr_b16 a[200:201], v45 offset:18432
v_mfma_f32_16x16x32_bf16 v[136:139], a[176:179], a[116:119], v[136:139]
ds_read_b64_tr_b16 a[202:203], v45 offset:19200
buffer_load_dwordx4 v241, s[48:51], s60 offen offset:1024 lds
v_mfma_f32_16x16x32_bf16 v[140:143], a[180:183], a[116:119], v[140:143]
ds_read_b64_tr_b16 a[204:205], v46 offset:18432
v_mfma_f32_16x16x32_bf16 v[116:119], a[180:183], a[112:115], v[116:119]
ds_read_b64_tr_b16 a[206:207], v46 offset:19200
s_waitcnt lgkmcnt(8)
v_mfma_f32_16x16x32_bf16 v[120:123], a[184:187], a[112:115], v[120:123]
ds_read_b64_tr_b16 a[208:209], v45 offset:18496
v_mfma_f32_16x16x32_bf16 v[144:147], a[184:187], a[116:119], v[144:147]
ds_read_b64_tr_b16 a[210:211], v45 offset:19264
s_add_u32 m0, s62, 8192
s_add_u32 s60, s60, 65536
s_cmp_eq_u32 s60, s1
s_cselect_b32 s60, s0, s60
buffer_load_dwordx4 v240, s[48:51], s60 offen lds
v_mfma_f32_16x16x32_bf16 v[148:151], a[188:191], a[116:119], v[148:151]
ds_read_b64_tr_b16 a[212:213], v46 offset:18496
v_mfma_f32_16x16x32_bf16 v[124:127], a[188:191], a[112:115], v[124:127]
ds_read_b64_tr_b16 a[214:215], v46 offset:19264
s_waitcnt lgkmcnt(8)
v_mfma_f32_16x16x32_bf16 v[128:131], a[192:195], a[112:115], v[128:131]
ds_read_b64_tr_b16 a[216:217], v45 offset:18560
v_mfma_f32_16x16x32_bf16 v[152:155], a[192:195], a[116:119], v[152:155]
ds_read_b64_tr_b16 a[218:219], v45 offset:19328
buffer_load_dwordx4 v241, s[48:51], s60 offen offset:1024 lds
v_mfma_f32_16x16x32_bf16 v[156:159], a[196:199], a[116:119], v[156:159]
ds_read_b64_tr_b16 a[220:221], v46 offset:18560
v_mfma_f32_16x16x32_bf16 v[132:135], a[196:199], a[112:115], v[132:135]
ds_read_b64_tr_b16 a[222:223], v46 offset:19328
s_waitcnt vmcnt(18) lgkmcnt(8)
v_mfma_f32_16x16x32_bf16 v[112:115], a[200:203], a[120:123], v[112:115]
ds_read_b64_tr_b16 a[176:177], v45 offset:24576
v_mfma_f32_16x16x32_bf16 v[136:139], a[200:203], a[124:127], v[136:139]
ds_read_b64_tr_b16 a[178:179], v45 offset:25344
s_add_u32 m0, s62, 10240
s_add_u32 s60, s60, 65536
buffer_load_dwordx4 v240, s[48:51], s60 offen lds
v_mfma_f32_16x16x32_bf16 v[140:143], a[204:207], a[124:127], v[140:143]
ds_read_b64_tr_b16 a[180:181], v46 offset:24576
v_mfma_f32_16x16x32_bf16 v[116:119], a[204:207], a[120:123], v[116:119]
ds_read_b64_tr_b16 a[182:183], v46 offset:25344
s_waitcnt lgkmcnt(8)
v_mfma_f32_16x16x32_bf16 v[120:123], a[208:211], a[120:123], v[120:123]
ds_read_b64_tr_b16 a[184:185], v45 offset:24640
v_mfma_f32_16x16x32_bf16 v[144:147], a[208:211], a[124:127], v[144:147]
ds_read_b64_tr_b16 a[186:187], v45 offset:25408
v_mfma_f32_16x16x32_bf16 v[148:151], a[212:215], a[124:127], v[148:151]
ds_read_b64_tr_b16 a[188:189], v46 offset:24640
v_mfma_f32_16x16x32_bf16 v[124:127], a[212:215], a[120:123], v[124:127]
ds_read_b64_tr_b16 a[190:191], v46 offset:25408
buffer_load_dwordx4 v241, s[48:51], s60 offen offset:1024 lds
s_waitcnt lgkmcnt(8)
v_mfma_f32_16x16x32_bf16 v[128:131], a[216:219], a[120:123], v[128:131]
ds_read_b64_tr_b16 a[192:193], v45 offset:24704
v_mfma_f32_16x16x32_bf16 v[152:155], a[216:219], a[124:127], v[152:155]
ds_read_b64_tr_b16 a[194:195], v45 offset:25472
v_mfma_f32_16x16x32_bf16 v[156:159], a[220:223], a[124:127], v[156:159]
ds_read_b64_tr_b16 a[196:197], v46 offset:24704
v_mfma_f32_16x16x32_bf16 v[132:135], a[220:223], a[120:123], v[132:135]
ds_read_b64_tr_b16 a[198:199], v46 offset:25472
s_waitcnt vmcnt(18) lgkmcnt(8)
v_mfma_f32_16x16x32_bf16 v[112:115], a[176:179], a[128:131], v[112:115]
ds_read_b64_tr_b16 a[200:201], v45 offset:30720
v_mfma_f32_16x16x32_bf16 v[136:139], a[176:179], a[132:135], v[136:139]
ds_read_b64_tr_b16 a[202:203], v45 offset:31488
buffer_load_dwordx4 v[208:211], v246, s[64:67], s78 offen offset:0 sc1
v_mfma_f32_16x16x32_bf16 v[140:143], a[180:183], a[132:135], v[140:143]
ds_read_b64_tr_b16 a[204:205], v46 offset:30720
v_mfma_f32_16x16x32_bf16 v[116:119], a[180:183], a[128:131], v[116:119]
ds_read_b64_tr_b16 a[206:207], v46 offset:31488
s_waitcnt lgkmcnt(8)
v_mfma_f32_16x16x32_bf16 v[120:123], a[184:187], a[128:131], v[120:123]
ds_read_b64_tr_b16 a[208:209], v45 offset:30784
buffer_load_dwordx4 v[212:215], v246, s[64:67], s78 offen offset:1024 sc1
v_mfma_f32_16x16x32_bf16 v[144:147], a[184:187], a[132:135], v[144:147]
ds_read_b64_tr_b16 a[210:211], v45 offset:31552
v_mfma_f32_16x16x32_bf16 v[148:151], a[188:191], a[132:135], v[148:151]
ds_read_b64_tr_b16 a[212:213], v46 offset:30784
v_mfma_f32_16x16x32_bf16 v[124:127], a[188:191], a[128:131], v[124:127]
ds_read_b64_tr_b16 a[214:215], v46 offset:31552
buffer_load_dwordx4 v[216:219], v246, s[64:67], s78 offen offset:2048 sc1
s_waitcnt lgkmcnt(8)
v_mfma_f32_16x16x32_bf16 v[128:131], a[192:195], a[128:131], v[128:131]
ds_read_b64_tr_b16 a[216:217], v45 offset:30848
v_mfma_f32_16x16x32_bf16 v[152:155], a[192:195], a[132:135], v[152:155]
ds_read_b64_tr_b16 a[218:219], v45 offset:31616
v_mfma_f32_16x16x32_bf16 v[156:159], a[196:199], a[132:135], v[156:159]
ds_read_b64_tr_b16 a[220:221], v46 offset:30848
buffer_load_dwordx4 v[220:223], v246, s[64:67], s78 offen offset:3072 sc1
v_mfma_f32_16x16x32_bf16 v[132:135], a[196:199], a[128:131], v[132:135]
ds_read_b64_tr_b16 a[222:223], v46 offset:31616
s_waitcnt vmcnt(21) lgkmcnt(10)
v_mfma_f32_16x16x32_bf16 v[112:115], a[200:203], a[136:139], v[112:115]
s_waitcnt lgkmcnt(8)
v_mfma_f32_16x16x32_bf16 v[116:119], a[204:207], a[136:139], v[116:119]
s_waitcnt lgkmcnt(6)
v_mfma_f32_16x16x32_bf16 v[120:123], a[208:211], a[136:139], v[120:123]
s_waitcnt lgkmcnt(4)
v_mfma_f32_16x16x32_bf16 v[124:127], a[212:215], a[136:139], v[124:127]
s_waitcnt lgkmcnt(2)
v_mfma_f32_16x16x32_bf16 v[128:131], a[216:219], a[136:139], v[128:131]
s_waitcnt lgkmcnt(0)
v_mfma_f32_16x16x32_bf16 v[132:135], a[220:223], a[136:139], v[132:135]
s_waitcnt vmcnt(20)
v_mfma_f32_16x16x32_bf16 v[136:139], a[200:203], a[140:143], v[136:139]
v_mfma_f32_16x16x32_bf16 v[140:143], a[204:207], a[140:143], v[140:143]
ds_write_b128 v47, v[112:115] offset:0
v_mfma_f32_16x16x32_bf16 v[144:147], a[208:211], a[140:143], v[144:147]
ds_write_b128 v47, v[116:119] offset:1024
v_mfma_f32_16x16x32_bf16 v[148:151], a[212:215], a[140:143], v[148:151]
ds_write_b128 v47, v[120:123] offset:2048
v_mfma_f32_16x16x32_bf16 v[152:155], a[216:219], a[140:143], v[152:155]
ds_write_b128 v47, v[124:127] offset:3072
v_mfma_f32_16x16x32_bf16 v[156:159], a[220:223], a[140:143], v[156:159]
ds_write_b128 v47, v[128:131] offset:4096
s_waitcnt vmcnt(0)
s_mov_b32 s25, 0
L_xg_23:
v_xor_b32 v50, s27, v211
v_xor_b32 v51, s27, v215
v_xor_b32 v52, s27, v219
v_xor_b32 v53, s27, v223
v_or3_b32 v50, v50, v51, v52
v_or_b32 v50, v50, v53
v_cmp_ne_u32 vcc, 0, v50
s_cbranch_vccz L_xgd_24
s_add_u32 s25, s25, 1
s_cmp_lt_u32 s25, 262144
s_cbranch_scc0 L_xgd_24
s_sleep 2
buffer_load_dwordx4 v[208:211], v246, s[64:67], s78 offen offset:0 sc1
buffer_load_dwordx4 v[212:215], v246, s[64:67], s78 offen offset:1024 sc1
buffer_load_dwordx4 v[216:219], v246, s[64:67], s78 offen offset:2048 sc1
buffer_load_dwordx4 v[220:223], v246, s[64:67], s78 offen offset:3072 sc1
s_waitcnt vmcnt(0)
s_branch L_xg_23
L_xgd_24:
ds_write_b128 v47, v[132:135] offset:5120
v_lshlrev_b32 v184, 16, v208
v_and_b32 v185, 0xffff0000, v208
v_lshlrev_b32 v186, 16, v209
v_and_b32 v187, 0xffff0000, v209
v_lshlrev_b32 v188, 16, v210
v_and_b32 v189, 0xffff0000, v210
v_lshlrev_b32 v190, 16, v212
v_and_b32 v191, 0xffff0000, v212
v_lshlrev_b32 v192, 16, v213
v_and_b32 v193, 0xffff0000, v213
v_lshlrev_b32 v194, 16, v214
v_and_b32 v195, 0xffff0000, v214
v_lshlrev_b32 v196, 16, v216
v_and_b32 v197, 0xffff0000, v216
v_lshlrev_b32 v198, 16, v217
v_and_b32 v199, 0xffff0000, v217
v_lshlrev_b32 v200, 16, v218
v_and_b32 v201, 0xffff0000, v218
v_lshlrev_b32 v202, 16, v220
v_and_b32 v203, 0xffff0000, v220
v_lshlrev_b32 v204, 16, v221
v_and_b32 v205, 0xffff0000, v221
v_lshlrev_b32_e64 v206, 16, v222
v_and_b32 v207, 0xffff0000, v222
v_pk_add_f32 v[160:161], v[160:161], v[184:185]
v_pk_add_f32 v[162:163], v[162:163], v[186:187]
v_pk_add_f32 v[164:165], v[164:165], v[188:189]
v_pk_add_f32 v[166:167], v[166:167], v[190:191]
v_pk_add_f32 v[168:169], v[168:169], v[192:193]
v_pk_add_f32 v[170:171], v[170:171], v[194:195]
v_pk_add_f32 v[172:173], v[172:173], v[196:197]
v_pk_add_f32 v[174:175], v[174:175], v[198:199]
v_pk_add_f32 v[176:177], v[176:177], v[200:201]
v_pk_add_f32 v[178:179], v[178:179], v[202:203]
v_pk_add_f32 v[180:181], v[180:181], v[204:205]
v_pk_add_f32 v[182:183], v[182:183], v[206:207]
v_pk_add_f32 v[10:11], v[136:137], v[160:161]
v_pk_add_f32 v[12:13], v[138:139], v[162:163]
v_pk_add_f32 v[14:15], v[140:141], v[164:165]
v_pk_add_f32 v[16:17], v[142:143], v[166:167]
v_pk_add_f32 v[18:19], v[144:145], v[168:169]
v_pk_add_f32 v[20:21], v[146:147], v[170:171]
v_pk_add_f32 v[22:23], v[148:149], v[172:173]
v_pk_add_f32 v[24:25], v[150:151], v[174:175]
v_pk_add_f32 v[26:27], v[152:153], v[176:177]
v_pk_add_f32 v[28:29], v[154:155], v[178:179]
v_pk_add_f32 v[30:31], v[156:157], v[180:181]
v_pk_add_f32 v[32:33], v[158:159], v[182:183]
s_waitcnt lgkmcnt(0)
s_barrier
ds_read_b128 v[184:187], v48 offset:0
ds_read_b128 v[188:191], v48 offset:1024
ds_read_b128 v[192:195], v48 offset:2048
ds_read_b128 v[196:199], v48 offset:3072
ds_read_b128 v[200:203], v48 offset:4096
ds_read_b128 v[204:207], v48 offset:5120
s_waitcnt lgkmcnt(4)
s_nop 0
v_pk_add_f32 v[10:11], v[10:11], v[184:185]
v_pk_add_f32 v[12:13], v[12:13], v[186:187]
v_pk_add_f32 v[14:15], v[14:15], v[188:189]
v_pk_add_f32 v[16:17], v[16:17], v[190:191]
v_pk_mul_f32 v[50:51], v[10:11], v[10:11]
s_add_u32 m0, s62, 49152
s_add_u32 s60, s60, 65536
s_cmp_eq_u32 s60, s1
s_cselect_b32 s60, s0, s60
buffer_load_dwordx4 v240, s[48:51], s60 offen lds
v_pk_mul_f32 v[52:53], v[12:13], v[12:13]
v_pk_mul_f32 v[54:55], v[14:15], v[14:15]
v_pk_mul_f32 v[56:57], v[16:17], v[16:17]
v_pk_fma_f32 v[50:51], v[50:51], s[80:81], s[80:81] op_sel:[0,0,1] op_sel_hi:[1,0,1]
v_pk_fma_f32 v[52:53], v[52:53], s[80:81], s[80:81] op_sel:[0,0,1] op_sel_hi:[1,0,1]
buffer_load_dwordx4 v241, s[48:51], s60 offen offset:1024 lds
v_pk_fma_f32 v[54:55], v[54:55], s[80:81], s[80:81] op_sel:[0,0,1] op_sel_hi:[1,0,1]
v_pk_fma_f32 v[56:57], v[56:57], s[80:81], s[80:81] op_sel:[0,0,1] op_sel_hi:[1,0,1]
v_pk_mul_f32 v[50:51], v[50:51], v[10:11]
v_pk_mul_f32 v[52:53], v[52:53], v[12:13]
v_pk_mul_f32 v[54:55], v[54:55], v[14:15]
s_add_u32 m0, s62, 51200
s_add_u32 s60, s60, 65536
buffer_load_dwordx4 v240, s[48:51], s60 offen lds
v_pk_mul_f32 v[56:57], v[56:57], v[16:17]
v_exp_f32 v50, v50
v_exp_f32 v51, v51
v_exp_f32 v52, v52
v_exp_f32 v53, v53
buffer_load_dwordx4 v241, s[48:51], s60 offen offset:1024 lds
v_exp_f32 v54, v54
v_exp_f32 v55, v55
v_exp_f32 v56, v56
v_exp_f32 v57, v57
v_pk_add_f32 v[50:51], v[50:51], 1.0 op_sel_hi:[1,0]
s_add_u32 m0, s62, 53248
s_add_u32 s60, s60, 65536
s_cmp_eq_u32 s60, s1
s_cselect_b32 s60, s0, s60
buffer_load_dwordx4 v240, s[48:51], s60 offen lds
v_pk_add_f32 v[52:53], v[52:53], 1.0 op_sel_hi:[1,0]
v_pk_add_f32 v[54:55], v[54:55], 1.0 op_sel_hi:[1,0]
v_pk_add_f32 v[56:57], v[56:57], 1.0 op_sel_hi:[1,0]
v_rcp_f32 v50, v50
v_rcp_f32 v51, v51
buffer_load_dwordx4 v241, s[48:51], s60 offen offset:1024 lds
v_rcp_f32 v52, v52
v_rcp_f32 v53, v53
v_rcp_f32 v54, v54
v_rcp_f32 v55, v55
v_rcp_f32 v56, v56
s_add_u32 m0, s62, 55296
s_add_u32 s60, s60, 65536
buffer_load_dwordx4 v240, s[48:51], s60 offen lds
v_rcp_f32 v57, v57
v_pk_mul_f32 v[50:51], v[50:51], v[10:11]
v_pk_mul_f32 v[52:53], v[52:53], v[12:13]
v_pk_mul_f32 v[54:55], v[54:55], v[14:15]
v_pk_mul_f32 v[56:57], v[56:57], v[16:17]
buffer_load_dwordx4 v241, s[48:51], s60 offen offset:1024 lds
v_cvt_pk_bf16_f32 v208, v50, v51
v_cvt_pk_bf16_f32 v209, v52, v53
v_cvt_pk_bf16_f32 v210, v54, v55
v_cvt_pk_bf16_f32 v211, v56, v57
s_cmp_lt_u32 s72, 43
s_cbranch_scc0 L_gsk_25
buffer_store_dwordx4 v[208:211], v246, s[64:67], s73 offen offset:0 sc1
L_gsk_25:
s_waitcnt lgkmcnt(2)
v_pk_add_f32 v[18:19], v[18:19], v[192:193]
s_add_u32 m0, s62, 57344
s_add_u32 s60, s60, 65536
s_cmp_eq_u32 s60, s1
s_cselect_b32 s60, s0, s60
buffer_load_dwordx4 v240, s[48:51], s60 offen lds
v_pk_add_f32 v[20:21], v[20:21], v[194:195]
v_pk_add_f32 v[22:23], v[22:23], v[196:197]
v_pk_add_f32 v[24:25], v[24:25], v[198:199]
v_pk_mul_f32 v[50:51], v[18:19], v[18:19]
v_pk_mul_f32 v[52:53], v[20:21], v[20:21]
buffer_load_dwordx4 v241, s[48:51], s60 offen offset:1024 lds
v_pk_mul_f32 v[54:55], v[22:23], v[22:23]
v_pk_mul_f32 v[56:57], v[24:25], v[24:25]
v_pk_fma_f32 v[50:51], v[50:51], s[80:81], s[80:81] op_sel:[0,0,1] op_sel_hi:[1,0,1]
v_pk_fma_f32 v[52:53], v[52:53], s[80:81], s[80:81] op_sel:[0,0,1] op_sel_hi:[1,0,1]
v_pk_fma_f32 v[54:55], v[54:55], s[80:81], s[80:81] op_sel:[0,0,1] op_sel_hi:[1,0,1]
s_add_u32 m0, s62, 59392
s_add_u32 s60, s60, 65536
buffer_load_dwordx4 v240, s[48:51], s60 offen lds
v_pk_fma_f32 v[56:57], v[56:57], s[80:81], s[80:81] op_sel:[0,0,1] op_sel_hi:[1,0,1]
v_pk_mul_f32 v[50:51], v[50:51], v[18:19]
v_pk_mul_f32 v[52:53], v[52:53], v[20:21]
v_pk_mul_f32 v[54:55], v[54:55], v[22:23]
v_pk_mul_f32 v[56:57], v[56:57], v[24:25]
buffer_load_dwordx4 v241, s[48:51], s60 offen offset:1024 lds
v_exp_f32 v50, v50
v_exp_f32 v51, v51
v_exp_f32 v52, v52
v_exp_f32 v53, v53
v_exp_f32 v54, v54
s_waitcnt lgkmcnt(0)
s_barrier
v_exp_f32 v55, v55
v_exp_f32 v56, v56
v_exp_f32 v57, v57
v_pk_add_f32 v[50:51], v[50:51], 1.0 op_sel_hi:[1,0]
v_pk_add_f32 v[52:53], v[52:53], 1.0 op_sel_hi:[1,0]
s_add_u32 m0, s62, 24576
s_add_u32 s60, s60, 65536
s_cmp_eq_u32 s60, s1
s_cselect_b32 s60, s0, s60
buffer_load_dwordx4 v240, s[48:51], s60 offen lds
v_pk_add_f32 v[54:55], v[54:55], 1.0 op_sel_hi:[1,0]
v_pk_add_f32 v[56:57], v[56:57], 1.0 op_sel_hi:[1,0]
v_rcp_f32 v50, v50
v_rcp_f32 v51, v51
v_rcp_f32 v52, v52
buffer_load_dwordx4 v241, s[48:51], s60 offen offset:1024 lds
v_rcp_f32 v53, v53
v_rcp_f32 v54, v54
v_rcp_f32 v55, v55
v_rcp_f32 v56, v56
v_rcp_f32 v57, v57
s_add_u32 m0, s62, 26624
s_add_u32 s60, s60, 65536
buffer_load_dwordx4 v240, s[48:51], s60 offen lds
v_pk_mul_f32 v[50:51], v[50:51], v[18:19]
v_pk_mul_f32 v[52:53], v[52:53], v[20:21]
v_pk_mul_f32 v[54:55], v[54:55], v[22:23]
v_pk_mul_f32 v[56:57], v[56:57], v[24:25]
v_cvt_pk_bf16_f32 v212, v50, v51
buffer_load_dwordx4 v241, s[48:51], s60 offen offset:1024 lds
v_cvt_pk_bf16_f32 v213, v52, v53
v_cvt_pk_bf16_f32 v214, v54, v55
v_cvt_pk_bf16_f32 v215, v56, v57
s_cmp_lt_u32 s72, 42
s_cbranch_scc0 L_gsk_26
buffer_store_dwordx4 v[212:215], v246, s[64:67], s73 offen offset:1024 sc1
L_gsk_26:
v_pk_add_f32 v[26:27], v[26:27], v[200:201]
v_pk_add_f32 v[28:29], v[28:29], v[202:203]
s_add_u32 m0, s62, 28672
s_add_u32 s60, s60, 65536
s_cmp_eq_u32 s60, s1
s_cselect_b32 s60, s0, s60
buffer_load_dwordx4 v240, s[48:51], s60 offen lds
v_pk_add_f32 v[30:31], v[30:31], v[204:205]
v_pk_add_f32 v[32:33], v[32:33], v[206:207]
v_pk_mul_f32 v[50:51], v[26:27], v[26:27]
v_pk_mul_f32 v[52:53], v[28:29], v[28:29]
v_pk_mul_f32 v[54:55], v[30:31], v[30:31]
buffer_load_dwordx4 v241, s[48:51], s60 offen offset:1024 lds
v_pk_mul_f32 v[56:57], v[32:33], v[32:33]
v_pk_fma_f32 v[50:51], v[50:51], s[80:81], s[80:81] op_sel:[0,0,1] op_sel_hi:[1,0,1]
v_pk_fma_f32 v[52:53], v[52:53], s[80:81], s[80:81] op_sel:[0,0,1] op_sel_hi:[1,0,1]
v_pk_fma_f32 v[54:55], v[54:55], s[80:81], s[80:81] op_sel:[0,0,1] op_sel_hi:[1,0,1]
v_pk_fma_f32 v[56:57], v[56:57], s[80:81], s[80:81] op_sel:[0,0,1] op_sel_hi:[1,0,1]
v_pk_mul_f32 v[50:51], v[50:51], v[26:27]
v_pk_mul_f32 v[52:53], v[52:53], v[28:29]
v_pk_mul_f32 v[54:55], v[54:55], v[30:31]
v_pk_mul_f32 v[56:57], v[56:57], v[32:33]
v_exp_f32 v50, v50
v_exp_f32 v51, v51
v_exp_f32 v52, v52
v_exp_f32 v53, v53
v_exp_f32 v54, v54
v_exp_f32 v55, v55
v_exp_f32 v56, v56
v_exp_f32 v57, v57
v_pk_add_f32 v[50:51], v[50:51], 1.0 op_sel_hi:[1,0]
v_pk_add_f32 v[52:53], v[52:53], 1.0 op_sel_hi:[1,0]
v_pk_add_f32 v[54:55], v[54:55], 1.0 op_sel_hi:[1,0]
v_pk_add_f32 v[56:57], v[56:57], 1.0 op_sel_hi:[1,0]
v_rcp_f32 v50, v50
v_rcp_f32 v51, v51
v_rcp_f32 v52, v52
v_rcp_f32 v53, v53
v_rcp_f32 v54, v54
v_rcp_f32 v55, v55
v_rcp_f32 v56, v56
v_rcp_f32_e64 v57, v57
v_pk_mul_f32 v[50:51], v[50:51], v[26:27]
v_pk_mul_f32 v[52:53], v[52:53], v[28:29]
v_pk_mul_f32 v[54:55], v[54:55], v[30:31]
v_pk_mul_f32 v[56:57], v[56:57], v[32:33]
v_cvt_pk_bf16_f32 v216, v50, v51
v_cvt_pk_bf16_f32 v217, v52, v53
v_cvt_pk_bf16_f32 v218, v54, v55
v_cvt_pk_bf16_f32 v219, v56, v57
s_cmp_lt_u32 s72, 41
s_cbranch_scc0 L_gsk_27
buffer_store_dwordx4 v[216:219], v246, s[64:67], s73 offen offset:2048 sc1
L_gsk_27:
ds_read_b64_tr_b16 a[0:1], v248 offset:0
ds_read_b64_tr_b16 a[4:5], v249 offset:0
ds_read_b64_tr_b16 a[8:9], v250 offset:0
ds_read_b64_tr_b16 a[12:13], v251 offset:0
ds_read_b64_tr_b16 a[2:3], v248 offset:2048
ds_read_b64_tr_b16 a[6:7], v249 offset:2048
ds_read_b64_tr_b16 a[10:11], v250 offset:2048
ds_read_b64_tr_b16 a[14:15], v251 offset:2048
ds_read_b64_tr_b16 a[16:17], v248 offset:4096
ds_read_b64_tr_b16 a[20:21], v249 offset:4096
ds_read_b64_tr_b16 a[24:25], v250 offset:4096
ds_read_b64_tr_b16 a[28:29], v251 offset:4096
s_waitcnt lgkmcnt(8)
ds_read_b64_tr_b16 a[18:19], v248 offset:6144
ds_read_b64_tr_b16 a[22:23], v249 offset:6144
ds_read_b64_tr_b16 a[26:27], v250 offset:6144
ds_read_b64_tr_b16 a[30:31], v251 offset:6144
s_waitcnt lgkmcnt(8)
ds_read_b64_tr_b16 a[32:33], v248 offset:8192
ds_read_b64_tr_b16 a[36:37], v249 offset:8192
ds_read_b64_tr_b16 a[40:41], v250 offset:8192
ds_read_b64_tr_b16 a[44:45], v251 offset:8192
s_waitcnt lgkmcnt(8)
ds_read_b64_tr_b16 a[34:35], v248 offset:10240
ds_read_b64_tr_b16 a[38:39], v249 offset:10240
ds_read_b64_tr_b16 a[42:43], v250 offset:10240
ds_read_b64_tr_b16 a[46:47], v251 offset:10240
s_waitcnt vmcnt(16) lgkmcnt(8)
ds_read_b64_tr_b16 a[48:49], v248 offset:49152
ds_read_b64_tr_b16 a[52:53], v249 offset:49152
ds_read_b64_tr_b16 a[56:57], v250 offset:49152
ds_read_b64_tr_b16 a[60:61], v251 offset:49152
s_waitcnt vmcnt(14) lgkmcnt(8)
ds_read_b64_tr_b16 a[50:51], v248 offset:51200
ds_read_b64_tr_b16 a[54:55], v249 offset:51200
ds_read_b64_tr_b16 a[58:59], v250 offset:51200
ds_read_b64_tr_b16 a[62:63], v251 offset:51200
s_waitcnt vmcnt(12) lgkmcnt(8)
ds_read_b64_tr_b16 a[64:65], v248 offset:53248
ds_read_b64_tr_b16 a[68:69], v249 offset:53248
ds_read_b64_tr_b16 a[72:73], v250 offset:53248
ds_read_b64_tr_b16 a[76:77], v251 offset:53248
s_waitcnt vmcnt(10) lgkmcnt(8)
ds_read_b64_tr_b16 a[66:67], v248 offset:55296
ds_read_b64_tr_b16 a[70:71], v249 offset:55296
ds_read_b64_tr_b16 a[74:75], v250 offset:55296
ds_read_b64_tr_b16 a[78:79], v251 offset:55296
s_waitcnt vmcnt(8) lgkmcnt(8)
ds_read_b64_tr_b16 a[80:81], v248 offset:57344
ds_read_b64_tr_b16 a[84:85], v249 offset:57344
ds_read_b64_tr_b16 a[88:89], v250 offset:57344
ds_read_b64_tr_b16 a[92:93], v251 offset:57344
s_waitcnt vmcnt(6) lgkmcnt(8)
ds_read_b64_tr_b16 a[82:83], v248 offset:59392
ds_read_b64_tr_b16 a[86:87], v249 offset:59392
ds_read_b64_tr_b16 a[90:91], v250 offset:59392
ds_read_b64_tr_b16 a[94:95], v251 offset:59392
s_lshl2_add_u32 s70, s8, s26
s_lshl_b32 s74, s70, 6
s_add_u32 s74, s74, 6955008
s_and_b32 s70, s4, 1
s_lshl_b32 s70, s70, 13
s_add_u32 s74, s74, s70
v_and_b32 v26, 3, v2
v_lshlrev_b32 v26, 4, v26
s_lshl_b32 s68, s8, 16
s_lshl_b32 s69, s26, 13
s_add_u32 s68, s68, s69
s_add_u32 s72, s68, 2097152
s_mul_i32 s71, s9, 176128
s_add_u32 s71, s71, 4194304
s_add_u32 s63, s63, s71
s_lshr_b32 s22, s0, 7
s_lshr_b32 s23, s1, 7
s_add_u32 s22, s22, s71
s_add_u32 s23, s23, s71
v_mov_b32 v18, v246
v_add_u32 v19, 44032, v18
v_add_u32 v20, 44032, v19
v_add_u32 v21, 44032, v20
v_lshrrev_b32 v24, 4, v2
v_and_b32 v25, 15, v2
v_lshlrev_b32 v25, 4, v25
v_lshl_add_u32 v22, v24, 9, v25
v_add_u32 v23, 32768, v22
s_waitcnt vmcnt(0)
s_barrier
s_cmp_lg_u32 s26, 0
s_cbranch_scc1 L_pub_28
s_lshl_b32 s68, s20, 4
s_add_u32 s68, s68, 6938624
v_lshlrev_b32 v3, 11, v2
v_mov_b32 v4, s27
s_mov_b64 exec, 255
buffer_store_dword v4, v3, s[64:67], s68 offen sc1
s_mov_b64 exec, -1
L_pub_28:
s_add_u32 m0, s62, 30720
s_add_u32 s60, s60, 65536
buffer_load_dwordx4 v240, s[48:51], s60 offen lds
buffer_load_dwordx4 v241, s[48:51], s60 offen offset:1024 lds
s_add_u32 m0, s62, 32768
s_add_u32 s61, s83, 0
s_and_b32 s61, s61, 7
s_lshl3_add_u32 s61, s26, s61
s_lshl_b32 s61, s61, 14
buffer_load_dwordx4 v242, s[36:39], s61 offen lds
buffer_load_dwordx4 v243, s[36:39], s61 offen offset:1024 lds
s_add_u32 m0, s62, 34816
s_add_u32 s61, s83, 1
s_and_b32 s61, s61, 7
s_lshl3_add_u32 s61, s26, s61
s_lshl_b32 s61, s61, 14
buffer_load_dwordx4 v242, s[36:39], s61 offen lds
buffer_load_dwordx4 v243, s[36:39], s61 offen offset:1024 lds
s_add_u32 m0, s62, 0
s_add_u32 s61, s83, 2
s_and_b32 s61, s61, 7
s_lshl3_add_u32 s61, s26, s61
s_lshl_b32 s61, s61, 14
buffer_load_dwordx4 v242, s[36:39], s61 offen lds
buffer_load_dwordx4 v243, s[36:39], s61 offen offset:1024 lds
s_add_u32 m0, s62, 2048
s_add_u32 s61, s83, 3
s_and_b32 s61, s61, 7
s_lshl3_add_u32 s61, s26, s61
s_lshl_b32 s61, s61, 14
buffer_load_dwordx4 v242, s[36:39], s61 offen lds
buffer_load_dwordx4 v243, s[36:39], s61 offen offset:1024 lds
s_add_u32 m0, s62, 4096
s_add_u32 s61, s83, 4
s_and_b32 s61, s61, 7
s_lshl3_add_u32 s61, s26, s61
s_lshl_b32 s61, s61, 14
buffer_load_dwordx4 v242, s[36:39], s61 offen lds
buffer_load_dwordx4 v243, s[36:39], s61 offen offset:1024 lds
s_waitcnt lgkmcnt(8)
ds_read_b64_tr_b16 a[96:97], v248 offset:24576
ds_read_b64_tr_b16 a[100:101], v249 offset:24576
ds_read_b64_tr_b16 a[104:105], v250 offset:24576
ds_read_b64_tr_b16 a[108:109], v251 offset:24576
s_add_u32 m0, s62, 6144
s_add_u32 s61, s83, 5
s_and_b32 s61, s61, 7
s_lshl3_add_u32 s61, s26, s61
s_lshl_b32 s61, s61, 14
buffer_load_dwordx4 v242, s[36:39], s61 offen lds
buffer_load_dwordx4 v243, s[36:39], s61 offen offset:1024 lds
s_waitcnt lgkmcnt(8)
ds_read_b64_tr_b16 a[98:99], v248 offset:26624
ds_read_b64_tr_b16 a[102:103], v249 offset:26624
ds_read_b64_tr_b16 a[106:107], v250 offset:26624
ds_read_b64_tr_b16 a[110:111], v251 offset:26624
s_add_u32 m0, s62, 8192
s_add_u32 s61, s83, 6
s_and_b32 s61, s61, 7
s_lshl3_add_u32 s61, s26, s61
s_lshl_b32 s61, s61, 14
buffer_load_dwordx4 v242, s[36:39], s61 offen lds
buffer_load_dwordx4 v243, s[36:39], s61 offen offset:1024 lds
s_waitcnt lgkmcnt(8)
ds_read_b64_tr_b16 a[112:113], v248 offset:28672
ds_read_b64_tr_b16 a[116:117], v249 offset:28672
ds_read_b64_tr_b16 a[120:121], v250 offset:28672
ds_read_b64_tr_b16 a[124:125], v251 offset:28672
s_add_u32 m0, s62, 10240
s_add_u32 s61, s83, 7
s_and_b32 s61, s61, 7
s_lshl3_add_u32 s61, s26, s61
s_lshl_b32 s61, s61, 14
buffer_load_dwordx4 v242, s[36:39], s61 offen lds
buffer_load_dwordx4 v243, s[36:39], s61 offen offset:1024 lds
s_waitcnt vmcnt(16) lgkmcnt(8)
ds_read_b64_tr_b16 a[114:115], v248 offset:30720
ds_read_b64_tr_b16 a[118:119], v249 offset:30720
ds_read_b64_tr_b16 a[122:123], v250 offset:30720
ds_read_b64_tr_b16 a[126:127], v251 offset:30720
s_waitcnt vmcnt(14) lgkmcnt(8)
ds_read_b64_tr_b16 a[176:177], v248 offset:32768
ds_read_b64_tr_b16 a[180:181], v249 offset:32768
ds_read_b64_tr_b16 a[184:185], v250 offset:32768
ds_read_b64_tr_b16 a[188:189], v251 offset:32768
s_waitcnt vmcnt(12) lgkmcnt(8)
ds_read_b64_tr_b16 a[178:179], v248 offset:34816
ds_read_b64_tr_b16 a[182:183], v249 offset:34816
ds_read_b64_tr_b16 a[186:187], v250 offset:34816
ds_read_b64_tr_b16 a[190:191], v251 offset:34816
s_waitcnt vmcnt(10) lgkmcnt(8)
ds_read_b64_tr_b16 a[192:193], v248 offset:0
ds_read_b64_tr_b16 a[196:197], v249 offset:0
ds_read_b64_tr_b16 a[200:201], v250 offset:0
ds_read_b64_tr_b16 a[204:205], v251 offset:0
s_waitcnt vmcnt(8) lgkmcnt(8)
ds_read_b64_tr_b16 a[194:195], v248 offset:2048
ds_read_b64_tr_b16 a[198:199], v249 offset:2048
ds_read_b64_tr_b16 a[202:203], v250 offset:2048
ds_read_b64_tr_b16 a[206:207], v251 offset:2048
s_waitcnt vmcnt(6) lgkmcnt(8)
ds_read_b64_tr_b16 a[208:209], v248 offset:4096
ds_read_b64_tr_b16 a[212:213], v249 offset:4096
ds_read_b64_tr_b16 a[216:217], v250 offset:4096
ds_read_b64_tr_b16 a[220:221], v251 offset:4096
s_waitcnt vmcnt(4) lgkmcnt(8)
ds_read_b64_tr_b16 a[210:211], v248 offset:6144
ds_read_b64_tr_b16 a[214:215], v249 offset:6144
ds_read_b64_tr_b16 a[218:219], v250 offset:6144
ds_read_b64_tr_b16 a[222:223], v251 offset:6144
s_waitcnt vmcnt(2) lgkmcnt(8)
ds_read_b64_tr_b16 a[224:225], v248 offset:8192
ds_read_b64_tr_b16 a[228:229], v249 offset:8192
ds_read_b64_tr_b16 a[232:233], v250 offset:8192
ds_read_b64_tr_b16 a[236:237], v251 offset:8192
s_waitcnt vmcnt(0) lgkmcnt(8)
ds_read_b64_tr_b16 a[226:227], v248 offset:10240
ds_read_b64_tr_b16 a[230:231], v249 offset:10240
ds_read_b64_tr_b16 a[234:235], v250 offset:10240
ds_read_b64_tr_b16 a[238:239], v251 offset:10240
s_lshr_b32 s70, s9, 1
s_lshl_b32 s70, s70, 5
s_mul_i32 s71, s26, 7
s_and_b32 s71, s71, 30
s_add_u32 s70, s70, s71
s_lshl_b32 s24, s70, 4
s_add_u32 s24, s24, 6938624
s_add_u32 s24, s24, s11
v_min_u32 v6, 9, v2
v_lshlrev_b32 v6, 4, v6
buffer_load_dword v7, v6, s[64:67], s24 offen sc1
s_add_u32 m0, s62, 49152
s_add_u32 s60, s60, 65536
s_cmp_eq_u32 s60, s1
s_cselect_b32 s60, s0, s60
buffer_load_dwordx4 v240, s[48:51], s60 offen lds
buffer_load_dwordx4 v241, s[48:51], s60 offen offset:1024 lds
s_add_u32 m0, s62, 51200
s_add_u32 s60, s60, 65536
buffer_load_dwordx4 v240, s[48:51], s60 offen lds
buffer_load_dwordx4 v241, s[48:51], s60 offen offset:1024 lds
s_add_u32 m0, s62, 53248
s_add_u32 s60, s60, 65536
s_cmp_eq_u32 s60, s1
s_cselect_b32 s60, s0, s60
buffer_load_dwordx4 v240, s[48:51], s60 offen lds
buffer_load_dwordx4 v241, s[48:51], s60 offen offset:1024 lds
s_add_u32 m0, s62, 55296
s_add_u32 s60, s60, 65536
buffer_load_dwordx4 v240, s[48:51], s60 offen lds
buffer_load_dwordx4 v241, s[48:51], s60 offen offset:1024 lds
s_add_u32 m0, s62, 57344
s_add_u32 s60, s60, 65536
s_cmp_eq_u32 s60, s1
s_cselect_b32 s60, s0, s60
s_cmp_eq_u32 s26, 3
s_cselect_b32 s60, 5636096, s60
buffer_load_dwordx4 v240, s[48:51], s60 offen lds
buffer_load_dwordx4 v241, s[48:51], s60 offen offset:1024 lds
s_add_u32 m0, s62, 59392
s_add_u32 s60, s60, 65536
buffer_load_dwordx4 v240, s[48:51], s60 offen lds
buffer_load_dwordx4 v241, s[48:51], s60 offen offset:1024 lds
s_waitcnt vmcnt(12) lgkmcnt(0)
v_cmp_ne_u32 vcc, s27, v7
s_cbranch_vccz L_go_29
s_mov_b32 s25, 0
L_poll_31:
v_cmp_ne_u32 vcc, s27, v7
s_cbranch_vccz L_polld_32
s_add_u32 s25, s25, 1
s_cmp_lt_u32 s25, 262144
s_cbranch_scc0 L_polld_32
s_sleep 1
buffer_load_dword v7, v6, s[64:67], s24 offen sc1
s_waitcnt vmcnt(0)
s_branch L_poll_31
L_polld_32:
L_go_29:
L_p2:
buffer_load_dwordx4 v[128:131], v18, s[64:67], s63 offen sc1
buffer_load_dwordx4 v[132:135], v19, s[64:67], s63 offen sc1
buffer_load_dwordx4 v[136:139], v20, s[64:67], s63 offen sc1
buffer_load_dwordx4 v[140:143], v21, s[64:67], s63 offen sc1
s_add_u32 s63, s63, 1024
s_cmp_eq_u32 s63, s23
s_cselect_b32 s63, s22, s63
buffer_load_dwordx4 v[144:147], v18, s[64:67], s63 offen sc1
buffer_load_dwordx4 v[148:151], v19, s[64:67], s63 offen sc1
buffer_load_dwordx4 v[152:155], v20, s[64:67], s63 offen sc1
buffer_load_dwordx4 v[156:159], v21, s[64:67], s63 offen sc1
s_add_u32 s63, s63, 1024
s_cmp_eq_u32 s63, s23
s_cselect_b32 s63, s22, s63
buffer_load_dwordx4 v[160:163], v18, s[64:67], s63 offen sc1
buffer_load_dwordx4 v[164:167], v19, s[64:67], s63 offen sc1
s_waitcnt vmcnt(9)
v_mfma_f32_16x16x32_bf16 v[64:67], v[128:131], a[0:3], 0
buffer_load_dwordx4 v[168:171], v20, s[64:67], s63 offen sc1
v_mfma_f32_16x16x32_bf16 v[68:71], v[128:131], a[4:7], 0
ds_read_b64_tr_b16 a[128:129], v248 offset:49152
ds_read_b64_tr_b16 a[132:133], v249 offset:49152
ds_read_b64_tr_b16 a[136:137], v250 offset:49152
ds_read_b64_tr_b16 a[140:141], v251 offset:49152
v_mfma_f32_16x16x32_bf16 v[72:75], v[128:131], a[8:11], 0
ds_read_b64_tr_b16 a[130:131], v248 offset:51200
ds_read_b64_tr_b16 a[134:135], v249 offset:51200
ds_read_b64_tr_b16 a[138:139], v250 offset:51200
ds_read_b64_tr_b16 a[142:143], v251 offset:51200
v_mfma_f32_16x16x32_bf16 v[76:79], v[128:131], a[12:15], 0
s_waitcnt vmcnt(9)
v_mfma_f32_16x16x32_bf16 v[92:95], v[132:135], a[12:15], 0
buffer_load_dwordx4 v[172:175], v21, s[64:67], s63 offen sc1
v_mfma_f32_16x16x32_bf16 v[88:91], v[132:135], a[8:11], 0
s_add_u32 s63, s63, 1024
v_mfma_f32_16x16x32_bf16 v[84:87], v[132:135], a[4:7], 0
s_cmp_eq_u32 s63, s23
s_cselect_b32 s63, s22, s63
v_mfma_f32_16x16x32_bf16 v[80:83], v[132:135], a[0:3], 0
s_waitcnt vmcnt(9)
v_mfma_f32_16x16x32_bf16 v[96:99], v[136:139], a[0:3], 0
buffer_load_dwordx4 v[176:179], v18, s[64:67], s63 offen sc1
v_mfma_f32_16x16x32_bf16 v[100:103], v[136:139], a[4:7], 0
v_mfma_f32_16x16x32_bf16 v[104:107], v[136:139], a[8:11], 0
v_mfma_f32_16x16x32_bf16 v[108:111], v[136:139], a[12:15], 0
s_waitcnt vmcnt(9)
v_mfma_f32_16x16x32_bf16 v[124:127], v[140:143], a[12:15], 0
buffer_load_dwordx4 v[180:183], v19, s[64:67], s63 offen sc1
v_mfma_f32_16x16x32_bf16 v[120:123], v[140:143], a[8:11], 0
v_mfma_f32_16x16x32_bf16 v[116:119], v[140:143], a[4:7], 0
v_mfma_f32_16x16x32_bf16 v[112:115], v[140:143], a[0:3], 0
s_waitcnt vmcnt(9)
v_mfma_f32_16x16x32_bf16 v[64:67], v[144:147], a[16:19], v[64:67]
buffer_load_dwordx4 v[184:187], v20, s[64:67], s63 offen sc1
v_mfma_f32_16x16x32_bf16 v[68:71], v[144:147], a[20:23], v[68:71]
ds_read_b64_tr_b16 a[144:145], v248 offset:53248
ds_read_b64_tr_b16 a[148:149], v249 offset:53248
ds_read_b64_tr_b16 a[152:153], v250 offset:53248
ds_read_b64_tr_b16 a[156:157], v251 offset:53248
v_mfma_f32_16x16x32_bf16 v[72:75], v[144:147], a[24:27], v[72:75]
s_waitcnt lgkmcnt(8)
ds_read_b64_tr_b16 a[146:147], v248 offset:55296
ds_read_b64_tr_b16 a[150:151], v249 offset:55296
ds_read_b64_tr_b16 a[154:155], v250 offset:55296
ds_read_b64_tr_b16 a[158:159], v251 offset:55296
v_mfma_f32_16x16x32_bf16 v[76:79], v[144:147], a[28:31], v[76:79]
s_waitcnt vmcnt(9)
v_mfma_f32_16x16x32_bf16 v[92:95], v[148:151], a[28:31], v[92:95]
buffer_load_dwordx4 v[188:191], v21, s[64:67], s63 offen sc1
v_mfma_f32_16x16x32_bf16 v[88:91], v[148:151], a[24:27], v[88:91]
s_add_u32 s63, s63, 1024
v_mfma_f32_16x16x32_bf16 v[84:87], v[148:151], a[20:23], v[84:87]
s_cmp_eq_u32 s63, s23
s_cselect_b32 s63, s22, s63
v_mfma_f32_16x16x32_bf16 v[80:83], v[148:151], a[16:19], v[80:83]
s_waitcnt vmcnt(9)
v_mfma_f32_16x16x32_bf16 v[96:99], v[152:155], a[16:19], v[96:99]
buffer_load_dwordx4 v[192:195], v18, s[64:67], s63 offen sc1
v_mfma_f32_16x16x32_bf16 v[100:103], v[152:155], a[20:23], v[100:103]
v_mfma_f32_16x16x32_bf16 v[104:107], v[152:155], a[24:27], v[104:107]
v_mfma_f32_16x16x32_bf16 v[108:111], v[152:155], a[28:31], v[108:111]
s_waitcnt vmcnt(9)
v_mfma_f32_16x16x32_bf16 v[124:127], v[156:159], a[28:31], v[124:127]
buffer_load_dwordx4 v[196:199], v19, s[64:67], s63 offen sc1
v_mfma_f32_16x16x32_bf16 v[120:123], v[156:159], a[24:27], v[120:123]
v_mfma_f32_16x16x32_bf16 v[116:119], v[156:159], a[20:23], v[116:119]
v_mfma_f32_16x16x32_bf16 v[112:115], v[156:159], a[16:19], v[112:115]
s_waitcnt vmcnt(9)
v_mfma_f32_16x16x32_bf16 v[64:67], v[160:163], a[32:35], v[64:67]
buffer_load_dwordx4 v[200:203], v20, s[64:67], s63 offen sc1
v_mfma_f32_16x16x32_bf16 v[68:71], v[160:163], a[36:39], v[68:71]
s_waitcnt lgkmcnt(8)
ds_read_b64_tr_b16 a[160:161], v248 offset:57344
ds_read_b64_tr_b16 a[164:165], v249 offset:57344
ds_read_b64_tr_b16 a[168:169], v250 offset:57344
ds_read_b64_tr_b16 a[172:173], v251 offset:57344
v_mfma_f32_16x16x32_bf16 v[72:75], v[160:163], a[40:43], v[72:75]
s_waitcnt lgkmcnt(8)
ds_read_b64_tr_b16 a[162:163], v248 offset:59392
ds_read_b64_tr_b16 a[166:167], v249 offset:59392
ds_read_b64_tr_b16 a[170:171], v250 offset:59392
ds_read_b64_tr_b16 a[174:175], v251 offset:59392
v_mfma_f32_16x16x32_bf16 v[76:79], v[160:163], a[44:47], v[76:79]
s_waitcnt vmcnt(9)
v_mfma_f32_16x16x32_bf16 v[92:95], v[164:167], a[44:47], v[92:95]
buffer_load_dwordx4 v[204:207], v21, s[64:67], s63 offen sc1
v_mfma_f32_16x16x32_bf16 v[88:91], v[164:167], a[40:43], v[88:91]
s_add_u32 s63, s63, 1024
v_mfma_f32_16x16x32_bf16 v[84:87], v[164:167], a[36:39], v[84:87]
s_cmp_eq_u32 s63, s23
s_cselect_b32 s63, s22, s63
v_mfma_f32_16x16x32_bf16 v[80:83], v[164:167], a[32:35], v[80:83]
s_waitcnt vmcnt(9)
v_mfma_f32_16x16x32_bf16 v[96:99], v[168:171], a[32:35], v[96:99]
buffer_load_dwordx4 v[208:211], v18, s[64:67], s63 offen sc1
v_mfma_f32_16x16x32_bf16 v[100:103], v[168:171], a[36:39], v[100:103]
v_mfma_f32_16x16x32_bf16 v[104:107], v[168:171], a[40:43], v[104:107]
v_mfma_f32_16x16x32_bf16 v[108:111], v[168:171], a[44:47], v[108:111]
s_waitcnt vmcnt(9)
v_mfma_f32_16x16x32_bf16 v[124:127], v[172:175], a[44:47], v[124:127]
buffer_load_dwordx4 v[212:215], v19, s[64:67], s63 offen sc1
v_mfma_f32_16x16x32_bf16 v[120:123], v[172:175], a[40:43], v[120:123]
v_mfma_f32_16x16x32_bf16 v[116:119], v[172:175], a[36:39], v[116:119]
v_mfma_f32_16x16x32_bf16 v[112:115], v[172:175], a[32:35], v[112:115]
s_waitcnt vmcnt(9)
v_mfma_f32_16x16x32_bf16 v[64:67], v[176:179], a[48:51], v[64:67]
buffer_load_dwordx4 v[216:219], v20, s[64:67], s63 offen sc1
v_mfma_f32_16x16x32_bf16 v[68:71], v[176:179], a[52:55], v[68:71]
v_mfma_f32_16x16x32_bf16 v[72:75], v[176:179], a[56:59], v[72:75]
v_mfma_f32_16x16x32_bf16 v[76:79], v[176:179], a[60:63], v[76:79]
s_waitcnt vmcnt(9)
v_mfma_f32_16x16x32_bf16 v[92:95], v[180:183], a[60:63], v[92:95]
buffer_load_dwordx4 v[220:223], v21, s[64:67], s63 offen sc1
v_mfma_f32_16x16x32_bf16 v[88:91], v[180:183], a[56:59], v[88:91]
s_add_u32 s63, s63, 1024
v_mfma_f32_16x16x32_bf16 v[84:87], v[180:183], a[52:55], v[84:87]
s_cmp_eq_u32 s63, s23
s_cselect_b32 s63, s22, s63
v_mfma_f32_16x16x32_bf16 v[80:83], v[180:183], a[48:51], v[80:83]
s_waitcnt vmcnt(9)
v_mfma_f32_16x16x32_bf16 v[96:99], v[184:187], a[48:51], v[96:99]
buffer_load_dwordx4 v[224:227], v18, s[64:67], s63 offen sc1
v_mfma_f32_16x16x32_bf16 v[100:103], v[184:187], a[52:55], v[100:103]
v_mfma_f32_16x16x32_bf16 v[104:107], v[184:187], a[56:59], v[104:107]
v_mfma_f32_16x16x32_bf16 v[108:111], v[184:187], a[60:63], v[108:111]
s_waitcnt vmcnt(9)
v_mfma_f32_16x16x32_bf16 v[124:127], v[188:191], a[60:63], v[124:127]
buffer_load_dwordx4 v[228:231], v19, s[64:67], s63 offen sc1
v_mfma_f32_16x16x32_bf16 v[120:123], v[188:191], a[56:59], v[120:123]
v_mfma_f32_16x16x32_bf16 v[116:119], v[188:191], a[52:55], v[116:119]
v_mfma_f32_16x16x32_bf16 v[112:115], v[188:191], a[48:51], v[112:115]
s_waitcnt vmcnt(9)
v_mfma_f32_16x16x32_bf16 v[64:67], v[192:195], a[64:67], v[64:67]
buffer_load_dwordx4 v[232:235], v20, s[64:67], s63 offen sc1
v_mfma_f32_16x16x32_bf16 v[68:71], v[192:195], a[68:71], v[68:71]
buffer_load_dword v27, v26, s[64:67], s74 offen sc1
v_mfma_f32_16x16x32_bf16 v[72:75], v[192:195], a[72:75], v[72:75]
v_mfma_f32_16x16x32_bf16 v[76:79], v[192:195], a[76:79], v[76:79]
s_waitcnt vmcnt(10)
v_mfma_f32_16x16x32_bf16 v[92:95], v[196:199], a[76:79], v[92:95]
buffer_load_dwordx4 v[236:239], v21, s[64:67], s63 offen sc1
v_mfma_f32_16x16x32_bf16 v[88:91], v[196:199], a[72:75], v[88:91]
s_add_u32 s63, s63, 1024
v_mfma_f32_16x16x32_bf16 v[84:87], v[196:199], a[68:71], v[84:87]
s_cmp_eq_u32 s63, s23
s_cselect_b32 s63, s22, s63
v_mfma_f32_16x16x32_bf16 v[80:83], v[196:199], a[64:67], v[80:83]
s_waitcnt vmcnt(10)
v_mfma_f32_16x16x32_bf16 v[96:99], v[200:203], a[64:67], v[96:99]
buffer_load_dwordx4 v[128:131], v18, s[64:67], s63 offen sc1
v_mfma_f32_16x16x32_bf16 v[100:103], v[200:203], a[68:71], v[100:103]
v_mfma_f32_16x16x32_bf16 v[104:107], v[200:203], a[72:75], v[104:107]
v_mfma_f32_16x16x32_bf16 v[108:111], v[200:203], a[76:79], v[108:111]
s_waitcnt vmcnt(10)
v_mfma_f32_16x16x32_bf16 v[124:127], v[204:207], a[76:79], v[124:127]
buffer_load_dwordx4 v[132:135], v19, s[64:67], s63 offen sc1
v_mfma_f32_16x16x32_bf16 v[120:123], v[204:207], a[72:75], v[120:123]
v_mfma_f32_16x16x32_bf16 v[116:119], v[204:207], a[68:71], v[116:119]
v_mfma_f32_16x16x32_bf16 v[112:115], v[204:207], a[64:67], v[112:115]
s_waitcnt vmcnt(10) lgkmcnt(0)
v_mfma_f32_16x16x32_bf16 v[64:67], v[208:211], a[80:83], v[64:67]
buffer_load_dwordx4 v[136:139], v20, s[64:67], s63 offen sc1
v_mfma_f32_16x16x32_bf16 v[68:71], v[208:211], a[84:87], v[68:71]
v_add_u32 v9, 8192, v247
v_mfma_f32_16x16x32_bf16 v[72:75], v[208:211], a[88:91], v[72:75]
v_accvgpr_read_b32 v10, a240
v_mfma_f32_16x16x32_bf16 v[76:79], v[208:211], a[92:95], v[76:79]
v_accvgpr_read_b32 v11, a241
s_waitcnt vmcnt(10)
v_mfma_f32_16x16x32_bf16 v[92:95], v[212:215], a[92:95], v[92:95]
buffer_load_dwordx4 v[140:143], v21, s[64:67], s63 offen sc1
v_mfma_f32_16x16x32_bf16 v[88:91], v[212:215], a[88:91], v[88:91]
s_add_u32 s63, s63, 1024
v_mfma_f32_16x16x32_bf16 v[84:87], v[212:215], a[84:87], v[84:87]
s_cmp_eq_u32 s63, s23
s_cselect_b32 s63, s22, s63
v_mfma_f32_16x16x32_bf16 v[80:83], v[212:215], a[80:83], v[80:83]
v_accvgpr_read_b32 v12, a242
s_waitcnt vmcnt(10)
v_mfma_f32_16x16x32_bf16 v[96:99], v[216:219], a[80:83], v[96:99]
buffer_load_dwordx4 v[144:147], v18, s[64:67], s63 offen sc1
v_mfma_f32_16x16x32_bf16 v[100:103], v[216:219], a[84:87], v[100:103]
v_accvgpr_read_b32 v13, a243
v_mfma_f32_16x16x32_bf16 v[104:107], v[216:219], a[88:91], v[104:107]
v_accvgpr_read_b32 v14, a244
v_mfma_f32_16x16x32_bf16 v[108:111], v[216:219], a[92:95], v[108:111]
v_accvgpr_read_b32 v15, a245
s_waitcnt vmcnt(10)
v_mfma_f32_16x16x32_bf16 v[124:127], v[220:223], a[92:95], v[124:127]
buffer_load_dwordx4 v[148:151], v19, s[64:67], s63 offen sc1
v_mfma_f32_16x16x32_bf16 v[120:123], v[220:223], a[88:91], v[120:123]
v_accvgpr_read_b32 v16, a246
v_mfma_f32_16x16x32_bf16 v[116:119], v[220:223], a[84:87], v[116:119]
v_accvgpr_read_b32 v17, a247
v_mfma_f32_16x16x32_bf16 v[112:115], v[220:223], a[80:83], v[112:115]
v_lshrrev_b32 v3, 5, v2
s_waitcnt vmcnt(10)
v_mfma_f32_16x16x32_bf16 v[64:67], v[224:227], a[96:99], v[64:67]
buffer_load_dwordx4 v[152:155], v20, s[64:67], s63 offen sc1
v_mfma_f32_16x16x32_bf16 v[68:71], v[224:227], a[100:103], v[68:71]
v_lshlrev_b32 v3, 5, v3
v_mfma_f32_16x16x32_bf16 v[72:75], v[224:227], a[104:107], v[72:75]
v_xor_b32 v3, v3, v246
v_mfma_f32_16x16x32_bf16 v[76:79], v[224:227], a[108:111], v[76:79]
v_xor_b32 v4, 0, v3
s_waitcnt vmcnt(10)
v_mfma_f32_16x16x32_bf16 v[92:95], v[228:231], a[108:111], v[92:95]
buffer_load_dwordx4 v[156:159], v21, s[64:67], s63 offen sc1
v_mfma_f32_16x16x32_bf16 v[88:91], v[228:231], a[104:107], v[88:91]
s_add_u32 s63, s63, 1024
v_mfma_f32_16x16x32_bf16 v[84:87], v[228:231], a[100:103], v[84:87]
s_cmp_eq_u32 s63, s23
s_cselect_b32 s63, s22, s63
v_mfma_f32_16x16x32_bf16 v[80:83], v[228:231], a[96:99], v[80:83]
v_add_u32 v56, s62, v4
s_waitcnt vmcnt(10)
v_mfma_f32_16x16x32_bf16 v[96:99], v[232:235], a[96:99], v[96:99]
buffer_load_dwordx4 v[160:163], v18, s[64:67], s63 offen sc1
v_mfma_f32_16x16x32_bf16 v[100:103], v[232:235], a[100:103], v[100:103]
v_xor_b32 v4, 64, v3
v_mfma_f32_16x16x32_bf16 v[104:107], v[232:235], a[104:107], v[104:107]
v_add_u32 v57, s62, v4
v_mfma_f32_16x16x32_bf16 v[108:111], v[232:235], a[108:111], v[108:111]
v_xor_b32 v4, 128, v3
s_waitcnt vmcnt(9)
v_mfma_f32_16x16x32_bf16 v[124:127], v[236:239], a[108:111], v[124:127]
buffer_load_dwordx4 v[164:167], v19, s[64:67], s63 offen sc1
v_mfma_f32_16x16x32_bf16 v[120:123], v[236:239], a[104:107], v[120:123]
v_add_u32 v58, s62, v4
v_mfma_f32_16x16x32_bf16 v[116:119], v[236:239], a[100:103], v[116:119]
v_xor_b32 v4, 192, v3
v_mfma_f32_16x16x32_bf16 v[112:115], v[236:239], a[96:99], v[112:115]
v_add_u32 v59, s62, v4
s_waitcnt vmcnt(9)
v_mfma_f32_16x16x32_bf16 v[64:67], v[128:131], a[112:115], v[64:67]
buffer_load_dwordx4 v[168:171], v20, s[64:67], s63 offen sc1
v_mfma_f32_16x16x32_bf16 v[68:71], v[128:131], a[116:119], v[68:71]
v_lshrrev_b32 v3, 3, v2
v_mfma_f32_16x16x32_bf16 v[72:75], v[128:131], a[120:123], v[72:75]
v_and_b32 v4, 7, v2
v_mfma_f32_16x16x32_bf16 v[76:79], v[128:131], a[124:127], v[76:79]
v_lshlrev_b32 v5, 1, v4
s_waitcnt vmcnt(9)
v_mfma_f32_16x16x32_bf16 v[92:95], v[132:135], a[124:127], v[92:95]
buffer_load_dwordx4 v[172:175], v21, s[64:67], s63 offen sc1
v_mfma_f32_16x16x32_bf16 v[88:91], v[132:135], a[120:123], v[88:91]
s_add_u32 s63, s63, 1024
v_mfma_f32_16x16x32_bf16 v[84:87], v[132:135], a[116:119], v[84:87]
s_cmp_eq_u32 s63, s23
s_cselect_b32 s63, s22, s63
v_mfma_f32_16x16x32_bf16 v[80:83], v[132:135], a[112:115], v[80:83]
v_xor_b32 v3, v3, v5
s_waitcnt vmcnt(9)
v_mfma_f32_16x16x32_bf16 v[96:99], v[136:139], a[112:115], v[96:99]
buffer_load_dwordx4 v[176:179], v18, s[64:67], s63 offen sc1
v_mfma_f32_16x16x32_bf16 v[100:103], v[136:139], a[116:119], v[100:103]
v_lshlrev_b32 v3, 4, v3
v_mfma_f32_16x16x32_bf16 v[104:107], v[136:139], a[120:123], v[104:107]
v_lshl_add_u32 v3, v4, 9, v3
v_mfma_f32_16x16x32_bf16 v[108:111], v[136:139], a[124:127], v[108:111]
s_lshl_b32 s68, s26, 12
s_waitcnt vmcnt(9)
v_mfma_f32_16x16x32_bf16 v[124:127], v[140:143], a[124:127], v[124:127]
buffer_load_dwordx4 v[180:183], v19, s[64:67], s63 offen sc1
v_mfma_f32_16x16x32_bf16 v[120:123], v[140:143], a[120:123], v[120:123]
s_cmp_eq_u32 s26, 3
s_cselect_b32 s68, 24576, s68
v_mfma_f32_16x16x32_bf16 v[116:119], v[140:143], a[116:119], v[116:119]
v_add_u32 v36, s68, v3
v_mfma_f32_16x16x32_bf16 v[112:115], v[140:143], a[112:115], v[112:115]
v_xor_b32 v37, 128, v36
s_waitcnt vmcnt(9)
v_mfma_f32_16x16x32_bf16 v[64:67], v[144:147], a[128:131], v[64:67]
buffer_load_dwordx4 v[184:187], v20, s[64:67], s63 offen sc1
v_mfma_f32_16x16x32_bf16 v[68:71], v[144:147], a[132:135], v[68:71]
v_add_u32 v38, 73728, v36
v_mfma_f32_16x16x32_bf16 v[72:75], v[144:147], a[136:139], v[72:75]
v_add_u32 v39, 73728, v37
v_mfma_f32_16x16x32_bf16 v[76:79], v[144:147], a[140:143], v[76:79]
v_lshlrev_b32 v8, 16, v0
s_waitcnt vmcnt(9)
v_mfma_f32_16x16x32_bf16 v[92:95], v[148:151], a[140:143], v[92:95]
buffer_load_dwordx4 v[188:191], v21, s[64:67], s63 offen sc1
v_mfma_f32_16x16x32_bf16 v[88:91], v[148:151], a[136:139], v[88:91]
s_add_u32 s63, s63, 1024
v_mfma_f32_16x16x32_bf16 v[84:87], v[148:151], a[132:135], v[84:87]
s_cmp_eq_u32 s63, s23
s_cselect_b32 s63, s22, s63
v_mfma_f32_16x16x32_bf16 v[80:83], v[148:151], a[128:131], v[80:83]
v_lshlrev_b32 v7, 16, v1
s_waitcnt vmcnt(9)
v_mfma_f32_16x16x32_bf16 v[96:99], v[152:155], a[128:131], v[96:99]
s_mov_b32 s25, 0
L_poll_33:
v_cmp_ne_u32 vcc, s27, v27
s_cbranch_vccz L_polld_34
s_add_u32 s25, s25, 1
s_cmp_lt_u32 s25, 262144
s_cbranch_scc0 L_polld_34
s_sleep 1
buffer_load_dword v27, v26, s[64:67], s74 offen sc1
s_waitcnt vmcnt(0)
s_branch L_poll_33
L_polld_34:
s_add_u32 s73, s83, 0
s_and_b32 s73, s73, 7
s_lshl_b32 s73, s73, 10
s_add_u32 s73, s73, s72
buffer_load_dwordx4 v[192:195], v22, s[64:67], s73 offen offset:0 sc1
v_mfma_f32_16x16x32_bf16 v[100:103], v[152:155], a[132:135], v[100:103]
v_lshlrev_b32 v40, 16, v10
v_mfma_f32_16x16x32_bf16 v[104:107], v[152:155], a[136:139], v[104:107]
v_and_b32 v41, 0xffff0000, v10
v_mfma_f32_16x16x32_bf16 v[108:111], v[152:155], a[140:143], v[108:111]
v_lshlrev_b32 v42, 16, v11
s_waitcnt vmcnt(9)
v_mfma_f32_16x16x32_bf16 v[124:127], v[156:159], a[140:143], v[124:127]
buffer_load_dwordx4 v[196:199], v22, s[64:67], s73 offen offset:256 sc1
v_mfma_f32_16x16x32_bf16 v[120:123], v[156:159], a[136:139], v[120:123]
v_and_b32 v43, 0xffff0000, v11
v_mfma_f32_16x16x32_bf16 v[116:119], v[156:159], a[132:135], v[116:119]
v_lshlrev_b32 v44, 16, v12
v_mfma_f32_16x16x32_bf16 v[112:115], v[156:159], a[128:131], v[112:115]
v_and_b32 v45, 0xffff0000, v12
s_waitcnt vmcnt(9)
v_mfma_f32_16x16x32_bf16 v[64:67], v[160:163], a[144:147], v[64:67]
buffer_load_dwordx4 v[200:203], v23, s[64:67], s73 offen offset:0 sc1
v_mfma_f32_16x16x32_bf16 v[68:71], v[160:163], a[148:151], v[68:71]
v_lshlrev_b32 v46, 16, v13
v_mfma_f32_16x16x32_bf16 v[72:75], v[160:163], a[152:155], v[72:75]
v_and_b32 v47, 0xffff0000, v13
v_mfma_f32_16x16x32_bf16 v[76:79], v[160:163], a[156:159], v[76:79]
v_lshlrev_b32 v48, 16, v14
s_waitcnt vmcnt(9)
v_mfma_f32_16x16x32_bf16 v[92:95], v[164:167], a[156:159], v[92:95]
buffer_load_dwordx4 v[204:207], v23, s[64:67], s73 offen offset:256 sc1
v_mfma_f32_16x16x32_bf16 v[88:91], v[164:167], a[152:155], v[88:91]
v_and_b32 v49, 0xffff0000, v14
v_mfma_f32_16x16x32_bf16 v[84:87], v[164:167], a[148:151], v[84:87]
v_lshlrev_b32 v50, 16, v15
v_mfma_f32_16x16x32_bf16 v[80:83], v[164:167], a[144:147], v[80:83]
v_and_b32 v51, 0xffff0000, v15
s_waitcnt vmcnt(9)
v_mfma_f32_16x16x32_bf16 v[96:99], v[168:171], a[144:147], v[96:99]
s_add_u32 s73, s83, 2
s_and_b32 s73, s73, 7
s_lshl_b32 s73, s73, 10
s_add_u32 s73, s73, s72
buffer_load_dwordx4 v[208:211], v22, s[64:67], s73 offen offset:0 sc1
v_mfma_f32_16x16x32_bf16 v[100:103], v[168:171], a[148:151], v[100:103]
v_lshlrev_b32 v52, 16, v16
v_mfma_f32_16x16x32_bf16 v[104:107], v[168:171], a[152:155], v[104:107]
v_and_b32 v53, 0xffff0000, v16
v_mfma_f32_16x16x32_bf16 v[108:111], v[168:171], a[156:159], v[108:111]
v_lshlrev_b32 v54, 16, v17
s_waitcnt vmcnt(9)
v_mfma_f32_16x16x32_bf16 v[124:127], v[172:175], a[156:159], v[124:127]
buffer_load_dwordx4 v[212:215], v22, s[64:67], s73 offen offset:256 sc1
v_mfma_f32_16x16x32_bf16 v[120:123], v[172:175], a[152:155], v[120:123]
v_and_b32 v55, 0xffff0000, v17
v_mfma_f32_16x16x32_bf16 v[116:119], v[172:175], a[148:151], v[116:119]
v_add_f32 v40, v40, v8
v_mfma_f32_16x16x32_bf16 v[112:115], v[172:175], a[144:147], v[112:115]
v_add_f32 v41, v41, v8
s_waitcnt vmcnt(9)
v_mfma_f32_16x16x32_bf16 v[64:67], v[176:179], a[160:163], v[64:67]
buffer_load_dwordx4 v[216:219], v23, s[64:67], s73 offen offset:0 sc1
v_mfma_f32_16x16x32_bf16 v[68:71], v[176:179], a[164:167], v[68:71]
v_add_f32 v42, v42, v8
v_mfma_f32_16x16x32_bf16 v[72:75], v[176:179], a[168:171], v[72:75]
v_add_f32 v43, v43, v8
v_mfma_f32_16x16x32_bf16 v[76:79], v[176:179], a[172:175], v[76:79]
v_add_f32 v44, v44, v8
s_waitcnt vmcnt(9)
v_mfma_f32_16x16x32_bf16 v[92:95], v[180:183], a[172:175], v[92:95]
buffer_load_dwordx4 v[220:223], v23, s[64:67], s73 offen offset:256 sc1
v_mfma_f32_16x16x32_bf16 v[88:91], v[180:183], a[168:171], v[88:91]
v_add_f32 v45, v45, v8
v_mfma_f32_16x16x32_bf16 v[84:87], v[180:183], a[164:167], v[84:87]
v_add_f32 v46, v46, v8
v_mfma_f32_16x16x32_bf16 v[80:83], v[180:183], a[160:163], v[80:83]
v_add_f32 v47, v47, v8
s_waitcnt vmcnt(9)
v_mfma_f32_16x16x32_bf16 v[96:99], v[184:187], a[160:163], v[96:99]
s_add_u32 s73, s83, 4
s_and_b32 s73, s73, 7
s_lshl_b32 s73, s73, 10
s_add_u32 s73, s73, s72
buffer_load_dwordx4 v[224:227], v22, s[64:67], s73 offen offset:0 sc1
v_mfma_f32_16x16x32_bf16 v[100:103], v[184:187], a[164:167], v[100:103]
v_add_f32 v48, v48, v7
v_mfma_f32_16x16x32_bf16 v[104:107], v[184:187], a[168:171], v[104:107]
v_add_f32 v49, v49, v7
v_mfma_f32_16x16x32_bf16 v[108:111], v[184:187], a[172:175], v[108:111]
v_add_f32 v50, v50, v7
s_waitcnt vmcnt(9)
v_mfma_f32_16x16x32_bf16 v[124:127], v[188:191], a[172:175], v[124:127]
buffer_load_dwordx4 v[228:231], v22, s[64:67], s73 offen offset:256 sc1
v_mfma_f32_16x16x32_bf16 v[120:123], v[188:191], a[168:171], v[120:123]
v_add_f32 v51, v51, v7
v_mfma_f32_16x16x32_bf16 v[116:119], v[188:191], a[164:167], v[116:119]
v_add_f32 v52, v52, v7
v_mfma_f32_16x16x32_bf16 v[112:115], v[188:191], a[160:163], v[112:115]
v_add_f32 v53, v53, v7
s_waitcnt vmcnt(9)
v_mfma_f32_16x16x32_bf16 v[64:67], a[176:179], v[192:195], v[64:67]
buffer_load_dwordx4 v[232:235], v23, s[64:67], s73 offen offset:0 sc1
v_mfma_f32_16x16x32_bf16 v[80:83], a[180:183], v[192:195], v[80:83]
v_add_f32 v54, v54, v7
v_mfma_f32_16x16x32_bf16 v[96:99], a[184:187], v[192:195], v[96:99]
v_add_f32 v55, v55, v7
v_mfma_f32_16x16x32_bf16 v[112:115], a[188:191], v[192:195], v[112:115]
s_waitcnt vmcnt(9)
v_mfma_f32_16x16x32_bf16 v[116:119], a[188:191], v[196:199], v[116:119]
buffer_load_dwordx4 v[236:239], v23, s[64:67], s73 offen offset:256 sc1
v_mfma_f32_16x16x32_bf16 v[100:103], a[184:187], v[196:199], v[100:103]
v_mfma_f32_16x16x32_bf16 v[84:87], a[180:183], v[196:199], v[84:87]
v_mfma_f32_16x16x32_bf16 v[68:71], a[176:179], v[196:199], v[68:71]
s_waitcnt vmcnt(9)
v_mfma_f32_16x16x32_bf16 v[72:75], a[176:179], v[200:203], v[72:75]
s_add_u32 s73, s83, 6
s_and_b32 s73, s73, 7
s_lshl_b32 s73, s73, 10
s_add_u32 s73, s73, s72
buffer_load_dwordx4 v[128:131], v22, s[64:67], s73 offen offset:0 sc1
v_mfma_f32_16x16x32_bf16 v[88:91], a[180:183], v[200:203], v[88:91]
v_mfma_f32_16x16x32_bf16 v[104:107], a[184:187], v[200:203], v[104:107]
v_mfma_f32_16x16x32_bf16 v[120:123], a[188:191], v[200:203], v[120:123]
s_waitcnt vmcnt(9)
v_mfma_f32_16x16x32_bf16 v[124:127], a[188:191], v[204:207], v[124:127]
buffer_load_dwordx4 v[132:135], v22, s[64:67], s73 offen offset:256 sc1
v_mfma_f32_16x16x32_bf16 v[108:111], a[184:187], v[204:207], v[108:111]
v_mfma_f32_16x16x32_bf16 v[92:95], a[180:183], v[204:207], v[92:95]
v_mfma_f32_16x16x32_bf16 v[76:79], a[176:179], v[204:207], v[76:79]
s_waitcnt vmcnt(9)
v_mfma_f32_16x16x32_bf16 v[64:67], a[192:195], v[208:211], v[64:67]
buffer_load_dwordx4 v[136:139], v23, s[64:67], s73 offen offset:0 sc1
v_mfma_f32_16x16x32_bf16 v[80:83], a[196:199], v[208:211], v[80:83]
v_mfma_f32_16x16x32_bf16 v[96:99], a[200:203], v[208:211], v[96:99]
v_mfma_f32_16x16x32_bf16 v[112:115], a[204:207], v[208:211], v[112:115]
s_waitcnt vmcnt(9)
v_mfma_f32_16x16x32_bf16 v[116:119], a[204:207], v[212:215], v[116:119]
buffer_load_dwordx4 v[140:143], v23, s[64:67], s73 offen offset:256 sc1
v_mfma_f32_16x16x32_bf16 v[100:103], a[200:203], v[212:215], v[100:103]
v_mfma_f32_16x16x32_bf16 v[84:87], a[196:199], v[212:215], v[84:87]
v_mfma_f32_16x16x32_bf16 v[68:71], a[192:195], v[212:215], v[68:71]
s_waitcnt vmcnt(9)
v_mfma_f32_16x16x32_bf16 v[72:75], a[192:195], v[216:219], v[72:75]
v_mfma_f32_16x16x32_bf16 v[88:91], a[196:199], v[216:219], v[88:91]
v_mfma_f32_16x16x32_bf16 v[104:107], a[200:203], v[216:219], v[104:107]
v_mfma_f32_16x16x32_bf16 v[120:123], a[204:207], v[216:219], v[120:123]
s_waitcnt vmcnt(8)
v_mfma_f32_16x16x32_bf16 v[124:127], a[204:207], v[220:223], v[124:127]
v_mfma_f32_16x16x32_bf16 v[108:111], a[200:203], v[220:223], v[108:111]
v_mfma_f32_16x16x32_bf16 v[92:95], a[196:199], v[220:223], v[92:95]
v_mfma_f32_16x16x32_bf16 v[76:79], a[192:195], v[220:223], v[76:79]
s_waitcnt vmcnt(7) lgkmcnt(0)
v_mfma_f32_16x16x32_bf16 v[64:67], a[208:211], v[224:227], v[64:67]
s_waitcnt vmcnt(3)
v_mfma_f32_16x16x32_bf16 v[64:67], a[224:227], v[128:131], v[64:67]
v_mfma_f32_16x16x32_bf16 v[80:83], a[212:215], v[224:227], v[80:83]
v_mfma_f32_16x16x32_bf16 v[80:83], a[228:231], v[128:131], v[80:83]
v_mfma_f32_16x16x32_bf16 v[96:99], a[216:219], v[224:227], v[96:99]
v_mfma_f32_16x16x32_bf16 v[96:99], a[232:235], v[128:131], v[96:99]
v_mfma_f32_16x16x32_bf16 v[112:115], a[220:223], v[224:227], v[112:115]
s_nop 2
ds_write_b128 v56, v[64:67] offset:0
v_mfma_f32_16x16x32_bf16 v[112:115], a[236:239], v[128:131], v[112:115]
v_mfma_f32_16x16x32_bf16 v[68:71], a[208:211], v[228:231], v[68:71]
ds_write_b128 v57, v[80:83] offset:1024
s_waitcnt vmcnt(2)
v_mfma_f32_16x16x32_bf16 v[68:71], a[224:227], v[132:135], v[68:71]
v_mfma_f32_16x16x32_bf16 v[84:87], a[212:215], v[228:231], v[84:87]
ds_write_b128 v58, v[96:99] offset:2048
v_mfma_f32_16x16x32_bf16 v[84:87], a[228:231], v[132:135], v[84:87]
v_mfma_f32_16x16x32_bf16 v[100:103], a[216:219], v[228:231], v[100:103]
ds_write_b128 v59, v[112:115] offset:3072
v_mfma_f32_16x16x32_bf16 v[100:103], a[232:235], v[132:135], v[100:103]
v_mfma_f32_16x16x32_bf16 v[116:119], a[220:223], v[228:231], v[116:119]
s_nop 0
ds_write_b128 v56, v[68:71] offset:4096
v_mfma_f32_16x16x32_bf16 v[116:119], a[236:239], v[132:135], v[116:119]
v_mfma_f32_16x16x32_bf16 v[72:75], a[208:211], v[232:235], v[72:75]
ds_write_b128 v57, v[84:87] offset:5120
s_waitcnt vmcnt(1)
v_mfma_f32_16x16x32_bf16 v[72:75], a[224:227], v[136:139], v[72:75]
v_mfma_f32_16x16x32_bf16 v[88:91], a[212:215], v[232:235], v[88:91]
ds_write_b128 v58, v[100:103] offset:6144
v_mfma_f32_16x16x32_bf16 v[88:91], a[228:231], v[136:139], v[88:91]
v_mfma_f32_16x16x32_bf16 v[104:107], a[216:219], v[232:235], v[104:107]
ds_write_b128 v59, v[116:119] offset:7168
v_mfma_f32_16x16x32_bf16 v[104:107], a[232:235], v[136:139], v[104:107]
v_mfma_f32_16x16x32_bf16 v[120:123], a[220:223], v[232:235], v[120:123]
s_nop 0
ds_write_b128 v56, v[72:75] offset:8192
v_mfma_f32_16x16x32_bf16 v[120:123], a[236:239], v[136:139], v[120:123]
v_mfma_f32_16x16x32_bf16 v[76:79], a[208:211], v[236:239], v[76:79]
ds_write_b128 v57, v[88:91] offset:9216
s_waitcnt vmcnt(0)
v_mfma_f32_16x16x32_bf16 v[76:79], a[224:227], v[140:143], v[76:79]
v_mfma_f32_16x16x32_bf16 v[92:95], a[212:215], v[236:239], v[92:95]
ds_write_b128 v58, v[104:107] offset:10240
v_mfma_f32_16x16x32_bf16 v[92:95], a[228:231], v[140:143], v[92:95]
v_mfma_f32_16x16x32_bf16 v[108:111], a[216:219], v[236:239], v[108:111]
ds_write_b128 v59, v[120:123] offset:11264
v_mfma_f32_16x16x32_bf16 v[108:111], a[232:235], v[140:143], v[108:111]
v_mfma_f32_16x16x32_bf16 v[124:127], a[220:223], v[236:239], v[124:127]
s_nop 0
ds_write_b128 v56, v[76:79] offset:24576
v_mfma_f32_16x16x32_bf16 v[124:127], a[236:239], v[140:143], v[124:127]
s_nop 0
ds_write_b128 v57, v[92:95] offset:25600
s_nop 1
ds_write_b128 v58, v[108:111] offset:26624
s_nop 2
ds_write_b128 v59, v[124:127] offset:27648
s_waitcnt lgkmcnt(0)
s_barrier
ds_read_b128 v[128:131], v36 offset:0
ds_read_b128 v[132:135], v36 offset:256
ds_read_b128 v[136:139], v36 offset:12288
ds_read_b128 v[140:143], v36 offset:12544
ds_read_b128 v[144:147], v38 offset:0
ds_read_b128 v[148:151], v38 offset:256
ds_read_b128 v[152:155], v38 offset:12288
ds_read_b128 v[156:159], v38 offset:12544
ds_read_b128 v[160:163], v37 offset:0
ds_read_b128 v[164:167], v37 offset:256
ds_read_b128 v[168:171], v37 offset:12288
ds_read_b128 v[172:175], v37 offset:12544
s_waitcnt lgkmcnt(11)
v_pk_add_f32 v[40:41], v[40:41], v[128:129]
v_pk_add_f32 v[42:43], v[42:43], v[130:131]
ds_read_b128 v[176:179], v39 offset:0
s_waitcnt lgkmcnt(11)
v_pk_add_f32 v[44:45], v[44:45], v[132:133]
v_pk_add_f32 v[46:47], v[46:47], v[134:135]
ds_read_b128 v[180:183], v39 offset:256
s_waitcnt lgkmcnt(11)
v_pk_add_f32 v[40:41], v[40:41], v[136:137]
v_pk_add_f32 v[42:43], v[42:43], v[138:139]
ds_read_b128 v[184:187], v39 offset:12288
s_waitcnt lgkmcnt(11)
v_pk_add_f32 v[44:45], v[44:45], v[140:141]
v_pk_add_f32 v[46:47], v[46:47], v[142:143]
ds_read_b128 v[188:191], v39 offset:12544
s_waitcnt lgkmcnt(11)
v_pk_add_f32 v[40:41], v[40:41], v[144:145]
v_pk_add_f32 v[42:43], v[42:43], v[146:147]
s_waitcnt lgkmcnt(10)
v_pk_add_f32 v[44:45], v[44:45], v[148:149]
v_pk_add_f32 v[46:47], v[46:47], v[150:151]
s_waitcnt lgkmcnt(9)
v_pk_add_f32 v[40:41], v[40:41], v[152:153]
v_pk_add_f32 v[42:43], v[42:43], v[154:155]
s_waitcnt lgkmcnt(8)
v_pk_add_f32 v[44:45], v[44:45], v[156:157]
v_pk_add_f32 v[46:47], v[46:47], v[158:159]
v_cvt_pk_bf16_f32 v28, v40, v41
v_cvt_pk_bf16_f32 v29, v42, v43
v_cvt_pk_bf16_f32 v30, v44, v45
v_cvt_pk_bf16_f32 v31, v46, v47
buffer_store_dwordx4 v[28:31], v247, s[56:59], 0 offen sc1 nt
s_waitcnt lgkmcnt(7)
v_pk_add_f32 v[48:49], v[48:49], v[160:161]
v_pk_add_f32 v[50:51], v[50:51], v[162:163]
s_waitcnt lgkmcnt(6)
v_pk_add_f32 v[52:53], v[52:53], v[164:165]
v_pk_add_f32 v[54:55], v[54:55], v[166:167]
s_waitcnt lgkmcnt(5)
v_pk_add_f32 v[48:49], v[48:49], v[168:169]
v_pk_add_f32 v[50:51], v[50:51], v[170:171]
s_waitcnt lgkmcnt(4)
v_pk_add_f32 v[52:53], v[52:53], v[172:173]
v_pk_add_f32 v[54:55], v[54:55], v[174:175]
s_waitcnt lgkmcnt(3)
v_pk_add_f32 v[48:49], v[48:49], v[176:177]
v_pk_add_f32 v[50:51], v[50:51], v[178:179]
s_waitcnt lgkmcnt(2)
v_pk_add_f32 v[52:53], v[52:53], v[180:181]
v_pk_add_f32 v[54:55], v[54:55], v[182:183]
s_waitcnt lgkmcnt(1)
v_pk_add_f32 v[48:49], v[48:49], v[184:185]
v_pk_add_f32 v[50:51], v[50:51], v[186:187]
s_waitcnt lgkmcnt(0)
v_pk_add_f32 v[52:53], v[52:53], v[188:189]
v_pk_add_f32 v[54:55], v[54:55], v[190:191]
v_cvt_pk_bf16_f32 v32, v48, v49
v_cvt_pk_bf16_f32 v33, v50, v51
v_cvt_pk_bf16_f32 v34, v52, v53
v_cvt_pk_bf16_f32 v35, v54, v55
buffer_store_dwordx4 v[32:35], v9, s[56:59], 0 offen sc1 nt
s_endpgm
L_spare:
s_lshl2_add_u32 s6, s3, s6
s_waitcnt lgkmcnt(0)
s_mov_b64 s[28:29], s[76:77]
s_mov_b64 s[40:41], s[84:85]
s_mov_b64 s[32:33], s[78:79]
s_mov_b64 s[36:37], s[80:81]
s_mov_b64 s[44:45], s[86:87]
s_mov_b64 s[48:49], s[88:89]
s_mov_b64 s[52:53], s[90:91]
s_mov_b32 s22, 6905728
s_mov_b32 s23, 11534336
s_load_dword s27, s[64:65], s22
s_load_dword s82, s[64:65], s23
s_mov_b32 s30, 2097152
s_mov_b32 s31, 0x20000
s_mov_b32 s42, 5636096
s_mov_b32 s43, 0x20000
s_mov_b32 s34, 1572864
s_mov_b32 s35, 0x20000
s_mov_b32 s66, 11534464
s_mov_b32 s67, 0x20000
s_mov_b32 s38, 524288
s_mov_b32 s39, 0x20000
s_mov_b32 s46, 2752
s_mov_b32 s47, 0x20000
s_mov_b32 s50, 5636096
s_mov_b32 s51, 0x20000
s_mov_b32 s54, 4096
s_mov_b32 s55, 0x20000
s_mov_b32 s58, 2097152
s_mov_b32 s59, 0x20000
s_lshl_b32 s11, s4, 11
s_lshr_b32 s18, s26, 1
s_and_b32 s19, s26, 1
s_and_b32 s68, s5, 7
s_lshr_b32 s8, s4, 1
s_lshl3_add_u32 s8, s8, s68
s_lshr_b32 s9, s5, 3
s_and_b32 s68, s5, 1
s_lshl1_add_u32 s9, s68, s9
s_and_b32 s9, s9, 3
s_and_b32 s68, s4, 1
s_lshl2_add_u32 s9, s68, s9
v_lshrrev_b32 v3, 3, v2
v_and_b32 v4, 7, v2
v_mul_u32_u24 v3, 3072, v3
v_lshl_add_u32 v5, v4, 4, v3
s_mul_i32 s74, s26, 393216
s_lshl_b32 s69, s6, 7
s_add_u32 s74, s74, s69
buffer_load_dwordx4 v[64:67], v5, s[32:35], s74 offen offset:1024
buffer_load_dwordx4 v[68:71], v5, s[32:35], s74 offen offset:2048
s_add_u32 s74, s74, 24576
buffer_load_dwordx4 v[72:75], v5, s[32:35], s74 offen offset:1024
buffer_load_dwordx4 v[76:79], v5, s[32:35], s74 offen offset:2048
s_add_u32 s74, s74, 24576
buffer_load_dwordx4 v[80:83], v5, s[32:35], s74 offen offset:1024
buffer_load_dwordx4 v[84:87], v5, s[32:35], s74 offen offset:2048
s_add_u32 s74, s74, 24576
buffer_load_dwordx4 v[88:91], v5, s[32:35], s74 offen offset:1024
buffer_load_dwordx4 v[92:95], v5, s[32:35], s74 offen offset:2048
s_add_u32 s74, s74, 24576
buffer_load_dwordx4 v[96:99], v5, s[32:35], s74 offen offset:1024
buffer_load_dwordx4 v[100:103], v5, s[32:35], s74 offen offset:2048
s_add_u32 s74, s74, 24576
buffer_load_dwordx4 v[104:107], v5, s[32:35], s74 offen offset:1024
buffer_load_dwordx4 v[108:111], v5, s[32:35], s74 offen offset:2048
s_add_u32 s74, s74, 24576
s_lshr_b32 s62, s26, 1
s_mul_i32 s62, s62, 73728
s_and_b32 s69, s26, 1
s_mul_i32 s69, s69, 12288
s_add_u32 s62, s62, s69
v_lshrrev_b32 v3, 3, v2
v_and_b32 v4, 7, v2
v_lshrrev_b32 v5, 4, v2
v_lshlrev_b32 v6, 1, v5
v_xor_b32 v6, v4, v6
v_lshlrev_b32 v6, 4, v6
s_lshl_b32 s68, s8, 7
v_lshl_add_u32 v240, v3, 12, v6
v_add_u32 v240, s68, v240
v_add_u32 v241, 31744, v240
s_lshl_b32 s69, s9, 7
v_lshl_add_u32 v242, v3, 10, v6
v_add_u32 v242, s69, v242
v_add_u32 v243, 7168, v242
s_lshl2_add_u32 s68, s8, s26
s_lshl_b32 s68, s68, 14
s_add_u32 s68, s68, s69
v_lshl_add_u32 v3, v3, 10, s68
v_lshl_add_u32 v247, v4, 4, v3
s_mul_i32 s68, s26, 11
s_add_u32 s69, s68, 11
s_min_u32 s69, s69, 43
s_lshl_b32 s0, s68, 17
s_lshl_b32 s1, s69, 17
s_and_b32 s70, s9, 1
s_lshl_b32 s70, s70, 2
s_and_b32 s71, s9, 2
s_add_u32 s70, s70, s71
s_add_u32 s70, s70, s8
s_and_b32 s71, s4, 1
s_lshl1_add_u32 s70, s71, s70
s_and_b32 s70, s70, 7
s_mul_i32 s70, s70, 10
s_lshr_b32 s70, s70, 3
s_add_u32 s68, s68, s70
s_lshl_b32 s60, s68, 17
s_lshl_b32 s63, s68, 10
s_add_u32 s70, s9, s8
s_lshl_b32 s70, s70, 1
s_and_b32 s83, s70, 6
v_bfe_u32 v3, v2, 2, 2
v_lshl_add_u32 v3, v5, 2, v3
v_bfe_u32 v4, v3, 1, 2
v_lshlrev_b32 v3, 7, v3
v_and_b32 v6, 3, v2
v_lshl_add_u32 v3, v6, 3, v3
v_add_u32 v3, s62, v3
v_xor_b32 v6, 0, v4
v_lshl_add_u32 v248, v6, 5, v3
v_xor_b32 v6, 1, v4
v_lshl_add_u32 v249, v6, 5, v3
v_xor_b32 v6, 2, v4
v_lshl_add_u32 v250, v6, 5, v3
v_xor_b32 v6, 3, v4
v_lshl_add_u32 v251, v6, 5, v3
v_lshlrev_b32 v246, 4, v2
s_waitcnt lgkmcnt(0)
s_mul_i32 s27, s27, 0x9E3779B1
s_mul_i32 s82, s82, 0x85EBCA6C
s_add_u32 s27, s27, s82
s_add_u32 s27, s27, 0x7F4A7C15
s_cmp_lg_u32 s26, 0
s_cbranch_scc1 L_pub_35
s_lshl_b32 s68, s12, 4
s_add_u32 s68, s68, 6987776
v_lshlrev_b32 v3, 11, v2
v_mov_b32 v4, s27
s_mov_b64 exec, 1
buffer_store_dword v4, v3, s[64:67], s68 offen sc1
s_mov_b64 exec, -1
L_pub_35:
v_lshrrev_b32 v3, 3, v2
v_and_b32 v4, 7, v2
v_mul_u32_u24 v3, 3072, v3
v_lshl_add_u32 v5, v4, 4, v3
v_mov_b32 v10, 0
v_mov_b32 v11, 0
v_mov_b32 v12, 0
v_mov_b32 v13, 0
v_mov_b32 v14, 0
v_mov_b32 v15, 0
v_mov_b32 v16, 0
v_mov_b32 v17, 0
v_mov_b32 v18, 0
v_mov_b32 v19, 0
v_mov_b32 v20, 0
v_mov_b32 v21, 0
v_mov_b32 v22, 0
v_mov_b32 v23, 0
v_mov_b32 v24, 0
v_mov_b32 v25, 0
s_mov_b32 s72, 0x00003f80
s_mov_b32 s73, 0x3f800000
buffer_load_dwordx4 v[112:115], v5, s[32:35], s74 offen offset:1024
buffer_load_dwordx4 v[116:119], v5, s[32:35], s74 offen offset:2048
s_add_u32 s74, s74, 24576
s_waitcnt vmcnt(13)
v_dot2c_f32_bf16 v10, s72, v64
v_dot2c_f32_bf16 v11, s73, v64
v_dot2c_f32_bf16 v12, s72, v65
v_dot2c_f32_bf16 v13, s73, v65
v_dot2c_f32_bf16 v14, s72, v66
v_dot2c_f32_bf16 v15, s73, v66
v_dot2c_f32_bf16 v16, s72, v67
v_dot2c_f32_bf16 v17, s73, v67
s_waitcnt vmcnt(12)
v_dot2c_f32_bf16 v18, s72, v68
v_dot2c_f32_bf16 v19, s73, v68
v_dot2c_f32_bf16 v20, s72, v69
v_dot2c_f32_bf16 v21, s73, v69
v_dot2c_f32_bf16 v22, s72, v70
v_dot2c_f32_bf16 v23, s73, v70
v_dot2c_f32_bf16 v24, s72, v71
v_dot2c_f32_bf16 v25, s73, v71
buffer_load_dwordx4 v[64:67], v5, s[32:35], s74 offen offset:1024
buffer_load_dwordx4 v[68:71], v5, s[32:35], s74 offen offset:2048
s_add_u32 s74, s74, 24576
s_waitcnt vmcnt(13)
v_dot2c_f32_bf16 v10, s72, v72
v_dot2c_f32_bf16 v11, s73, v72
v_dot2c_f32_bf16 v12, s72, v73
v_dot2c_f32_bf16 v13, s73, v73
v_dot2c_f32_bf16 v14, s72, v74
v_dot2c_f32_bf16 v15, s73, v74
v_dot2c_f32_bf16 v16, s72, v75
v_dot2c_f32_bf16 v17, s73, v75
s_waitcnt vmcnt(12)
v_dot2c_f32_bf16 v18, s72, v76
v_dot2c_f32_bf16 v19, s73, v76
v_dot2c_f32_bf16 v20, s72, v77
v_dot2c_f32_bf16 v21, s73, v77
v_dot2c_f32_bf16 v22, s72, v78
v_dot2c_f32_bf16 v23, s73, v78
v_dot2c_f32_bf16 v24, s72, v79
v_dot2c_f32_bf16 v25, s73, v79
buffer_load_dwordx4 v[72:75], v5, s[32:35], s74 offen offset:1024
buffer_load_dwordx4 v[76:79], v5, s[32:35], s74 offen offset:2048
s_add_u32 s74, s74, 24576
s_waitcnt vmcnt(13)
v_dot2c_f32_bf16 v10, s72, v80
v_dot2c_f32_bf16 v11, s73, v80
v_dot2c_f32_bf16 v12, s72, v81
v_dot2c_f32_bf16 v13, s73, v81
v_dot2c_f32_bf16 v14, s72, v82
v_dot2c_f32_bf16 v15, s73, v82
v_dot2c_f32_bf16 v16, s72, v83
v_dot2c_f32_bf16 v17, s73, v83
s_waitcnt vmcnt(12)
v_dot2c_f32_bf16 v18, s72, v84
v_dot2c_f32_bf16 v19, s73, v84
v_dot2c_f32_bf16 v20, s72, v85
v_dot2c_f32_bf16 v21, s73, v85
v_dot2c_f32_bf16 v22, s72, v86
v_dot2c_f32_bf16 v23, s73, v86
v_dot2c_f32_bf16 v24, s72, v87
v_dot2c_f32_bf16 v25, s73, v87
buffer_load_dwordx4 v[80:83], v5, s[32:35], s74 offen offset:1024
buffer_load_dwordx4 v[84:87], v5, s[32:35], s74 offen offset:2048
s_add_u32 s74, s74, 24576
s_waitcnt vmcnt(13)
v_dot2c_f32_bf16 v10, s72, v88
v_dot2c_f32_bf16 v11, s73, v88
v_dot2c_f32_bf16 v12, s72, v89
v_dot2c_f32_bf16 v13, s73, v89
v_dot2c_f32_bf16 v14, s72, v90
v_dot2c_f32_bf16 v15, s73, v90
v_dot2c_f32_bf16 v16, s72, v91
v_dot2c_f32_bf16 v17, s73, v91
s_waitcnt vmcnt(12)
v_dot2c_f32_bf16 v18, s72, v92
v_dot2c_f32_bf16 v19, s73, v92
v_dot2c_f32_bf16 v20, s72, v93
v_dot2c_f32_bf16 v21, s73, v93
v_dot2c_f32_bf16 v22, s72, v94
v_dot2c_f32_bf16 v23, s73, v94
v_dot2c_f32_bf16 v24, s72, v95
v_dot2c_f32_bf16 v25, s73, v95
buffer_load_dwordx4 v[88:91], v5, s[32:35], s74 offen offset:1024
buffer_load_dwordx4 v[92:95], v5, s[32:35], s74 offen offset:2048
s_add_u32 s74, s74, 24576
s_waitcnt vmcnt(13)
v_dot2c_f32_bf16 v10, s72, v96
v_dot2c_f32_bf16 v11, s73, v96
v_dot2c_f32_bf16 v12, s72, v97
v_dot2c_f32_bf16 v13, s73, v97
v_dot2c_f32_bf16 v14, s72, v98
v_dot2c_f32_bf16 v15, s73, v98
v_dot2c_f32_bf16 v16, s72, v99
v_dot2c_f32_bf16 v17, s73, v99
s_waitcnt vmcnt(12)
v_dot2c_f32_bf16 v18, s72, v100
v_dot2c_f32_bf16 v19, s73, v100
v_dot2c_f32_bf16 v20, s72, v101
v_dot2c_f32_bf16 v21, s73, v101
v_dot2c_f32_bf16 v22, s72, v102
v_dot2c_f32_bf16 v23, s73, v102
v_dot2c_f32_bf16 v24, s72, v103
v_dot2c_f32_bf16 v25, s73, v103
buffer_load_dwordx4 v[96:99], v5, s[32:35], s74 offen offset:1024
buffer_load_dwordx4 v[100:103], v5, s[32:35], s74 offen offset:2048
s_add_u32 s74, s74, 24576
s_waitcnt vmcnt(13)
v_dot2c_f32_bf16 v10, s72, v104
v_dot2c_f32_bf16 v11, s73, v104
v_dot2c_f32_bf16 v12, s72, v105
v_dot2c_f32_bf16 v13, s73, v105
v_dot2c_f32_bf16 v14, s72, v106
v_dot2c_f32_bf16 v15, s73, v106
v_dot2c_f32_bf16 v16, s72, v107
v_dot2c_f32_bf16 v17, s73, v107
s_waitcnt vmcnt(12)
v_dot2c_f32_bf16 v18, s72, v108
v_dot2c_f32_bf16 v19, s73, v108
v_dot2c_f32_bf16 v20, s72, v109
v_dot2c_f32_bf16 v21, s73, v109
v_dot2c_f32_bf16 v22, s72, v110
v_dot2c_f32_bf16 v23, s73, v110
v_dot2c_f32_bf16 v24, s72, v111
v_dot2c_f32_bf16 v25, s73, v111
buffer_load_dwordx4 v[104:107], v5, s[32:35], s74 offen offset:1024
buffer_load_dwordx4 v[108:111], v5, s[32:35], s74 offen offset:2048
s_add_u32 s74, s74, 24576
s_waitcnt vmcnt(13)
v_dot2c_f32_bf16 v10, s72, v112
v_dot2c_f32_bf16 v11, s73, v112
v_dot2c_f32_bf16 v12, s72, v113
v_dot2c_f32_bf16 v13, s73, v113
v_dot2c_f32_bf16 v14, s72, v114
v_dot2c_f32_bf16 v15, s73, v114
v_dot2c_f32_bf16 v16, s72, v115
v_dot2c_f32_bf16 v17, s73, v115
s_waitcnt vmcnt(12)
v_dot2c_f32_bf16 v18, s72, v116
v_dot2c_f32_bf16 v19, s73, v116
v_dot2c_f32_bf16 v20, s72, v117
v_dot2c_f32_bf16 v21, s73, v117
v_dot2c_f32_bf16 v22, s72, v118
v_dot2c_f32_bf16 v23, s73, v118
v_dot2c_f32_bf16 v24, s72, v119
v_dot2c_f32_bf16 v25, s73, v119
buffer_load_dwordx4 v[112:115], v5, s[32:35], s74 offen offset:1024
buffer_load_dwordx4 v[116:119], v5, s[32:35], s74 offen offset:2048
s_add_u32 s74, s74, 24576
s_waitcnt vmcnt(13)
v_dot2c_f32_bf16 v10, s72, v64
v_dot2c_f32_bf16 v11, s73, v64
v_dot2c_f32_bf16 v12, s72, v65
v_dot2c_f32_bf16 v13, s73, v65
v_dot2c_f32_bf16 v14, s72, v66
v_dot2c_f32_bf16 v15, s73, v66
v_dot2c_f32_bf16 v16, s72, v67
v_dot2c_f32_bf16 v17, s73, v67
s_waitcnt vmcnt(12)
v_dot2c_f32_bf16 v18, s72, v68
v_dot2c_f32_bf16 v19, s73, v68
v_dot2c_f32_bf16 v20, s72, v69
v_dot2c_f32_bf16 v21, s73, v69
v_dot2c_f32_bf16 v22, s72, v70
v_dot2c_f32_bf16 v23, s73, v70
v_dot2c_f32_bf16 v24, s72, v71
v_dot2c_f32_bf16 v25, s73, v71
buffer_load_dwordx4 v[64:67], v5, s[32:35], s74 offen offset:1024
buffer_load_dwordx4 v[68:71], v5, s[32:35], s74 offen offset:2048
s_add_u32 s74, s74, 24576
s_waitcnt vmcnt(13)
v_dot2c_f32_bf16 v10, s72, v72
v_dot2c_f32_bf16 v11, s73, v72
v_dot2c_f32_bf16 v12, s72, v73
v_dot2c_f32_bf16 v13, s73, v73
v_dot2c_f32_bf16 v14, s72, v74
v_dot2c_f32_bf16 v15, s73, v74
v_dot2c_f32_bf16 v16, s72, v75
v_dot2c_f32_bf16 v17, s73, v75
s_waitcnt vmcnt(12)
v_dot2c_f32_bf16 v18, s72, v76
v_dot2c_f32_bf16 v19, s73, v76
v_dot2c_f32_bf16 v20, s72, v77
v_dot2c_f32_bf16 v21, s73, v77
v_dot2c_f32_bf16 v22, s72, v78
v_dot2c_f32_bf16 v23, s73, v78
v_dot2c_f32_bf16 v24, s72, v79
v_dot2c_f32_bf16 v25, s73, v79
buffer_load_dwordx4 v[72:75], v5, s[32:35], s74 offen offset:1024
buffer_load_dwordx4 v[76:79], v5, s[32:35], s74 offen offset:2048
s_add_u32 s74, s74, 24576
s_waitcnt vmcnt(13)
v_dot2c_f32_bf16 v10, s72, v80
v_dot2c_f32_bf16 v11, s73, v80
v_dot2c_f32_bf16 v12, s72, v81
v_dot2c_f32_bf16 v13, s73, v81
v_dot2c_f32_bf16 v14, s72, v82
v_dot2c_f32_bf16 v15, s73, v82
v_dot2c_f32_bf16 v16, s72, v83
v_dot2c_f32_bf16 v17, s73, v83
s_waitcnt vmcnt(12)
v_dot2c_f32_bf16 v18, s72, v84
v_dot2c_f32_bf16 v19, s73, v84
v_dot2c_f32_bf16 v20, s72, v85
v_dot2c_f32_bf16 v21, s73, v85
v_dot2c_f32_bf16 v22, s72, v86
v_dot2c_f32_bf16 v23, s73, v86
v_dot2c_f32_bf16 v24, s72, v87
v_dot2c_f32_bf16 v25, s73, v87
s_waitcnt vmcnt(11)
v_dot2c_f32_bf16 v10, s72, v88
v_dot2c_f32_bf16 v11, s73, v88
v_dot2c_f32_bf16 v12, s72, v89
v_dot2c_f32_bf16 v13, s73, v89
v_dot2c_f32_bf16 v14, s72, v90
v_dot2c_f32_bf16 v15, s73, v90
v_dot2c_f32_bf16 v16, s72, v91
v_dot2c_f32_bf16 v17, s73, v91
s_waitcnt vmcnt(10)
v_dot2c_f32_bf16 v18, s72, v92
v_dot2c_f32_bf16 v19, s73, v92
v_dot2c_f32_bf16 v20, s72, v93
v_dot2c_f32_bf16 v21, s73, v93
v_dot2c_f32_bf16 v22, s72, v94
v_dot2c_f32_bf16 v23, s73, v94
v_dot2c_f32_bf16 v24, s72, v95
v_dot2c_f32_bf16 v25, s73, v95
s_waitcnt vmcnt(9)
v_dot2c_f32_bf16 v10, s72, v96
v_dot2c_f32_bf16 v11, s73, v96
v_dot2c_f32_bf16 v12, s72, v97
v_dot2c_f32_bf16 v13, s73, v97
v_dot2c_f32_bf16 v14, s72, v98
v_dot2c_f32_bf16 v15, s73, v98
v_dot2c_f32_bf16 v16, s72, v99
v_dot2c_f32_bf16 v17, s73, v99
s_waitcnt vmcnt(8)
v_dot2c_f32_bf16 v18, s72, v100
v_dot2c_f32_bf16 v19, s73, v100
v_dot2c_f32_bf16 v20, s72, v101
v_dot2c_f32_bf16 v21, s73, v101
v_dot2c_f32_bf16 v22, s72, v102
v_dot2c_f32_bf16 v23, s73, v102
v_dot2c_f32_bf16 v24, s72, v103
v_dot2c_f32_bf16 v25, s73, v103
s_waitcnt vmcnt(7)
v_dot2c_f32_bf16 v10, s72, v104
v_dot2c_f32_bf16 v11, s73, v104
v_dot2c_f32_bf16 v12, s72, v105
v_dot2c_f32_bf16 v13, s73, v105
v_dot2c_f32_bf16 v14, s72, v106
v_dot2c_f32_bf16 v15, s73, v106
v_dot2c_f32_bf16 v16, s72, v107
v_dot2c_f32_bf16 v17, s73, v107
s_waitcnt vmcnt(6)
v_dot2c_f32_bf16 v18, s72, v108
v_dot2c_f32_bf16 v19, s73, v108
v_dot2c_f32_bf16 v20, s72, v109
v_dot2c_f32_bf16 v21, s73, v109
v_dot2c_f32_bf16 v22, s72, v110
v_dot2c_f32_bf16 v23, s73, v110
v_dot2c_f32_bf16 v24, s72, v111
v_dot2c_f32_bf16 v25, s73, v111
s_waitcnt vmcnt(5)
v_dot2c_f32_bf16 v10, s72, v112
v_dot2c_f32_bf16 v11, s73, v112
v_dot2c_f32_bf16 v12, s72, v113
v_dot2c_f32_bf16 v13, s73, v113
v_dot2c_f32_bf16 v14, s72, v114
v_dot2c_f32_bf16 v15, s73, v114
v_dot2c_f32_bf16 v16, s72, v115
v_dot2c_f32_bf16 v17, s73, v115
s_waitcnt vmcnt(4)
v_dot2c_f32_bf16 v18, s72, v116
v_dot2c_f32_bf16 v19, s73, v116
v_dot2c_f32_bf16 v20, s72, v117
v_dot2c_f32_bf16 v21, s73, v117
v_dot2c_f32_bf16 v22, s72, v118
v_dot2c_f32_bf16 v23, s73, v118
v_dot2c_f32_bf16 v24, s72, v119
v_dot2c_f32_bf16 v25, s73, v119
s_waitcnt vmcnt(3)
v_dot2c_f32_bf16 v10, s72, v64
v_dot2c_f32_bf16 v11, s73, v64
v_dot2c_f32_bf16 v12, s72, v65
v_dot2c_f32_bf16 v13, s73, v65
v_dot2c_f32_bf16 v14, s72, v66
v_dot2c_f32_bf16 v15, s73, v66
v_dot2c_f32_bf16 v16, s72, v67
v_dot2c_f32_bf16 v17, s73, v67
s_waitcnt vmcnt(2)
v_dot2c_f32_bf16 v18, s72, v68
v_dot2c_f32_bf16 v19, s73, v68
v_dot2c_f32_bf16 v20, s72, v69
v_dot2c_f32_bf16 v21, s73, v69
v_dot2c_f32_bf16 v22, s72, v70
v_dot2c_f32_bf16 v23, s73, v70
v_dot2c_f32_bf16 v24, s72, v71
v_dot2c_f32_bf16 v25, s73, v71
s_waitcnt vmcnt(1)
v_dot2c_f32_bf16 v10, s72, v72
v_dot2c_f32_bf16 v11, s73, v72
v_dot2c_f32_bf16 v12, s72, v73
v_dot2c_f32_bf16 v13, s73, v73
v_dot2c_f32_bf16 v14, s72, v74
v_dot2c_f32_bf16 v15, s73, v74
v_dot2c_f32_bf16 v16, s72, v75
v_dot2c_f32_bf16 v17, s73, v75
s_waitcnt vmcnt(0)
v_dot2c_f32_bf16 v18, s72, v76
v_dot2c_f32_bf16 v19, s73, v76
v_dot2c_f32_bf16 v20, s72, v77
v_dot2c_f32_bf16 v21, s73, v77
v_dot2c_f32_bf16 v22, s72, v78
v_dot2c_f32_bf16 v23, s73, v78
v_dot2c_f32_bf16 v24, s72, v79
v_dot2c_f32_bf16 v25, s73, v79
s_mul_i32 s68, s26, 6144
s_add_u32 s68, s68, 0
v_lshl_add_u32 v3, v2, 5, s68
s_nop 0
ds_write_b128 v3, v[10:13] offset:0
ds_write_b128 v3, v[14:17] offset:16
ds_write_b128 v3, v[18:21] offset:2048
ds_write_b128 v3, v[22:25] offset:2064
s_waitcnt lgkmcnt(0)
s_barrier
s_cmp_ge_u32 s26, 2
s_cbranch_scc1 L_cs_36
s_lshl_b32 s68, s26, 11
s_add_u32 s68, s68, 0
s_nop 0
v_lshl_add_u32 v3, v2, 2, s68
ds_read_b32 v10, v3 offset:0
ds_read_b32 v11, v3 offset:256
ds_read_b32 v12, v3 offset:512
ds_read_b32 v13, v3 offset:768
ds_read_b32 v14, v3 offset:1024
ds_read_b32 v15, v3 offset:1280
ds_read_b32 v16, v3 offset:1536
ds_read_b32 v17, v3 offset:1792
ds_read_b32 v18, v3 offset:6144
ds_read_b32 v19, v3 offset:6400
ds_read_b32 v20, v3 offset:6656
ds_read_b32 v21, v3 offset:6912
ds_read_b32 v22, v3 offset:7168
ds_read_b32 v23, v3 offset:7424
ds_read_b32 v24, v3 offset:7680
ds_read_b32 v25, v3 offset:7936
s_waitcnt lgkmcnt(7)
ds_read_b32 v26, v3 offset:12288
ds_read_b32 v27, v3 offset:12544
ds_read_b32 v28, v3 offset:12800
ds_read_b32 v29, v3 offset:13056
ds_read_b32 v30, v3 offset:13312
ds_read_b32 v31, v3 offset:13568
ds_read_b32 v32, v3 offset:13824
ds_read_b32 v33, v3 offset:14080
s_waitcnt lgkmcnt(7)
ds_read_b32 v34, v3 offset:18432
ds_read_b32 v35, v3 offset:18688
ds_read_b32 v36, v3 offset:18944
ds_read_b32 v37, v3 offset:19200
ds_read_b32 v38, v3 offset:19456
ds_read_b32 v39, v3 offset:19712
ds_read_b32 v40, v3 offset:19968
ds_read_b32 v41, v3 offset:20224
s_waitcnt lgkmcnt(0)
s_nop 0
v_pk_add_f32 v[10:11], v[10:11], v[26:27]
v_pk_add_f32 v[12:13], v[12:13], v[28:29]
v_pk_add_f32 v[14:15], v[14:15], v[30:31]
v_pk_add_f32 v[16:17], v[16:17], v[32:33]
v_pk_add_f32 v[18:19], v[18:19], v[34:35]
v_pk_add_f32 v[20:21], v[20:21], v[36:37]
v_pk_add_f32 v[22:23], v[22:23], v[38:39]
v_pk_add_f32 v[24:25], v[24:25], v[40:41]
v_pk_add_f32 v[10:11], v[10:11], v[18:19]
v_pk_add_f32 v[12:13], v[12:13], v[20:21]
v_pk_add_f32 v[14:15], v[14:15], v[22:23]
v_pk_add_f32 v[16:17], v[16:17], v[24:25]
v_pk_add_f32 v[10:11], v[10:11], v[14:15]
v_pk_add_f32 v[12:13], v[12:13], v[16:17]
v_pk_add_f32 v[10:11], v[10:11], v[12:13]
v_add_f32 v10, v10, v11
s_lshl2_add_u32 s68, s6, s26
s_lshl_b32 s68, s68, 8
s_add_u32 s68, s68, 6897920
v_lshlrev_b32 v3, 2, v2
buffer_store_dword v10, v3, s[64:67], s68 offen sc1
L_cs_36:
s_waitcnt vmcnt(0)
s_barrier
s_lshl1_add_u32 s70, s6, 0
s_cmp_lg_u32 s26, 0
s_cbranch_scc1 L_pub_37
s_lshl_b32 s68, s70, 4
s_add_u32 s68, s68, 6971392
v_lshlrev_b32 v3, 11, v2
v_mov_b32 v4, s27
s_mov_b64 exec, 255
buffer_store_dword v4, v3, s[64:67], s68 offen sc1
s_mov_b64 exec, -1
L_pub_37:
v_lshrrev_b32 v3, 3, v2
v_and_b32 v4, 7, v2
v_mul_u32_u24 v3, 3072, v3
v_lshl_add_u32 v5, v4, 4, v3
s_mul_i32 s74, s26, 393216
s_lshl_b32 s69, s6, 7
s_add_u32 s74, s74, s69
buffer_load_dwordx4 v[64:67], v5, s[32:35], s74 offen offset:0
s_add_u32 s74, s74, 24576
buffer_load_dwordx4 v[68:71], v5, s[32:35], s74 offen offset:0
s_add_u32 s74, s74, 24576
buffer_load_dwordx4 v[72:75], v5, s[32:35], s74 offen offset:0
s_add_u32 s74, s74, 24576
buffer_load_dwordx4 v[76:79], v5, s[32:35], s74 offen offset:0
s_add_u32 s74, s74, 24576
buffer_load_dwordx4 v[80:83], v5, s[32:35], s74 offen offset:0
s_add_u32 s74, s74, 24576
buffer_load_dwordx4 v[84:87], v5, s[32:35], s74 offen offset:0
s_add_u32 s74, s74, 24576
buffer_load_dwordx4 v[88:91], v5, s[32:35], s74 offen offset:0
s_add_u32 s74, s74, 24576
buffer_load_dwordx4 v[92:95], v5, s[32:35], s74 offen offset:0
s_add_u32 s74, s74, 24576
buffer_load_dwordx4 v[96:99], v5, s[32:35], s74 offen offset:0
s_add_u32 s74, s74, 24576
buffer_load_dwordx4 v[100:103], v5, s[32:35], s74 offen offset:0
s_add_u32 s74, s74, 24576
buffer_load_dwordx4 v[104:107], v5, s[32:35], s74 offen offset:0
s_add_u32 s74, s74, 24576
buffer_load_dwordx4 v[108:111], v5, s[32:35], s74 offen offset:0
s_add_u32 s74, s74, 24576
v_mov_b32 v10, 0
v_mov_b32 v11, 0
v_mov_b32 v12, 0
v_mov_b32 v13, 0
v_mov_b32 v14, 0
v_mov_b32 v15, 0
v_mov_b32 v16, 0
v_mov_b32 v17, 0
s_mov_b32 s72, 0x00003f80
s_mov_b32 s73, 0x3f800000
buffer_load_dwordx4 v[112:115], v5, s[32:35], s74 offen offset:0
s_add_u32 s74, s74, 24576
s_waitcnt vmcnt(12)
v_dot2c_f32_bf16 v10, s72, v64
v_dot2c_f32_bf16 v11, s73, v64
v_dot2c_f32_bf16 v12, s72, v65
v_dot2c_f32_bf16 v13, s73, v65
v_dot2c_f32_bf16 v14, s72, v66
v_dot2c_f32_bf16 v15, s73, v66
v_dot2c_f32_bf16 v16, s72, v67
v_dot2c_f32_bf16 v17, s73, v67
buffer_load_dwordx4 v[64:67], v5, s[32:35], s74 offen offset:0
s_add_u32 s74, s74, 24576
s_waitcnt vmcnt(12)
v_dot2c_f32_bf16 v10, s72, v68
v_dot2c_f32_bf16 v11, s73, v68
v_dot2c_f32_bf16 v12, s72, v69
v_dot2c_f32_bf16 v13, s73, v69
v_dot2c_f32_bf16 v14, s72, v70
v_dot2c_f32_bf16 v15, s73, v70
v_dot2c_f32_bf16 v16, s72, v71
v_dot2c_f32_bf16 v17, s73, v71
buffer_load_dwordx4 v[68:71], v5, s[32:35], s74 offen offset:0
s_add_u32 s74, s74, 24576
s_waitcnt vmcnt(12)
v_dot2c_f32_bf16 v10, s72, v72
v_dot2c_f32_bf16 v11, s73, v72
v_dot2c_f32_bf16 v12, s72, v73
v_dot2c_f32_bf16 v13, s73, v73
v_dot2c_f32_bf16 v14, s72, v74
v_dot2c_f32_bf16 v15, s73, v74
v_dot2c_f32_bf16 v16, s72, v75
v_dot2c_f32_bf16 v17, s73, v75
buffer_load_dwordx4 v[72:75], v5, s[32:35], s74 offen offset:0
s_add_u32 s74, s74, 24576
s_waitcnt vmcnt(12)
v_dot2c_f32_bf16 v10, s72, v76
v_dot2c_f32_bf16 v11, s73, v76
v_dot2c_f32_bf16 v12, s72, v77
v_dot2c_f32_bf16 v13, s73, v77
v_dot2c_f32_bf16 v14, s72, v78
v_dot2c_f32_bf16 v15, s73, v78
v_dot2c_f32_bf16 v16, s72, v79
v_dot2c_f32_bf16 v17, s73, v79
s_waitcnt vmcnt(11)
v_dot2c_f32_bf16 v10, s72, v80
v_dot2c_f32_bf16 v11, s73, v80
v_dot2c_f32_bf16 v12, s72, v81
v_dot2c_f32_bf16 v13, s73, v81
v_dot2c_f32_bf16 v14, s72, v82
v_dot2c_f32_bf16 v15, s73, v82
v_dot2c_f32_bf16 v16, s72, v83
v_dot2c_f32_bf16 v17, s73, v83
s_waitcnt vmcnt(10)
v_dot2c_f32_bf16 v10, s72, v84
v_dot2c_f32_bf16 v11, s73, v84
v_dot2c_f32_bf16 v12, s72, v85
v_dot2c_f32_bf16 v13, s73, v85
v_dot2c_f32_bf16 v14, s72, v86
v_dot2c_f32_bf16 v15, s73, v86
v_dot2c_f32_bf16 v16, s72, v87
v_dot2c_f32_bf16 v17, s73, v87
s_waitcnt vmcnt(9)
v_dot2c_f32_bf16 v10, s72, v88
v_dot2c_f32_bf16 v11, s73, v88
v_dot2c_f32_bf16 v12, s72, v89
v_dot2c_f32_bf16 v13, s73, v89
v_dot2c_f32_bf16 v14, s72, v90
v_dot2c_f32_bf16 v15, s73, v90
v_dot2c_f32_bf16 v16, s72, v91
v_dot2c_f32_bf16 v17, s73, v91
s_waitcnt vmcnt(8)
v_dot2c_f32_bf16 v10, s72, v92
v_dot2c_f32_bf16 v11, s73, v92
v_dot2c_f32_bf16 v12, s72, v93
v_dot2c_f32_bf16 v13, s73, v93
v_dot2c_f32_bf16 v14, s72, v94
v_dot2c_f32_bf16 v15, s73, v94
v_dot2c_f32_bf16 v16, s72, v95
v_dot2c_f32_bf16 v17, s73, v95
s_waitcnt vmcnt(7)
v_dot2c_f32_bf16 v10, s72, v96
v_dot2c_f32_bf16 v11, s73, v96
v_dot2c_f32_bf16 v12, s72, v97
v_dot2c_f32_bf16 v13, s73, v97
v_dot2c_f32_bf16 v14, s72, v98
v_dot2c_f32_bf16 v15, s73, v98
v_dot2c_f32_bf16 v16, s72, v99
v_dot2c_f32_bf16 v17, s73, v99
s_waitcnt vmcnt(6)
v_dot2c_f32_bf16 v10, s72, v100
v_dot2c_f32_bf16 v11, s73, v100
v_dot2c_f32_bf16 v12, s72, v101
v_dot2c_f32_bf16 v13, s73, v101
v_dot2c_f32_bf16 v14, s72, v102
v_dot2c_f32_bf16 v15, s73, v102
v_dot2c_f32_bf16 v16, s72, v103
v_dot2c_f32_bf16 v17, s73, v103
s_waitcnt vmcnt(5)
v_dot2c_f32_bf16 v10, s72, v104
v_dot2c_f32_bf16 v11, s73, v104
v_dot2c_f32_bf16 v12, s72, v105
v_dot2c_f32_bf16 v13, s73, v105
v_dot2c_f32_bf16 v14, s72, v106
v_dot2c_f32_bf16 v15, s73, v106
v_dot2c_f32_bf16 v16, s72, v107
v_dot2c_f32_bf16 v17, s73, v107
s_waitcnt vmcnt(4)
v_dot2c_f32_bf16 v10, s72, v108
v_dot2c_f32_bf16 v11, s73, v108
v_dot2c_f32_bf16 v12, s72, v109
v_dot2c_f32_bf16 v13, s73, v109
v_dot2c_f32_bf16 v14, s72, v110
v_dot2c_f32_bf16 v15, s73, v110
v_dot2c_f32_bf16 v16, s72, v111
v_dot2c_f32_bf16 v17, s73, v111
s_waitcnt vmcnt(3)
v_dot2c_f32_bf16 v10, s72, v112
v_dot2c_f32_bf16 v11, s73, v112
v_dot2c_f32_bf16 v12, s72, v113
v_dot2c_f32_bf16 v13, s73, v113
v_dot2c_f32_bf16 v14, s72, v114
v_dot2c_f32_bf16 v15, s73, v114
v_dot2c_f32_bf16 v16, s72, v115
v_dot2c_f32_bf16 v17, s73, v115
s_waitcnt vmcnt(2)
v_dot2c_f32_bf16 v10, s72, v64
v_dot2c_f32_bf16 v11, s73, v64
v_dot2c_f32_bf16 v12, s72, v65
v_dot2c_f32_bf16 v13, s73, v65
v_dot2c_f32_bf16 v14, s72, v66
v_dot2c_f32_bf16 v15, s73, v66
v_dot2c_f32_bf16 v16, s72, v67
v_dot2c_f32_bf16 v17, s73, v67
s_waitcnt vmcnt(1)
v_dot2c_f32_bf16 v10, s72, v68
v_dot2c_f32_bf16 v11, s73, v68
v_dot2c_f32_bf16 v12, s72, v69
v_dot2c_f32_bf16 v13, s73, v69
v_dot2c_f32_bf16 v14, s72, v70
v_dot2c_f32_bf16 v15, s73, v70
v_dot2c_f32_bf16 v16, s72, v71
v_dot2c_f32_bf16 v17, s73, v71
s_waitcnt vmcnt(0)
v_dot2c_f32_bf16 v10, s72, v72
v_dot2c_f32_bf16 v11, s73, v72
v_dot2c_f32_bf16 v12, s72, v73
v_dot2c_f32_bf16 v13, s73, v73
v_dot2c_f32_bf16 v14, s72, v74
v_dot2c_f32_bf16 v15, s73, v74
v_dot2c_f32_bf16 v16, s72, v75
v_dot2c_f32_bf16 v17, s73, v75
s_mul_i32 s68, s26, 6144
s_add_u32 s68, s68, 24576
v_lshl_add_u32 v3, v2, 5, s68
s_nop 0
ds_write_b128 v3, v[10:13] offset:0
ds_write_b128 v3, v[14:17] offset:16
s_waitcnt lgkmcnt(0)
s_barrier
s_cmp_ge_u32 s26, 1
s_cbranch_scc1 L_cs_38
s_lshl_b32 s68, s26, 11
s_add_u32 s68, s68, 24576
v_lshl_add_u32 v3, v2, 2, s68
ds_read_b32 v10, v3 offset:0
ds_read_b32 v11, v3 offset:256
ds_read_b32 v12, v3 offset:512
ds_read_b32 v13, v3 offset:768
ds_read_b32 v14, v3 offset:1024
ds_read_b32 v15, v3 offset:1280
ds_read_b32 v16, v3 offset:1536
ds_read_b32 v17, v3 offset:1792
ds_read_b32 v18, v3 offset:6144
ds_read_b32 v19, v3 offset:6400
ds_read_b32 v20, v3 offset:6656
ds_read_b32 v21, v3 offset:6912
ds_read_b32 v22, v3 offset:7168
ds_read_b32 v23, v3 offset:7424
ds_read_b32 v24, v3 offset:7680
ds_read_b32 v25, v3 offset:7936
s_waitcnt lgkmcnt(7)
ds_read_b32 v26, v3 offset:12288
ds_read_b32 v27, v3 offset:12544
ds_read_b32 v28, v3 offset:12800
ds_read_b32 v29, v3 offset:13056
ds_read_b32 v30, v3 offset:13312
ds_read_b32 v31, v3 offset:13568
ds_read_b32 v32, v3 offset:13824
ds_read_b32 v33, v3 offset:14080
s_waitcnt lgkmcnt(7)
ds_read_b32 v34, v3 offset:18432
ds_read_b32 v35, v3 offset:18688
ds_read_b32 v36, v3 offset:18944
ds_read_b32 v37, v3 offset:19200
ds_read_b32 v38, v3 offset:19456
ds_read_b32 v39, v3 offset:19712
ds_read_b32 v40, v3 offset:19968
ds_read_b32 v41, v3 offset:20224
s_waitcnt lgkmcnt(0)
s_nop 0
v_pk_add_f32 v[10:11], v[10:11], v[26:27]
v_pk_add_f32 v[12:13], v[12:13], v[28:29]
v_pk_add_f32 v[14:15], v[14:15], v[30:31]
v_pk_add_f32 v[16:17], v[16:17], v[32:33]
v_pk_add_f32 v[18:19], v[18:19], v[34:35]
v_pk_add_f32 v[20:21], v[20:21], v[36:37]
v_pk_add_f32 v[22:23], v[22:23], v[38:39]
v_pk_add_f32 v[24:25], v[24:25], v[40:41]
v_pk_add_f32 v[10:11], v[10:11], v[18:19]
v_pk_add_f32 v[12:13], v[12:13], v[20:21]
v_pk_add_f32 v[14:15], v[14:15], v[22:23]
v_pk_add_f32 v[16:17], v[16:17], v[24:25]
v_pk_add_f32 v[10:11], v[10:11], v[14:15]
v_pk_add_f32 v[12:13], v[12:13], v[16:17]
v_pk_add_f32 v[10:11], v[10:11], v[12:13]
v_add_f32 v10, v10, v11
s_lshl2_add_u32 s68, s6, s26
s_lshl_b32 s68, s68, 8
s_add_u32 s68, s68, 6897664
v_lshlrev_b32 v3, 2, v2
buffer_store_dword v10, v3, s[64:67], s68 offen sc1
L_cs_38:
s_waitcnt vmcnt(0)
s_barrier
s_lshl1_add_u32 s70, s6, 1
s_cmp_lg_u32 s26, 0
s_cbranch_scc1 L_pub_39
s_lshl_b32 s68, s70, 4
s_add_u32 s68, s68, 6971392
v_lshlrev_b32 v3, 11, v2
v_mov_b32 v4, s27
s_mov_b64 exec, 255
buffer_store_dword v4, v3, s[64:67], s68 offen sc1
s_mov_b64 exec, -1
L_pub_39:
s_lshl2_add_u32 s70, s6, s26
v_lshlrev_b32 v3, 6, v2
buffer_load_dword v5, v3, s[52:55], 0 offen
s_mul_i32 s68, s70, 16384
buffer_load_dwordx4 v[64:67], v246, s[36:39], s68 offen offset:0
buffer_load_dwordx4 v[68:71], v246, s[36:39], s68 offen offset:1024
buffer_load_dwordx4 v[72:75], v246, s[36:39], s68 offen offset:2048
buffer_load_dwordx4 v[76:79], v246, s[36:39], s68 offen offset:3072
s_add_u32 s68, s68, 4096
buffer_load_dwordx4 v[80:83], v246, s[36:39], s68 offen offset:0
buffer_load_dwordx4 v[84:87], v246, s[36:39], s68 offen offset:1024
buffer_load_dwordx4 v[88:91], v246, s[36:39], s68 offen offset:2048
buffer_load_dwordx4 v[92:95], v246, s[36:39], s68 offen offset:3072
s_add_u32 s68, s68, 4096
buffer_load_dwordx4 v[96:99], v246, s[36:39], s68 offen offset:0
buffer_load_dwordx4 v[100:103], v246, s[36:39], s68 offen offset:1024
buffer_load_dwordx4 v[104:107], v246, s[36:39], s68 offen offset:2048
buffer_load_dwordx4 v[108:111], v246, s[36:39], s68 offen offset:3072
s_add_u32 s68, s68, 4096
buffer_load_dwordx4 v[112:115], v246, s[36:39], s68 offen offset:0
buffer_load_dwordx4 v[116:119], v246, s[36:39], s68 offen offset:1024
buffer_load_dwordx4 v[120:123], v246, s[36:39], s68 offen offset:2048
buffer_load_dwordx4 v[124:127], v246, s[36:39], s68 offen offset:3072
s_add_u32 s68, s68, 4096
s_waitcnt vmcnt(15)
s_mul_i32 s68, s70, 176128
s_waitcnt vmcnt(0)
s_or_b32 s70, s6, s26
s_cmp_eq_u32 s70, 0
s_cbranch_scc0 L_noep
s_mov_b32 s70, 0
s_lshl_b32 s68, s70, 4
s_add_u32 s68, s68, 6905856
s_add_u32 s68, s68, s11
v_min_u32 v3, 63, v2
v_lshlrev_b32 v3, 4, v3
s_mov_b32 s69, 0
L_poll_40:
buffer_load_dword v4, v3, s[64:67], s68 offen sc1
s_waitcnt vmcnt(0)
v_cmp_ne_u32 vcc, s27, v4
s_cbranch_vccz L_polld_41
s_add_u32 s69, s69, 1
s_cmp_lt_u32 s69, 262144
s_cbranch_scc0 L_polld_41
s_sleep 1
s_branch L_poll_40
L_polld_41:
s_mov_b32 s70, 64
s_lshl_b32 s68, s70, 4
s_add_u32 s68, s68, 6905856
s_add_u32 s68, s68, s11
v_min_u32 v3, 63, v2
v_lshlrev_b32 v3, 4, v3
s_mov_b32 s69, 0
L_poll_42:
buffer_load_dword v4, v3, s[64:67], s68 offen sc1
s_waitcnt vmcnt(0)
v_cmp_ne_u32 vcc, s27, v4
s_cbranch_vccz L_polld_43
s_add_u32 s69, s69, 1
s_cmp_lt_u32 s69, 262144
s_cbranch_scc0 L_polld_43
s_sleep 1
s_branch L_poll_42
L_polld_43:
s_mov_b32 s70, 0
s_lshl_b32 s68, s70, 4
s_add_u32 s68, s68, 6987776
v_min_u32 v3, 63, v2
v_lshlrev_b32 v3, 4, v3
s_mov_b32 s69, 0
L_poll_44:
buffer_load_dword v4, v3, s[64:67], s68 offen sc1
s_waitcnt vmcnt(0)
v_cmp_ne_u32 vcc, s27, v4
s_cbranch_vccz L_polld_45
s_add_u32 s69, s69, 1
s_cmp_lt_u32 s69, 262144
s_cbranch_scc0 L_polld_45
s_sleep 1
s_branch L_poll_44
L_polld_45:
s_mov_b32 s70, 64
s_lshl_b32 s68, s70, 4
s_add_u32 s68, s68, 6987776
v_min_u32 v3, 63, v2
v_lshlrev_b32 v3, 4, v3
s_mov_b32 s69, 0
L_poll_46:
buffer_load_dword v4, v3, s[64:67], s68 offen sc1
s_waitcnt vmcnt(0)
v_cmp_ne_u32 vcc, s27, v4
s_cbranch_vccz L_polld_47
s_add_u32 s69, s69, 1
s_cmp_lt_u32 s69, 262144
s_cbranch_scc0 L_polld_47
s_sleep 1
s_branch L_poll_46
L_polld_47:
s_mov_b32 s68, 6905728
v_mov_b32 v4, s27
s_mov_b64 exec, 1
buffer_store_dword v4, off, s[64:67], s68 sc1
s_mov_b32 s68, 11534336
buffer_store_dword v4, off, s[64:67], s68 sc1
s_mov_b64 exec, -1
L_noep:
v_lshrrev_b32 v3, 9, v247
v_and_b32 v3, 0xffe, v3
v_add_u32 v4, 8192, v247
buffer_load_dwordx4 a[240:243], v247, s[28:31], 0 offen
buffer_load_dwordx4 a[244:247], v4, s[28:31], 0 offen
buffer_load_ushort v0, v3, s[52:55], 0 offen
buffer_load_ushort v1, v3, s[52:55], 0 offen offset:16
s_add_u32 m0, s62, 0
s_add_u32 s61, s83, 0
s_and_b32 s61, s61, 7
s_lshl3_add_u32 s61, s26, s61
s_lshl_b32 s61, s61, 14
buffer_load_dwordx4 v242, s[36:39], s61 offen lds
buffer_load_dwordx4 v243, s[36:39], s61 offen offset:1024 lds
s_add_u32 m0, s62, 2048
s_add_u32 s61, s83, 1
s_and_b32 s61, s61, 7
s_lshl3_add_u32 s61, s26, s61
s_lshl_b32 s61, s61, 14
buffer_load_dwordx4 v242, s[36:39], s61 offen lds
buffer_load_dwordx4 v243, s[36:39], s61 offen offset:1024 lds
s_add_u32 m0, s62, 4096
s_add_u32 s61, s83, 2
s_and_b32 s61, s61, 7
s_lshl3_add_u32 s61, s26, s61
s_lshl_b32 s61, s61, 14
buffer_load_dwordx4 v242, s[36:39], s61 offen lds
buffer_load_dwordx4 v243, s[36:39], s61 offen offset:1024 lds
s_add_u32 m0, s62, 6144
s_add_u32 s61, s83, 3
s_and_b32 s61, s61, 7
s_lshl3_add_u32 s61, s26, s61
s_lshl_b32 s61, s61, 14
buffer_load_dwordx4 v242, s[36:39], s61 offen lds
buffer_load_dwordx4 v243, s[36:39], s61 offen offset:1024 lds
s_add_u32 m0, s62, 8192
s_add_u32 s61, s83, 4
s_and_b32 s61, s61, 7
s_lshl3_add_u32 s61, s26, s61
s_lshl_b32 s61, s61, 14
buffer_load_dwordx4 v242, s[36:39], s61 offen lds
buffer_load_dwordx4 v243, s[36:39], s61 offen offset:1024 lds
s_add_u32 m0, s62, 10240
s_add_u32 s61, s83, 5
s_and_b32 s61, s61, 7
s_lshl3_add_u32 s61, s26, s61
s_lshl_b32 s61, s61, 14
buffer_load_dwordx4 v242, s[36:39], s61 offen lds
buffer_load_dwordx4 v243, s[36:39], s61 offen offset:1024 lds
s_add_u32 m0, s62, 49152
s_add_u32 s61, s83, 6
s_and_b32 s61, s61, 7
s_lshl3_add_u32 s61, s26, s61
s_lshl_b32 s61, s61, 14
buffer_load_dwordx4 v242, s[36:39], s61 offen lds
buffer_load_dwordx4 v243, s[36:39], s61 offen offset:1024 lds
s_add_u32 m0, s62, 51200
s_add_u32 s61, s83, 7
s_and_b32 s61, s61, 7
s_lshl3_add_u32 s61, s26, s61
s_lshl_b32 s61, s61, 14
buffer_load_dwordx4 v242, s[36:39], s61 offen lds
buffer_load_dwordx4 v243, s[36:39], s61 offen offset:1024 lds
s_add_u32 m0, s62, 53248
s_nop 0
buffer_load_dwordx4 v240, s[48:51], s60 offen lds
buffer_load_dwordx4 v241, s[48:51], s60 offen offset:1024 lds
s_lshl2_add_u32 s70, s8, s26
s_lshl_b32 s74, s70, 6
s_add_u32 s74, s74, 6955008
s_and_b32 s70, s4, 1
s_lshl_b32 s70, s70, 13
s_waitcnt vmcnt(16)
ds_read_b64_tr_b16 a[176:177], v248 offset:0
ds_read_b64_tr_b16 a[180:181], v249 offset:0
ds_read_b64_tr_b16 a[184:185], v250 offset:0
ds_read_b64_tr_b16 a[188:189], v251 offset:0
s_add_u32 m0, s62, 55296
s_add_u32 s60, s60, 65536
buffer_load_dwordx4 v240, s[48:51], s60 offen lds
buffer_load_dwordx4 v241, s[48:51], s60 offen offset:1024 lds
s_add_u32 s74, s74, s70
v_and_b32 v26, 3, v2
v_lshlrev_b32 v26, 4, v26
s_lshl_b32 s68, s8, 16
s_waitcnt vmcnt(16)
ds_read_b64_tr_b16 a[178:179], v248 offset:2048
ds_read_b64_tr_b16 a[182:183], v249 offset:2048
ds_read_b64_tr_b16 a[186:187], v250 offset:2048
ds_read_b64_tr_b16 a[190:191], v251 offset:2048
s_add_u32 m0, s62, 57344
s_add_u32 s60, s60, 65536
s_cmp_eq_u32 s60, s1
s_cselect_b32 s60, s0, s60
buffer_load_dwordx4 v240, s[48:51], s60 offen lds
buffer_load_dwordx4 v241, s[48:51], s60 offen offset:1024 lds
s_lshl_b32 s69, s26, 13
s_add_u32 s68, s68, s69
s_add_u32 s72, s68, 2097152
s_mul_i32 s71, s9, 176128
s_waitcnt vmcnt(16)
ds_read_b64_tr_b16 a[192:193], v248 offset:4096
ds_read_b64_tr_b16 a[196:197], v249 offset:4096
ds_read_b64_tr_b16 a[200:201], v250 offset:4096
ds_read_b64_tr_b16 a[204:205], v251 offset:4096
s_add_u32 m0, s62, 59392
s_add_u32 s60, s60, 65536
buffer_load_dwordx4 v240, s[48:51], s60 offen lds
buffer_load_dwordx4 v241, s[48:51], s60 offen offset:1024 lds
s_add_u32 s71, s71, 4194304
s_add_u32 s63, s63, s71
s_lshr_b32 s22, s0, 7
s_waitcnt vmcnt(16) lgkmcnt(8)
ds_read_b64_tr_b16 a[194:195], v248 offset:6144
ds_read_b64_tr_b16 a[198:199], v249 offset:6144
ds_read_b64_tr_b16 a[202:203], v250 offset:6144
ds_read_b64_tr_b16 a[206:207], v251 offset:6144
s_add_u32 m0, s62, 24576
s_add_u32 s60, s60, 65536
s_cmp_eq_u32 s60, s1
s_cselect_b32 s60, s0, s60
buffer_load_dwordx4 v240, s[48:51], s60 offen lds
buffer_load_dwordx4 v241, s[48:51], s60 offen offset:1024 lds
s_lshr_b32 s23, s1, 7
s_add_u32 s22, s22, s71
s_waitcnt vmcnt(16) lgkmcnt(8)
ds_read_b64_tr_b16 a[208:209], v248 offset:8192
ds_read_b64_tr_b16 a[212:213], v249 offset:8192
ds_read_b64_tr_b16 a[216:217], v250 offset:8192
ds_read_b64_tr_b16 a[220:221], v251 offset:8192
s_add_u32 m0, s62, 26624
s_add_u32 s60, s60, 65536
buffer_load_dwordx4 v240, s[48:51], s60 offen lds
buffer_load_dwordx4 v241, s[48:51], s60 offen offset:1024 lds
s_add_u32 s23, s23, s71
v_mov_b32 v18, v246
s_waitcnt vmcnt(16) lgkmcnt(8)
ds_read_b64_tr_b16 a[210:211], v248 offset:10240
ds_read_b64_tr_b16 a[214:215], v249 offset:10240
ds_read_b64_tr_b16 a[218:219], v250 offset:10240
ds_read_b64_tr_b16 a[222:223], v251 offset:10240
s_add_u32 m0, s62, 28672
s_add_u32 s60, s60, 65536
s_cmp_eq_u32 s60, s1
s_cselect_b32 s60, s0, s60
buffer_load_dwordx4 v240, s[48:51], s60 offen lds
buffer_load_dwordx4 v241, s[48:51], s60 offen offset:1024 lds
v_add_u32 v19, 44032, v18
v_add_u32 v20, 44032, v19
s_waitcnt vmcnt(16) lgkmcnt(8)
ds_read_b64_tr_b16 a[224:225], v248 offset:49152
ds_read_b64_tr_b16 a[228:229], v249 offset:49152
ds_read_b64_tr_b16 a[232:233], v250 offset:49152
ds_read_b64_tr_b16 a[236:237], v251 offset:49152
s_add_u32 m0, s62, 30720
s_add_u32 s60, s60, 65536
buffer_load_dwordx4 v240, s[48:51], s60 offen lds
buffer_load_dwordx4 v241, s[48:51], s60 offen offset:1024 lds
v_add_u32 v21, 44032, v20
s_waitcnt vmcnt(16) lgkmcnt(8)
ds_read_b64_tr_b16 a[226:227], v248 offset:51200
ds_read_b64_tr_b16 a[230:231], v249 offset:51200
ds_read_b64_tr_b16 a[234:235], v250 offset:51200
ds_read_b64_tr_b16 a[238:239], v251 offset:51200
s_add_u32 m0, s62, 32768
s_add_u32 s60, s60, 65536
s_cmp_eq_u32 s60, s1
s_cselect_b32 s60, s0, s60
buffer_load_dwordx4 v240, s[48:51], s60 offen lds
buffer_load_dwordx4 v241, s[48:51], s60 offen offset:1024 lds
v_lshrrev_b32 v24, 4, v2
s_waitcnt vmcnt(16) lgkmcnt(8)
ds_read_b64_tr_b16 a[0:1], v248 offset:53248
ds_read_b64_tr_b16 a[4:5], v249 offset:53248
ds_read_b64_tr_b16 a[8:9], v250 offset:53248
ds_read_b64_tr_b16 a[12:13], v251 offset:53248
s_add_u32 m0, s62, 34816
s_add_u32 s60, s60, 65536
buffer_load_dwordx4 v240, s[48:51], s60 offen lds
buffer_load_dwordx4 v241, s[48:51], s60 offen offset:1024 lds
v_and_b32 v25, 15, v2
s_waitcnt vmcnt(16) lgkmcnt(8)
ds_read_b64_tr_b16 a[2:3], v248 offset:55296
ds_read_b64_tr_b16 a[6:7], v249 offset:55296
ds_read_b64_tr_b16 a[10:11], v250 offset:55296
ds_read_b64_tr_b16 a[14:15], v251 offset:55296
s_add_u32 m0, s62, 0
s_add_u32 s60, s60, 65536
s_cmp_eq_u32 s60, s1
s_cselect_b32 s60, s0, s60
buffer_load_dwordx4 v240, s[48:51], s60 offen lds
buffer_load_dwordx4 v241, s[48:51], s60 offen offset:1024 lds
v_lshlrev_b32 v25, 4, v25
s_waitcnt vmcnt(16) lgkmcnt(8)
ds_read_b64_tr_b16 a[16:17], v248 offset:57344
ds_read_b64_tr_b16 a[20:21], v249 offset:57344
ds_read_b64_tr_b16 a[24:25], v250 offset:57344
ds_read_b64_tr_b16 a[28:29], v251 offset:57344
s_add_u32 m0, s62, 2048
s_add_u32 s60, s60, 65536
buffer_load_dwordx4 v240, s[48:51], s60 offen lds
buffer_load_dwordx4 v241, s[48:51], s60 offen offset:1024 lds
v_lshl_add_u32 v22, v24, 9, v25
s_waitcnt vmcnt(16) lgkmcnt(8)
ds_read_b64_tr_b16 a[18:19], v248 offset:59392
ds_read_b64_tr_b16 a[22:23], v249 offset:59392
ds_read_b64_tr_b16 a[26:27], v250 offset:59392
ds_read_b64_tr_b16 a[30:31], v251 offset:59392
s_add_u32 m0, s62, 4096
s_add_u32 s60, s60, 65536
s_cmp_eq_u32 s60, s1
s_cselect_b32 s60, s0, s60
buffer_load_dwordx4 v240, s[48:51], s60 offen lds
buffer_load_dwordx4 v241, s[48:51], s60 offen offset:1024 lds
v_add_u32 v23, 32768, v22
s_waitcnt vmcnt(16) lgkmcnt(8)
ds_read_b64_tr_b16 a[32:33], v248 offset:24576
ds_read_b64_tr_b16 a[36:37], v249 offset:24576
ds_read_b64_tr_b16 a[40:41], v250 offset:24576
ds_read_b64_tr_b16 a[44:45], v251 offset:24576
s_add_u32 m0, s62, 6144
s_add_u32 s60, s60, 65536
buffer_load_dwordx4 v240, s[48:51], s60 offen lds
buffer_load_dwordx4 v241, s[48:51], s60 offen offset:1024 lds
s_waitcnt vmcnt(16) lgkmcnt(8)
ds_read_b64_tr_b16 a[34:35], v248 offset:26624
ds_read_b64_tr_b16 a[38:39], v249 offset:26624
ds_read_b64_tr_b16 a[42:43], v250 offset:26624
ds_read_b64_tr_b16 a[46:47], v251 offset:26624
s_add_u32 m0, s62, 8192
s_add_u32 s60, s60, 65536
s_cmp_eq_u32 s60, s1
s_cselect_b32 s60, s0, s60
buffer_load_dwordx4 v240, s[48:51], s60 offen lds
buffer_load_dwordx4 v241, s[48:51], s60 offen offset:1024 lds
s_waitcnt vmcnt(16) lgkmcnt(8)
ds_read_b64_tr_b16 a[48:49], v248 offset:28672
ds_read_b64_tr_b16 a[52:53], v249 offset:28672
ds_read_b64_tr_b16 a[56:57], v250 offset:28672
ds_read_b64_tr_b16 a[60:61], v251 offset:28672
s_add_u32 m0, s62, 10240
s_add_u32 s60, s60, 65536
buffer_load_dwordx4 v240, s[48:51], s60 offen lds
buffer_load_dwordx4 v241, s[48:51], s60 offen offset:1024 lds
s_waitcnt vmcnt(16) lgkmcnt(8)
ds_read_b64_tr_b16 a[50:51], v248 offset:30720
ds_read_b64_tr_b16 a[54:55], v249 offset:30720
ds_read_b64_tr_b16 a[58:59], v250 offset:30720
ds_read_b64_tr_b16 a[62:63], v251 offset:30720
s_waitcnt vmcnt(14) lgkmcnt(8)
ds_read_b64_tr_b16 a[64:65], v248 offset:32768
ds_read_b64_tr_b16 a[68:69], v249 offset:32768
ds_read_b64_tr_b16 a[72:73], v250 offset:32768
ds_read_b64_tr_b16 a[76:77], v251 offset:32768
s_waitcnt vmcnt(12) lgkmcnt(8)
ds_read_b64_tr_b16 a[66:67], v248 offset:34816
ds_read_b64_tr_b16 a[70:71], v249 offset:34816
ds_read_b64_tr_b16 a[74:75], v250 offset:34816
ds_read_b64_tr_b16 a[78:79], v251 offset:34816
s_waitcnt vmcnt(10) lgkmcnt(8)
ds_read_b64_tr_b16 a[80:81], v248 offset:0
ds_read_b64_tr_b16 a[84:85], v249 offset:0
ds_read_b64_tr_b16 a[88:89], v250 offset:0
ds_read_b64_tr_b16 a[92:93], v251 offset:0
s_waitcnt vmcnt(8) lgkmcnt(8)
ds_read_b64_tr_b16 a[82:83], v248 offset:2048
ds_read_b64_tr_b16 a[86:87], v249 offset:2048
ds_read_b64_tr_b16 a[90:91], v250 offset:2048
ds_read_b64_tr_b16 a[94:95], v251 offset:2048
s_waitcnt vmcnt(6) lgkmcnt(8)
ds_read_b64_tr_b16 a[96:97], v248 offset:4096
ds_read_b64_tr_b16 a[100:101], v249 offset:4096
ds_read_b64_tr_b16 a[104:105], v250 offset:4096
ds_read_b64_tr_b16 a[108:109], v251 offset:4096
s_waitcnt vmcnt(4) lgkmcnt(8)
ds_read_b64_tr_b16 a[98:99], v248 offset:6144
ds_read_b64_tr_b16 a[102:103], v249 offset:6144
ds_read_b64_tr_b16 a[106:107], v250 offset:6144
ds_read_b64_tr_b16 a[110:111], v251 offset:6144
s_waitcnt vmcnt(2) lgkmcnt(8)
ds_read_b64_tr_b16 a[112:113], v248 offset:8192
ds_read_b64_tr_b16 a[116:117], v249 offset:8192
ds_read_b64_tr_b16 a[120:121], v250 offset:8192
ds_read_b64_tr_b16 a[124:125], v251 offset:8192
s_waitcnt vmcnt(0) lgkmcnt(8)
ds_read_b64_tr_b16 a[114:115], v248 offset:10240
ds_read_b64_tr_b16 a[118:119], v249 offset:10240
ds_read_b64_tr_b16 a[122:123], v250 offset:10240
ds_read_b64_tr_b16 a[126:127], v251 offset:10240
s_lshr_b32 s70, s9, 1
s_lshl_b32 s70, s70, 5
s_mul_i32 s71, s26, 7
s_and_b32 s71, s71, 30
s_add_u32 s70, s70, s71
s_lshl_b32 s24, s70, 4
s_add_u32 s24, s24, 6938624
s_add_u32 s24, s24, s11
v_min_u32 v6, 9, v2
v_lshlrev_b32 v6, 4, v6
buffer_load_dword v7, v6, s[64:67], s24 offen sc1
s_add_u32 m0, s62, 49152
s_add_u32 s60, s60, 65536
s_cmp_eq_u32 s60, s1
s_cselect_b32 s60, s0, s60
buffer_load_dwordx4 v240, s[48:51], s60 offen lds
buffer_load_dwordx4 v241, s[48:51], s60 offen offset:1024 lds
s_add_u32 m0, s62, 51200
s_add_u32 s60, s60, 65536
buffer_load_dwordx4 v240, s[48:51], s60 offen lds
buffer_load_dwordx4 v241, s[48:51], s60 offen offset:1024 lds
s_add_u32 m0, s62, 53248
s_add_u32 s60, s60, 65536
s_cmp_eq_u32 s60, s1
s_cselect_b32 s60, s0, s60
buffer_load_dwordx4 v240, s[48:51], s60 offen lds
buffer_load_dwordx4 v241, s[48:51], s60 offen offset:1024 lds
s_add_u32 m0, s62, 55296
s_add_u32 s60, s60, 65536
buffer_load_dwordx4 v240, s[48:51], s60 offen lds
buffer_load_dwordx4 v241, s[48:51], s60 offen offset:1024 lds
s_add_u32 m0, s62, 57344
s_add_u32 s60, s60, 65536
s_cmp_eq_u32 s60, s1
s_cselect_b32 s60, s0, s60
s_cmp_eq_u32 s26, 3
s_cselect_b32 s60, 5636096, s60
buffer_load_dwordx4 v240, s[48:51], s60 offen lds
buffer_load_dwordx4 v241, s[48:51], s60 offen offset:1024 lds
s_add_u32 m0, s62, 59392
s_add_u32 s60, s60, 65536
buffer_load_dwordx4 v240, s[48:51], s60 offen lds
buffer_load_dwordx4 v241, s[48:51], s60 offen offset:1024 lds
s_waitcnt vmcnt(12) lgkmcnt(0)
v_cmp_ne_u32 vcc, s27, v7
s_cbranch_vccz L_go_48
s_mov_b32 s25, 0
L_poll_50:
v_cmp_ne_u32 vcc, s27, v7
s_cbranch_vccz L_polld_51
s_add_u32 s25, s25, 1
s_cmp_lt_u32 s25, 262144
s_cbranch_scc0 L_polld_51
s_sleep 1
buffer_load_dword v7, v6, s[64:67], s24 offen sc1
s_waitcnt vmcnt(0)
s_branch L_poll_50
L_polld_51:
L_go_48:
s_branch L_p2
L_exit:
s_endpgm
L_end:
.section .rodata,"a"
.p2align 6
.amdhsa_kernel parallel_sum__linear_attn_block__mixer_token_mlp__prompt_kernel
  .amdhsa_next_free_vgpr 512
  .amdhsa_next_free_sgpr 102
  .amdhsa_accum_offset 256
  .amdhsa_group_segment_fixed_size 0
  .amdhsa_kernarg_size 88
  .amdhsa_user_sgpr_count 2
  .amdhsa_user_sgpr_kernarg_segment_ptr 1
  .amdhsa_system_sgpr_workgroup_id_x 1
  .amdhsa_float_denorm_mode_32 3
.end_amdhsa_kernel
.text
```
